```python
import torch

def _softmax(x, axis=-1):
    return torch.softmax(x, dim=axis)
def _gelu(x):
    return torch.nn.functional.gelu(x, approximate="tanh")
def _silu(x):
    return torch.nn.functional.silu(x)
def _sigmoid(x):
    return torch.sigmoid(x)
def _layernorm(x, axis=-1, eps=1e-5):
    m = x.mean(dim=axis, keepdim=True)
    v = x.var(dim=axis, keepdim=True, unbiased=False)
    return (x - m) / torch.sqrt(v + eps)
def _scatter_add(tgt, idx, src, axis=0):
    return tgt.clone().index_add_(axis, idx, src)
def _segment_sum(src, seg, n):
    out = torch.zeros((n,) + src.shape[1:], dtype=src.dtype)
    return out.index_add_(0, seg, src)
def _pad(x, pw):
    flat = tuple(v for pair in reversed(pw) for v in pair)
    return torch.nn.functional.pad(x, flat)

kernel_name = 'concat_heads__compressed_kv_cla__spectral_gfnet__prompt'

def setup_inputs():

    _w = (lambda a: (lambda t: t.to(torch.bfloat16) if t.is_floating_point() else t)(torch.as_tensor(a)))
    def _A_setup():
        B, H, Sq, Sk, D, M = 1, 32, 2048, 2048, 128, 512
        Dc = 4 * D
        return {
            "x": _w((lambda *s: torch.randn(*s, dtype=torch.bfloat16) * 3.2)(B, Sq, M)),
            "c_kv": _w((lambda *s: torch.randn(*s, dtype=torch.bfloat16) * 0.05)(B, Sk, Dc)),
            "w_q": _w((lambda *s: torch.randn(*s, dtype=torch.bfloat16) * 3.2)(M, H, D) * (M ** -0.5)),
            "w_uk": _w((lambda *s: torch.randn(*s, dtype=torch.bfloat16) * 3.2)(Dc, H, D) * (Dc ** -0.5)),
            "w_uv": _w((lambda *s: torch.randn(*s, dtype=torch.bfloat16) * 0.05)(Dc, H, D) * (Dc ** -0.5)),
            "w_o": _w((lambda *s: torch.randn(*s, dtype=torch.bfloat16) * 0.05)(H, D, M) * ((H * D) ** -0.5)),
        }
    _A_in = _A_setup()

    def _B_setup():
        B, S, D = 1, 2048, 512
        Df = D // 2 + 1
        return {
            "x": _w((lambda *s: torch.randn(*s, dtype=torch.bfloat16) * 0.05)(B, S, D)),
            "w_r": _w((lambda *s: torch.randn(*s, dtype=torch.bfloat16) * 0.05)(S, Df) * 0.02),
            "w_i": _w((lambda *s: torch.randn(*s, dtype=torch.bfloat16) * 0.05)(S, Df) * 0.02),
        }
    _B_in = _B_setup()

    return {
        "A_x": _A_in["x"],
        "A_c_kv": _A_in["c_kv"],
        "A_w_q": _A_in["w_q"],
        "A_w_uk": _A_in["w_uk"],
        "A_w_uv": _A_in["w_uv"],
        "A_w_o": _A_in["w_o"],
        "B_x": _B_in["x"],
        "B_w_r": _B_in["w_r"],
        "B_w_i": _B_in["w_i"],
    }

def reference(A_x, A_c_kv, A_w_q, A_w_uk, A_w_uv, A_w_o, B_x, B_w_r, B_w_i):
    def _A_ref(x, c_kv, w_q, w_uk, w_uv, w_o):
        B, Sq, M = x.shape[0], x.shape[1], x.shape[2]
        Sk = c_kv.shape[1]
        H, D = w_q.shape[1], w_q.shape[2]
        q = torch.einsum("bqm,mhd->bhqd", x, w_q)
        k = torch.einsum("bkc,chd->bhkd", c_kv, w_uk)
        v = torch.einsum("bkc,chd->bhkd", c_kv, w_uv)
        scores = torch.einsum("bhqd,bhkd->bhqk", q, k) * (D ** -0.5)
        off = Sk - Sq
        qi = torch.arange(Sq)[:, None]
        kj = torch.arange(Sk)[None, :]
        cmask = kj <= (qi + off)
        scores = torch.where(cmask[None, None], scores, -1e9)
        p = _softmax(scores, axis=-1)
        ctx = torch.einsum("bhqk,bhkd->bhqd", p, v)
        return torch.einsum("bhqd,hdm->bqm", ctx, w_o)

    def _B_ref(x, w_r, w_i):
        B, S, D = x.shape
        X = (lambda x, axes=(-2,-1): torch.fft.rfft2(x.float(), dim=axes))(x, axes=(-2, -1))
        W = w_r + 1j * w_i
        X = X * W
        y = (lambda x, s, axes=(-2,-1): torch.fft.irfft2(x, s=s, dim=axes).to(torch.bfloat16))(X, (S, D), axes=(-2, -1))
        return y

    a = _A_ref(A_x, A_c_kv, A_w_q, A_w_uk, A_w_uv, A_w_o)
    b = _B_ref(B_x, B_w_r, B_w_i)
    return torch.concatenate([a, b], axis=-1)
```

```asm
; @launch grid=(256,1,1) block=(512,1,1) lds=163840
.amdgcn_target "amdgcn-amd-amdhsa--gfx950"
.text
.globl concat_heads__compressed_kv_cla__spectral_gfnet__prompt_kernel
.p2align 8
.type concat_heads__compressed_kv_cla__spectral_gfnet__prompt_kernel,@function
concat_heads__compressed_kv_cla__spectral_gfnet__prompt_kernel:
    s_cmp_ge_u32 s2, 8
    s_cbranch_scc1 concat_nopf_1
    s_getpc_b64 s[14:15]
concat_pc_2:
    v_lshlrev_b32 v4, 7, v0
    v_add_u32 v4, code_first-concat_pc_2+0, v4
    v_min_u32 v4, code_last-concat_pc_2, v4
    v_mov_b32 v5, s15
    v_add_co_u32 v4, vcc, s14, v4
    s_nop 1
    v_addc_co_u32 v5, vcc, 0, v5, vcc
    global_load_dword v13, v[4:5], off
concat_nopf_1:
code_first:
    s_cmp_ge_u32 s2, 256
    s_cbranch_scc1 concat_end
    s_load_dwordx8 s[84:91], s[0:1], 0
    s_load_dwordx2 s[92:93], s[0:1], 32
    s_load_dwordx4 s[96:99], s[0:1], 48
    s_load_dwordx2 s[94:95], s[0:1], 64
    s_load_dwordx2 s[12:13], s[0:1], 88
    s_load_dwordx2 s[76:77], s[0:1], 40
    v_lshrrev_b32 v94, 6, v0
    v_and_b32 v1, 63, v0
    v_readfirstlane_b32 s3, v94
    s_and_b32 s14, s2, 7
    s_lshl_b32 s14, s14, 2
    s_bfe_u32 s15, s2, 0x20003
    s_add_u32 s4, s14, s15
    s_lshr_b32 s5, s2, 5
    s_lshl_b32 s60, s3, 10
    s_lshl_b32 s61, s5, 18
    s_lshl_b32 s62, s4, 8
    s_lshl_b32 s63, s5, 17
    s_sub_u32 s64, 0x1e0000, s63
    v_lshrrev_b32 v14, 3, v0
    v_lshrrev_b32 v6, 4, v0
    v_xor_b32 v7, v6, v0
    v_and_b32 v8, 7, v7
    v_lshlrev_b32 v8, 4, v8
    v_lshl_add_u32 v14, v14, 10, v8
    v_and_b32 v8, 15, v7
    v_lshlrev_b32 v8, 4, v8
    v_lshrrev_b32 v9, 4, v1
    v_lshl_add_u32 v92, v9, 16, v8
    v_and_b32 v7, 3, v6
    v_bfe_u32 v8, v0, 7, 1
    v_lshl_add_u32 v7, v8, 2, v7
    v_lshlrev_b32 v7, 1, v7
    v_xor_b32 v7, v7, v0
    v_and_b32 v7, 15, v7
    v_lshlrev_b32 v7, 4, v7
    v_lshl_add_u32 v15, v6, 13, v7
    v_lshlrev_b32 v2, 4, v1
    s_waitcnt lgkmcnt(0)
    s_mov_b32 s16, s86
    s_mov_b32 s17, s87
    s_mov_b32 s18, 0x200000
    s_mov_b32 s19, 0x20000
    s_mov_b32 s24, s90
    s_mov_b32 s25, s91
    s_mov_b32 s26, 0x400000
    s_mov_b32 s27, 0x20000
    s_mov_b32 s28, s92
    s_mov_b32 s29, s93
    s_mov_b32 s30, 0x400000
    s_mov_b32 s31, 0x20000
    s_add_u32 m0, s60, 0x18000
    s_add_u32 s14, s62, 0x0
    buffer_load_dwordx4 v15, s[24:27], s14 offen nt lds
    s_add_u32 m0, s60, 0x1a000
    s_add_u32 s14, s62, 0x0
    buffer_load_dwordx4 v15, s[28:31], s14 offen nt lds
    s_add_u32 m0, s60, 0x0
    s_add_u32 s14, s61, 0x0
    buffer_load_dwordx4 v14, s[16:19], s14 offen lds
    s_add_u32 m0, s60, 0x2000
    s_add_u32 s14, s61, 0x10000
    buffer_load_dwordx4 v14, s[16:19], s14 offen lds
    s_add_u32 m0, s60, 0x4000
    s_add_u32 s14, s61, 0x20000
    buffer_load_dwordx4 v14, s[16:19], s14 offen lds
    s_add_u32 m0, s60, 0x6000
    s_add_u32 s14, s61, 0x30000
    buffer_load_dwordx4 v14, s[16:19], s14 offen lds
    s_mov_b32 s40, s96
    s_mov_b32 s41, s97
    s_mov_b32 s42, 0x200000
    s_mov_b32 s43, 0x20000
    s_and_b32 s15, s2, 7
    s_lshl_b32 s15, s15, 3
    s_add_u32 s15, s15, s5
    s_lshl_b32 s72, s15, 7
    s_and_b32 s71, s15, 15
    s_lshl_b32 s71, s71, 2
    s_lshr_b32 s14, s15, 4
    s_lshl_b32 s14, s14, 8
    s_add_u32 s71, s71, s14
    s_lshr_b32 s14, s3, 2
    s_lshl_b32 s14, s14, 10
    s_add_u32 s71, s71, s14
    s_and_b32 s14, s3, 3
    s_add_u32 s71, s71, s14
    s_lshl_b32 s71, s71, 10
    s_add_u32 m0, s60, 0x24000
    s_add_u32 s14, s71, 0x0
    buffer_load_dwordx4 v92, s[40:43], s14 offen nt lds
    s_add_u32 s8, s12, 0x4800000
    s_addc_u32 s9, s13, 0
    s_mov_b32 s10, 0x8000
    s_mov_b32 s11, 0x20000
    s_load_dword s6, s[8:9], 0
    s_mov_b32 s48, s98
    s_mov_b32 s49, s99
    s_mov_b32 s50, 0x101000
    s_mov_b32 s51, 0x20000
    s_mov_b32 s52, s94
    s_mov_b32 s53, s95
    s_mov_b32 s54, 0x101000
    s_mov_b32 s55, 0x20000
    s_mov_b32 s20, s84
    s_mov_b32 s21, s85
    s_mov_b32 s22, 0x200000
    s_mov_b32 s23, 0x20000
    s_mov_b32 s32, s88
    s_mov_b32 s33, s89
    s_mov_b32 s34, 0x400000
    s_mov_b32 s35, 0x20000
    s_mov_b32 s36, s12
    s_mov_b32 s37, s13
    s_mov_b32 s38, 0x5000000
    s_mov_b32 s39, 0x20000
    s_add_u32 s44, s12, 0x4000000
    s_addc_u32 s45, s13, 0
    s_mov_b32 s46, 0x200000
    s_mov_b32 s47, 0x20000
    s_add_u32 s56, s12, 0x4400000
    s_addc_u32 s57, s13, 0
    s_mov_b32 s58, 0x202000
    s_mov_b32 s59, 0x20000
    s_lshr_b32 s74, s2, 1
    s_lshl_b32 s74, s74, 15
    s_and_b32 s14, s2, 1
    s_lshl_b32 s14, s14, 9
    s_add_u32 s74, s74, s14
    s_mov_b32 s78, 0x400000
    s_mov_b32 s79, 0x20000
    s_cmp_eq_u32 s3, 0
    s_cselect_b32 s7, 0, 0x40000000
    s_bfe_u32 s14, s2, 0x20003
    s_lshl_b32 s14, s14, 3
    s_add_u32 s14, s14, s3
    s_lshl_b32 s15, s14, 16
    s_add_u32 s72, s72, s15
    s_lshl_b32 s14, s14, 4
    v_and_b32 v88, 15, v1
    v_add_u32 v89, s14, v88
    v_lshrrev_b32 v90, 4, v1
    v_lshrrev_b32 v93, 3, v1
    v_lshlrev_b32 v93, 13, v93
    v_and_b32 v91, 7, v1
    v_lshl_add_u32 v93, v91, 4, v93
    v_lshrrev_b32 v84, 1, v89
    v_and_b32 v85, 1, v89
    v_cmp_eq_u32 vcc, 1, v89
    v_mov_b32 v91, 0x100
    s_nop 0
    v_cndmask_b32 v84, v84, v91, vcc
    v_cndmask_b32 v85, v85, 0, vcc
    v_cvt_f32_u32 v84, v84
    v_cvt_f32_u32 v85, v85
    v_mul_f32 v84, 0x3b000000, v84
    v_mul_f32 v85, 0x3e800000, v85
    v_lshlrev_b32 v91, 3, v90
    v_cvt_f32_u32 v91, v91
    v_fmac_f32 v85, v91, v84
    v_xor_b32 v89, v88, v90
    v_lshlrev_b32 v89, 4, v89
    v_lshl_add_u32 v89, v88, 8, v89
    v_add_u32 v86, 0x24000, v89
    s_bfe_u32 s14, s2, 0x20002
    s_lshl_b32 s14, s14, 3
    s_lshr_b32 s15, s2, 4
    s_lshl_b32 s67, s15, 7
    s_add_u32 s67, s67, s14
    s_mul_i32 s67, s67, 514
    s_lshl_b32 s15, s15, 5
    s_add_u32 s15, s15, s14
    s_lshl_b32 s69, s15, 4
    s_and_b32 s68, s2, 3
    s_lshl_b32 s14, s68, 3
    s_add_u32 s14, s14, s3
    s_cmp_eq_u32 s14, 24
    s_cselect_b32 s68, 0, 0x40000000
    s_add_u32 s70, s69, s68
    s_add_u32 s70, s70, 0x200000
    s_add_u32 s68, s68, s67
    s_add_u32 s68, s68, 512
    s_lshl_b32 s15, s14, 4
    s_add_u32 s67, s67, s15
    s_lshl_b32 s15, s14, 16
    s_add_u32 s69, s69, s15
    v_bfe_u32 v94, v1, 2, 2
    v_bfe_u32 v95, v1, 4, 1
    v_lshl_add_u32 v95, v95, 2, v94
    v_lshlrev_b32 v95, 5, v95
    v_lshl_add_u32 v95, v94, 8, v95
    v_lshrrev_b32 v94, 4, v1
    v_lshl_add_u32 v95, v94, 11, v95
    v_and_b32 v94, 3, v1
    v_lshl_add_u32 v95, v94, 3, v95
    v_add_u32 v0, 0x18000, v95
    s_and_b32 s15, s3, 3
    s_lshl_b32 s15, s15, 6
    v_xor_b32 v0, s15, v0
    v_xor_b32 v3, 32, v0
    s_lshr_b32 s14, s3, 2
    s_lshl_b32 s14, s14, 7
    v_and_b32 v94, 15, v1
    v_add_u32 v94, s14, v94
    v_lshlrev_b32 v94, 7, v94
    v_bfe_u32 v8, v1, 1, 3
    v_lshrrev_b32 v9, 4, v1
    v_xor_b32 v8, v8, v9
    v_lshl_add_u32 v6, v8, 4, v94
    v_xor_b32 v7, 64, v6
    v_add_u32 v8, 0x10000, v6
    v_add_u32 v9, 0x10000, v7
    s_lshl_b32 s65, s4, 5
    s_lshl_b32 s14, s5, 2
    s_add_u32 s65, s65, s14
    s_lshr_b32 s14, s3, 2
    s_lshl_b32 s14, s14, 1
    s_add_u32 s65, s65, s14
    s_lshl_b32 s65, s65, 15
    s_and_b32 s15, s3, 3
    s_lshl_b32 s15, s15, 10
    s_add_u32 s65, s65, s15
    s_add_u32 s66, s65, s15
    s_add_u32 s66, s66, 0x4000
    s_mov_b32 s73, 0x3e0293ee
    s_waitcnt lgkmcnt(0)
    s_add_u32 s6, s6, 1
    v_bfe_u32 v94, v1, 2, 3
    v_and_b32 v95, 3, v1
    v_lshl_add_u32 v94, v95, 5, v94
    v_mul_u32_u24 v94, 514, v94
    buffer_load_ushort v100, v94, s[48:51], s68 offen nt
    buffer_load_ushort v101, v94, s[52:55], s68 offen nt
    v_lshrrev_b32 v95, 5, v1
    v_lshl_add_u32 v94, v95, 3, v94
    buffer_load_dwordx2 v[96:97], v94, s[48:51], s67 offen nt
    buffer_load_dwordx2 v[98:99], v94, s[52:55], s67 offen nt
    s_waitcnt vmcnt(4) lgkmcnt(0)
    s_barrier
    ds_read_b64_tr_b16 v[16:17], v0 offset:0
    ds_read_b64_tr_b16 v[18:19], v0 offset:1024
    ds_read_b64_tr_b16 v[20:21], v3 offset:0
    ds_read_b64_tr_b16 v[22:23], v3 offset:1024
    ds_read_b64_tr_b16 v[24:25], v0 offset:8192
    ds_read_b64_tr_b16 v[26:27], v0 offset:9216
    ds_read_b64_tr_b16 v[28:29], v3 offset:8192
    ds_read_b64_tr_b16 v[30:31], v3 offset:9216
    ds_read_b128 v[48:51], v6 offset:0
    ds_read_b128 v[52:55], v6 offset:2048
    ds_read_b128 v[56:59], v6 offset:4096
    s_setprio 3
    s_waitcnt lgkmcnt(2)
    v_mfma_f32_16x16x32_bf16 v[128:131], v[16:19], v[48:51], 0
    ds_read_b128 v[60:63], v6 offset:6144
    v_mfma_f32_16x16x32_bf16 v[192:195], v[48:51], v[24:27], 0
    ds_read_b128 v[112:115], v6 offset:8192
    s_add_u32 m0, s60, 0x1c000
    s_add_u32 s14, s62, 0x40000
    buffer_load_dwordx4 v15, s[24:27], s14 offen nt lds
    v_xor_b32 v87, 0, v86
    ds_read_b128 v[64:67], v87 offset:0
    ds_read_b128 v[68:71], v87 offset:4096
    v_fmamk_f32 v88, v84, 0x00000000, v85
    v_mfma_f32_16x16x32_bf16 v[132:135], v[20:23], v[48:51], 0
    ds_read_b128 v[116:119], v6 offset:10240
    v_mfma_f32_16x16x32_bf16 v[200:203], v[48:51], v[28:31], 0
    ds_read_b128 v[120:123], v6 offset:12288
    s_add_u32 m0, s60, 0x1e000
    s_add_u32 s14, s62, 0x40000
    buffer_load_dwordx4 v15, s[28:31], s14 offen nt lds
    v_fmamk_f32 v89, v84, 0x3f800000, v85
    v_cos_f32 v88, v88
    v_cos_f32 v89, v89
    ds_read_b128 v[124:127], v6 offset:14336
    s_waitcnt lgkmcnt(8)
    v_mfma_f32_16x16x32_bf16 v[136:139], v[16:19], v[52:55], 0
    v_mfma_f32_16x16x32_bf16 v[196:199], v[52:55], v[24:27], 0
    s_add_u32 m0, s60, 0x8000
    s_add_u32 s14, s61, 0x80
    buffer_load_dwordx4 v14, s[16:19], s14 offen lds
    v_fmamk_f32 v90, v84, 0x40000000, v85
    v_fmamk_f32 v91, v84, 0x40400000, v85
    v_mfma_f32_16x16x32_bf16 v[140:143], v[20:23], v[52:55], 0
    v_mfma_f32_16x16x32_bf16 v[204:207], v[52:55], v[28:31], 0
    s_add_u32 m0, s60, 0xa000
    s_add_u32 s14, s61, 0x10080
    buffer_load_dwordx4 v14, s[16:19], s14 offen lds
    v_cvt_pk_bf16_f32 v72, v88, v89
    v_cos_f32 v90, v90
    v_cos_f32 v91, v91
    s_setprio 2
    s_waitcnt lgkmcnt(7)
    v_mfma_f32_16x16x32_bf16 v[144:147], v[16:19], v[56:59], 0
    v_mfma_f32_16x16x32_bf16 v[208:211], v[56:59], v[24:27], 0
    s_add_u32 m0, s60, 0xc000
    s_add_u32 s14, s61, 0x20080
    buffer_load_dwordx4 v14, s[16:19], s14 offen lds
    v_fmamk_f32 v88, v84, 0x40800000, v85
    s_add_u32 m0, s60, 0xe000
    s_add_u32 s14, s61, 0x30080
    buffer_load_dwordx4 v14, s[16:19], s14 offen lds
    v_fmamk_f32 v89, v84, 0x40a00000, v85
    v_cvt_pk_bf16_f32 v73, v90, v91
    v_mfma_f32_16x16x32_bf16 v[148:151], v[20:23], v[56:59], 0
    v_mfma_f32_16x16x32_bf16 v[216:219], v[56:59], v[28:31], 0
    v_cos_f32 v88, v88
    v_cos_f32 v89, v89
    s_waitcnt lgkmcnt(6)
    v_mfma_f32_16x16x32_bf16 v[152:155], v[16:19], v[60:63], 0
    v_mfma_f32_16x16x32_bf16 v[212:215], v[60:63], v[24:27], 0
    s_add_u32 m0, s60, 0x20000
    s_add_u32 s14, s62, 0x80000
    buffer_load_dwordx4 v15, s[24:27], s14 offen nt lds
    v_fmamk_f32 v90, v84, 0x40c00000, v85
    s_add_u32 m0, s60, 0x22000
    s_add_u32 s14, s62, 0x80000
    buffer_load_dwordx4 v15, s[28:31], s14 offen nt lds
    v_fmamk_f32 v91, v84, 0x40e00000, v85
    v_cvt_pk_bf16_f32 v74, v88, v89
    v_mfma_f32_16x16x32_bf16 v[156:159], v[20:23], v[60:63], 0
    v_mfma_f32_16x16x32_bf16 v[220:223], v[60:63], v[28:31], 0
    v_cos_f32 v90, v90
    s_setprio 1
    s_waitcnt lgkmcnt(5)
    v_mfma_f32_16x16x32_bf16 v[160:163], v[16:19], v[112:115], 0
    v_mfma_f32_16x16x32_bf16 v[224:227], v[112:115], v[24:27], 0
    v_cos_f32 v91, v91
    s_nop 0
    v_cvt_pk_bf16_f32 v75, v90, v91
    v_mfma_f32_16x16x32_bf16 v[164:167], v[20:23], v[112:115], 0
    v_mfma_f32_16x16x32_bf16 v[232:235], v[112:115], v[28:31], 0
    s_waitcnt lgkmcnt(3)
    v_mfma_f32_16x16x32_bf16 v[76:79], v[64:67], v[72:75], 0
    v_mfma_f32_16x16x32_bf16 v[80:83], v[68:71], v[72:75], 0
    s_waitcnt vmcnt(6) lgkmcnt(0)
    s_barrier
    s_setprio 3
    v_mfma_f32_16x16x32_bf16 v[168:171], v[16:19], v[116:119], 0
    ds_read_b64_tr_b16 v[32:33], v0 offset:16384
    v_mfma_f32_16x16x32_bf16 v[228:231], v[116:119], v[24:27], 0
    ds_read_b64_tr_b16 v[34:35], v0 offset:17408
    s_add_u32 m0, s60, 0x18000
    s_add_u32 s14, s62, 0xc0000
    buffer_load_dwordx4 v15, s[24:27], s14 offen nt lds
    v_xor_b32 v87, 64, v86
    ds_read_b128 v[64:67], v87 offset:0
    ds_read_b128 v[68:71], v87 offset:4096
    v_fmamk_f32 v88, v84, 0x42000000, v85
    v_mfma_f32_16x16x32_bf16 v[172:175], v[20:23], v[116:119], 0
    ds_read_b64_tr_b16 v[36:37], v3 offset:16384
    v_mfma_f32_16x16x32_bf16 v[236:239], v[116:119], v[28:31], 0
    ds_read_b64_tr_b16 v[38:39], v3 offset:17408
    v_fmamk_f32 v89, v84, 0x42040000, v85
    v_cos_f32 v88, v88
    ds_read_b64_tr_b16 v[40:41], v0 offset:24576
    v_mfma_f32_16x16x32_bf16 v[176:179], v[16:19], v[120:123], 0
    ds_read_b64_tr_b16 v[42:43], v0 offset:25600
    v_mfma_f32_16x16x32_bf16 v[240:243], v[120:123], v[24:27], 0
    ds_read_b64_tr_b16 v[44:45], v3 offset:24576
    s_add_u32 m0, s60, 0x1a000
    s_add_u32 s14, s62, 0xc0000
    buffer_load_dwordx4 v15, s[28:31], s14 offen nt lds
    v_cos_f32 v89, v89
    v_mfma_f32_16x16x32_bf16 v[180:183], v[20:23], v[120:123], 0
    ds_read_b64_tr_b16 v[46:47], v3 offset:25600
    v_mfma_f32_16x16x32_bf16 v[248:251], v[120:123], v[28:31], 0
    ds_read_b128 v[48:51], v7 offset:0
    v_fmamk_f32 v90, v84, 0x42080000, v85
    v_fmamk_f32 v91, v84, 0x420c0000, v85
    ds_read_b128 v[52:55], v7 offset:2048
    s_setprio 2
    v_mfma_f32_16x16x32_bf16 v[184:187], v[16:19], v[124:127], 0
    ds_read_b128 v[56:59], v7 offset:4096
    v_mfma_f32_16x16x32_bf16 v[244:247], v[124:127], v[24:27], 0
    ds_read_b128 v[60:63], v7 offset:6144
    s_add_u32 m0, s60, 0x10000
    s_add_u32 s14, s61, 0x100
    buffer_load_dwordx4 v14, s[16:19], s14 offen lds
    v_cvt_pk_bf16_f32 v72, v88, v89
    v_mfma_f32_16x16x32_bf16 v[188:191], v[20:23], v[124:127], 0
    ds_read_b128 v[112:115], v7 offset:8192
    v_mfma_f32_16x16x32_bf16 v[252:255], v[124:127], v[28:31], 0
    s_waitcnt lgkmcnt(9)
    ds_read_b128 v[116:119], v7 offset:10240
    v_cos_f32 v90, v90
    v_cos_f32 v91, v91
    ds_read_b128 v[120:123], v7 offset:12288
    s_waitcnt lgkmcnt(6)
    v_mfma_f32_16x16x32_bf16 v[128:131], v[32:35], v[48:51], v[128:131]
    v_mfma_f32_16x16x32_bf16 v[192:195], v[48:51], v[40:43], v[192:195]
    ds_read_b128 v[124:127], v7 offset:14336
    s_add_u32 m0, s60, 0x12000
    s_add_u32 s14, s61, 0x10100
    buffer_load_dwordx4 v14, s[16:19], s14 offen lds
    v_fmamk_f32 v88, v84, 0x42100000, v85
    v_mfma_f32_16x16x32_bf16 v[132:135], v[36:39], v[48:51], v[132:135]
    v_mfma_f32_16x16x32_bf16 v[200:203], v[48:51], v[44:47], v[200:203]
    v_fmamk_f32 v89, v84, 0x42140000, v85
    v_cvt_pk_bf16_f32 v73, v90, v91
    s_setprio 1
    s_waitcnt lgkmcnt(6)
    v_mfma_f32_16x16x32_bf16 v[136:139], v[32:35], v[52:55], v[136:139]
    v_mfma_f32_16x16x32_bf16 v[196:199], v[52:55], v[40:43], v[196:199]
    s_add_u32 m0, s60, 0x14000
    s_add_u32 s14, s61, 0x20100
    buffer_load_dwordx4 v14, s[16:19], s14 offen lds
    v_cos_f32 v88, v88
    v_cos_f32 v89, v89
    v_mfma_f32_16x16x32_bf16 v[140:143], v[36:39], v[52:55], v[140:143]
    v_mfma_f32_16x16x32_bf16 v[204:207], v[52:55], v[44:47], v[204:207]
    v_fmamk_f32 v90, v84, 0x42180000, v85
    s_waitcnt lgkmcnt(5)
    v_mfma_f32_16x16x32_bf16 v[144:147], v[32:35], v[56:59], v[144:147]
    v_mfma_f32_16x16x32_bf16 v[208:211], v[56:59], v[40:43], v[208:211]
    s_add_u32 m0, s60, 0x16000
    s_add_u32 s14, s61, 0x30100
    buffer_load_dwordx4 v14, s[16:19], s14 offen lds
    v_fmamk_f32 v91, v84, 0x421c0000, v85
    v_cvt_pk_bf16_f32 v74, v88, v89
    v_mfma_f32_16x16x32_bf16 v[148:151], v[36:39], v[56:59], v[148:151]
    v_mfma_f32_16x16x32_bf16 v[216:219], v[56:59], v[44:47], v[216:219]
    v_cos_f32 v90, v90
    s_setprio 0
    s_waitcnt lgkmcnt(4)
    v_mfma_f32_16x16x32_bf16 v[152:155], v[32:35], v[60:63], v[152:155]
    v_mfma_f32_16x16x32_bf16 v[212:215], v[60:63], v[40:43], v[212:215]
    v_cos_f32 v91, v91
    s_nop 0
    v_cvt_pk_bf16_f32 v75, v90, v91
    v_mfma_f32_16x16x32_bf16 v[156:159], v[36:39], v[60:63], v[156:159]
    v_mfma_f32_16x16x32_bf16 v[220:223], v[60:63], v[44:47], v[220:223]
    s_waitcnt lgkmcnt(3)
    v_mfma_f32_16x16x32_bf16 v[160:163], v[32:35], v[112:115], v[160:163]
    v_mfma_f32_16x16x32_bf16 v[224:227], v[112:115], v[40:43], v[224:227]
    v_mfma_f32_16x16x32_bf16 v[164:167], v[36:39], v[112:115], v[164:167]
    v_mfma_f32_16x16x32_bf16 v[232:235], v[112:115], v[44:47], v[232:235]
    v_mfma_f32_16x16x32_bf16 v[76:79], v[64:67], v[72:75], v[76:79]
    v_mfma_f32_16x16x32_bf16 v[80:83], v[68:71], v[72:75], v[80:83]
    s_mov_b32 s14, 0x05040100
    s_mov_b32 s15, 0x07060302
    v_perm_b32 v104, v98, v96, s14
    v_perm_b32 v105, v98, v96, s15
    v_perm_b32 v106, v99, v97, s14
    v_perm_b32 v107, v99, v97, s15
    v_lshl_or_b32 v100, v101, 16, v100
    v_and_b32 v94, 31, v1
    v_lshlrev_b32 v94, 2, v94
    v_lshrrev_b32 v95, 5, v1
    v_lshl_add_u32 v101, v95, 30, v94
    v_lshl_add_u32 v94, v95, 9, v94
    s_add_u32 s14, s60, 0x26000
    v_add_u32 v94, s14, v94
    v_add_u32 v95, s14, v2
    ds_write_b32 v94, v104 offset:0
    ds_write_b32 v94, v105 offset:128
    ds_write_b32 v94, v106 offset:256
    ds_write_b32 v94, v107 offset:384
    ds_read_b128 v[96:99], v95
    s_waitcnt vmcnt(6) lgkmcnt(0)
    s_barrier
    s_setprio 3
    v_mfma_f32_16x16x32_bf16 v[168:171], v[32:35], v[116:119], v[168:171]
    ds_read_b64_tr_b16 v[16:17], v0 offset:32768
    v_mfma_f32_16x16x32_bf16 v[228:231], v[116:119], v[40:43], v[228:231]
    ds_read_b64_tr_b16 v[18:19], v0 offset:33792
    s_add_u32 m0, s60, 0x26000
    s_add_u32 s14, s71, 0x100
    buffer_load_dwordx4 v92, s[40:43], s14 offen nt lds
    v_xor_b32 v87, 128, v86
    ds_read_b128 v[64:67], v87 offset:0
    ds_read_b128 v[68:71], v87 offset:4096
    v_fmamk_f32 v88, v84, 0x42800000, v85
    v_mfma_f32_16x16x32_bf16 v[172:175], v[36:39], v[116:119], v[172:175]
    ds_read_b64_tr_b16 v[20:21], v3 offset:32768
    v_mfma_f32_16x16x32_bf16 v[236:239], v[116:119], v[44:47], v[236:239]
    ds_read_b64_tr_b16 v[22:23], v3 offset:33792
    v_fmamk_f32 v89, v84, 0x42820000, v85
    v_cos_f32 v88, v88
    ds_read_b64_tr_b16 v[24:25], v0 offset:40960
    v_mfma_f32_16x16x32_bf16 v[176:179], v[32:35], v[120:123], v[176:179]
    ds_read_b64_tr_b16 v[26:27], v0 offset:41984
    v_mfma_f32_16x16x32_bf16 v[240:243], v[120:123], v[40:43], v[240:243]
    ds_read_b64_tr_b16 v[28:29], v3 offset:40960
    s_add_u32 m0, s60, 0x1c000
    s_add_u32 s14, s62, 0x100000
    buffer_load_dwordx4 v15, s[24:27], s14 offen nt lds
    v_cos_f32 v89, v89
    v_mfma_f32_16x16x32_bf16 v[180:183], v[36:39], v[120:123], v[180:183]
    ds_read_b64_tr_b16 v[30:31], v3 offset:41984
    v_mfma_f32_16x16x32_bf16 v[248:251], v[120:123], v[44:47], v[248:251]
    ds_read_b128 v[48:51], v6 offset:32768
    v_fmamk_f32 v90, v84, 0x42840000, v85
    v_fmamk_f32 v91, v84, 0x42860000, v85
    ds_read_b128 v[52:55], v6 offset:34816
    s_setprio 2
    v_mfma_f32_16x16x32_bf16 v[184:187], v[32:35], v[124:127], v[184:187]
    ds_read_b128 v[56:59], v6 offset:36864
    v_mfma_f32_16x16x32_bf16 v[244:247], v[124:127], v[40:43], v[244:247]
    ds_read_b128 v[60:63], v6 offset:38912
    s_add_u32 m0, s60, 0x1e000
    s_add_u32 s14, s62, 0x100000
    buffer_load_dwordx4 v15, s[28:31], s14 offen nt lds
    v_cvt_pk_bf16_f32 v72, v88, v89
    v_mfma_f32_16x16x32_bf16 v[188:191], v[36:39], v[124:127], v[188:191]
    ds_read_b128 v[112:115], v6 offset:40960
    v_mfma_f32_16x16x32_bf16 v[252:255], v[124:127], v[44:47], v[252:255]
    s_waitcnt lgkmcnt(9)
    ds_read_b128 v[116:119], v6 offset:43008
    v_cos_f32 v90, v90
    v_cos_f32 v91, v91
    ds_read_b128 v[120:123], v6 offset:45056
    s_waitcnt lgkmcnt(6)
    v_mfma_f32_16x16x32_bf16 v[128:131], v[16:19], v[48:51], v[128:131]
    v_mfma_f32_16x16x32_bf16 v[192:195], v[48:51], v[24:27], v[192:195]
    ds_read_b128 v[124:127], v6 offset:47104
    v_fmamk_f32 v88, v84, 0x42880000, v85
    v_mfma_f32_16x16x32_bf16 v[132:135], v[20:23], v[48:51], v[132:135]
    v_mfma_f32_16x16x32_bf16 v[200:203], v[48:51], v[28:31], v[200:203]
    s_add_u32 m0, s60, 0x0
    s_add_u32 s14, s61, 0x180
    buffer_load_dwordx4 v14, s[16:19], s14 offen lds
    v_fmamk_f32 v89, v84, 0x428a0000, v85
    v_cvt_pk_bf16_f32 v73, v90, v91
    s_setprio 1
    s_waitcnt lgkmcnt(6)
    v_mfma_f32_16x16x32_bf16 v[136:139], v[16:19], v[52:55], v[136:139]
    v_mfma_f32_16x16x32_bf16 v[196:199], v[52:55], v[24:27], v[196:199]
    v_cos_f32 v88, v88
    v_cos_f32 v89, v89
    v_mfma_f32_16x16x32_bf16 v[140:143], v[20:23], v[52:55], v[140:143]
    v_mfma_f32_16x16x32_bf16 v[204:207], v[52:55], v[28:31], v[204:207]
    s_add_u32 m0, s60, 0x2000
    s_add_u32 s14, s61, 0x10180
    buffer_load_dwordx4 v14, s[16:19], s14 offen lds
    v_fmamk_f32 v90, v84, 0x428c0000, v85
    s_waitcnt lgkmcnt(5)
    v_mfma_f32_16x16x32_bf16 v[144:147], v[16:19], v[56:59], v[144:147]
    v_mfma_f32_16x16x32_bf16 v[208:211], v[56:59], v[24:27], v[208:211]
    v_fmamk_f32 v91, v84, 0x428e0000, v85
    v_cvt_pk_bf16_f32 v74, v88, v89
    v_mfma_f32_16x16x32_bf16 v[148:151], v[20:23], v[56:59], v[148:151]
    v_mfma_f32_16x16x32_bf16 v[216:219], v[56:59], v[28:31], v[216:219]
    v_cos_f32 v90, v90
    s_setprio 0
    s_waitcnt lgkmcnt(4)
    v_mfma_f32_16x16x32_bf16 v[152:155], v[16:19], v[60:63], v[152:155]
    v_mfma_f32_16x16x32_bf16 v[212:215], v[60:63], v[24:27], v[212:215]
    v_cos_f32 v91, v91
    s_nop 0
    v_cvt_pk_bf16_f32 v75, v90, v91
    v_mfma_f32_16x16x32_bf16 v[156:159], v[20:23], v[60:63], v[156:159]
    v_mfma_f32_16x16x32_bf16 v[220:223], v[60:63], v[28:31], v[220:223]
    s_waitcnt lgkmcnt(3)
    v_mfma_f32_16x16x32_bf16 v[160:163], v[16:19], v[112:115], v[160:163]
    v_mfma_f32_16x16x32_bf16 v[224:227], v[112:115], v[24:27], v[224:227]
    v_mfma_f32_16x16x32_bf16 v[164:167], v[20:23], v[112:115], v[164:167]
    v_mfma_f32_16x16x32_bf16 v[232:235], v[112:115], v[28:31], v[232:235]
    buffer_store_dwordx4 v[96:99], v93, s[56:59], s69 offen sc1
    buffer_store_dword v100, v101, s[56:59], s70 offen sc1
    v_mfma_f32_16x16x32_bf16 v[76:79], v[64:67], v[72:75], v[76:79]
    v_mfma_f32_16x16x32_bf16 v[80:83], v[68:71], v[72:75], v[80:83]
    s_waitcnt vmcnt(11) lgkmcnt(0)
    s_barrier
    s_setprio 3
    v_mfma_f32_16x16x32_bf16 v[168:171], v[16:19], v[116:119], v[168:171]
    ds_read_b64_tr_b16 v[32:33], v0 offset:0
    v_mfma_f32_16x16x32_bf16 v[228:231], v[116:119], v[24:27], v[228:231]
    ds_read_b64_tr_b16 v[34:35], v0 offset:1024
    s_add_u32 m0, s60, 0x20000
    s_add_u32 s14, s62, 0x140000
    buffer_load_dwordx4 v15, s[24:27], s14 offen nt lds
    v_xor_b32 v87, 192, v86
    ds_read_b128 v[64:67], v87 offset:0
    ds_read_b128 v[68:71], v87 offset:4096
    v_mul_f32 v12, 0x42000000, v84
    v_cos_f32 v12, v12
    v_mfma_f32_16x16x32_bf16 v[172:175], v[20:23], v[116:119], v[172:175]
    ds_read_b64_tr_b16 v[36:37], v3 offset:0
    v_mfma_f32_16x16x32_bf16 v[236:239], v[116:119], v[28:31], v[236:239]
    ds_read_b64_tr_b16 v[38:39], v3 offset:1024
    v_add_f32 v12, v12, v12
    ds_read_b64_tr_b16 v[40:41], v0 offset:8192
    v_mfma_f32_16x16x32_bf16 v[176:179], v[16:19], v[120:123], v[176:179]
    ds_read_b64_tr_b16 v[42:43], v0 offset:9216
    v_mfma_f32_16x16x32_bf16 v[240:243], v[120:123], v[24:27], v[240:243]
    ds_read_b64_tr_b16 v[44:45], v3 offset:8192
    v_fmamk_f32 v96, v84, 0x42c00000, v85
    v_fmamk_f32 v97, v84, 0x42c20000, v85
    v_mfma_f32_16x16x32_bf16 v[180:183], v[20:23], v[120:123], v[180:183]
    ds_read_b64_tr_b16 v[46:47], v3 offset:9216
    v_mfma_f32_16x16x32_bf16 v[248:251], v[120:123], v[28:31], v[248:251]
    ds_read_b128 v[48:51], v7 offset:32768
    s_add_u32 m0, s60, 0x22000
    s_add_u32 s14, s62, 0x140000
    buffer_load_dwordx4 v15, s[28:31], s14 offen nt lds
    v_cos_f32 v96, v96
    ds_read_b128 v[52:55], v7 offset:34816
    s_setprio 2
    v_mfma_f32_16x16x32_bf16 v[184:187], v[16:19], v[124:127], v[184:187]
    ds_read_b128 v[56:59], v7 offset:36864
    v_mfma_f32_16x16x32_bf16 v[244:247], v[124:127], v[24:27], v[244:247]
    ds_read_b128 v[60:63], v7 offset:38912
    v_cos_f32 v97, v97
    v_fmamk_f32 v98, v84, 0x42c40000, v85
    v_mfma_f32_16x16x32_bf16 v[188:191], v[20:23], v[124:127], v[188:191]
    ds_read_b128 v[112:115], v7 offset:40960
    v_mfma_f32_16x16x32_bf16 v[252:255], v[124:127], v[28:31], v[252:255]
    s_waitcnt lgkmcnt(9)
    ds_read_b128 v[116:119], v7 offset:43008
    v_fmamk_f32 v99, v84, 0x42c60000, v85
    v_cvt_pk_bf16_f32 v72, v96, v97
    ds_read_b128 v[120:123], v7 offset:45056
    s_waitcnt lgkmcnt(6)
    v_mfma_f32_16x16x32_bf16 v[128:131], v[32:35], v[48:51], v[128:131]
    v_mfma_f32_16x16x32_bf16 v[192:195], v[48:51], v[40:43], v[192:195]
    ds_read_b128 v[124:127], v7 offset:47104
    s_add_u32 m0, s60, 0x4000
    s_add_u32 s14, s61, 0x20180
    buffer_load_dwordx4 v14, s[16:19], s14 offen lds
    v_cos_f32 v98, v98
    v_cos_f32 v99, v99
    v_mfma_f32_16x16x32_bf16 v[132:135], v[36:39], v[48:51], v[132:135]
    v_mfma_f32_16x16x32_bf16 v[200:203], v[48:51], v[44:47], v[200:203]
    v_fmamk_f32 v100, v84, 0x42c80000, v85
    s_setprio 1
    s_waitcnt lgkmcnt(6)
    v_mfma_f32_16x16x32_bf16 v[136:139], v[32:35], v[52:55], v[136:139]
    v_mfma_f32_16x16x32_bf16 v[196:199], v[52:55], v[40:43], v[196:199]
    v_fmamk_f32 v101, v84, 0x42ca0000, v85
    v_cvt_pk_bf16_f32 v73, v98, v99
    v_mfma_f32_16x16x32_bf16 v[140:143], v[36:39], v[52:55], v[140:143]
    v_mfma_f32_16x16x32_bf16 v[204:207], v[52:55], v[44:47], v[204:207]
    s_add_u32 m0, s60, 0x6000
    s_add_u32 s14, s61, 0x30180
    buffer_load_dwordx4 v14, s[16:19], s14 offen lds
    v_cos_f32 v100, v100
    v_cos_f32 v101, v101
    s_waitcnt lgkmcnt(5)
    v_mfma_f32_16x16x32_bf16 v[144:147], v[32:35], v[56:59], v[144:147]
    v_mfma_f32_16x16x32_bf16 v[208:211], v[56:59], v[40:43], v[208:211]
    v_fmamk_f32 v102, v84, 0x42cc0000, v85
    v_fmamk_f32 v103, v84, 0x42ce0000, v85
    v_mfma_f32_16x16x32_bf16 v[148:151], v[36:39], v[56:59], v[148:151]
    v_mfma_f32_16x16x32_bf16 v[216:219], v[56:59], v[44:47], v[216:219]
    v_cvt_pk_bf16_f32 v74, v100, v101
    s_setprio 0
    s_waitcnt lgkmcnt(4)
    v_mfma_f32_16x16x32_bf16 v[152:155], v[32:35], v[60:63], v[152:155]
    v_mfma_f32_16x16x32_bf16 v[212:215], v[60:63], v[40:43], v[212:215]
    v_cos_f32 v102, v102
    v_cos_f32 v103, v103
    v_mfma_f32_16x16x32_bf16 v[156:159], v[36:39], v[60:63], v[156:159]
    v_mfma_f32_16x16x32_bf16 v[220:223], v[60:63], v[44:47], v[220:223]
    v_cvt_pk_bf16_f32 v75, v102, v103
    s_waitcnt lgkmcnt(3)
    v_mfma_f32_16x16x32_bf16 v[160:163], v[32:35], v[112:115], v[160:163]
    v_mfma_f32_16x16x32_bf16 v[224:227], v[112:115], v[40:43], v[224:227]
    v_mfma_f32_16x16x32_bf16 v[164:167], v[36:39], v[112:115], v[164:167]
    v_mfma_f32_16x16x32_bf16 v[232:235], v[112:115], v[44:47], v[232:235]
    v_mfma_f32_16x16x32_bf16 v[76:79], v[64:67], v[72:75], v[76:79]
    v_mfma_f32_16x16x32_bf16 v[80:83], v[68:71], v[72:75], v[80:83]
    s_waitcnt vmcnt(8) lgkmcnt(0)
    s_barrier
    s_setprio 3
    v_mfma_f32_16x16x32_bf16 v[168:171], v[32:35], v[116:119], v[168:171]
    ds_read_b64_tr_b16 v[16:17], v0 offset:16384
    v_mfma_f32_16x16x32_bf16 v[228:231], v[116:119], v[40:43], v[228:231]
    ds_read_b64_tr_b16 v[18:19], v0 offset:17408
    s_add_u32 m0, s60, 0x24000
    s_add_u32 s14, s71, 0x200
    buffer_load_dwordx4 v92, s[40:43], s14 offen nt lds
    v_xor_b32 v87, 0, v86
    ds_read_b128 v[64:67], v87 offset:8192
    ds_read_b128 v[68:71], v87 offset:12288
    v_fmamk_f32 v104, v84, 0x43000000, v85
    v_mfma_f32_16x16x32_bf16 v[172:175], v[36:39], v[116:119], v[172:175]
    ds_read_b64_tr_b16 v[20:21], v3 offset:16384
    v_mfma_f32_16x16x32_bf16 v[236:239], v[116:119], v[44:47], v[236:239]
    ds_read_b64_tr_b16 v[22:23], v3 offset:17408
    v_fmamk_f32 v105, v84, 0x43010000, v85
    v_cos_f32 v104, v104
    ds_read_b64_tr_b16 v[24:25], v0 offset:24576
    v_mfma_f32_16x16x32_bf16 v[176:179], v[32:35], v[120:123], v[176:179]
    ds_read_b64_tr_b16 v[26:27], v0 offset:25600
    v_mfma_f32_16x16x32_bf16 v[240:243], v[120:123], v[40:43], v[240:243]
    ds_read_b64_tr_b16 v[28:29], v3 offset:24576
    s_add_u32 m0, s60, 0x18000
    s_add_u32 s14, s62, 0x180000
    buffer_load_dwordx4 v15, s[24:27], s14 offen nt lds
    v_cos_f32 v105, v105
    v_mfma_f32_16x16x32_bf16 v[180:183], v[36:39], v[120:123], v[180:183]
    ds_read_b64_tr_b16 v[30:31], v3 offset:25600
    v_mfma_f32_16x16x32_bf16 v[248:251], v[120:123], v[44:47], v[248:251]
    ds_read_b128 v[48:51], v8 offset:0
    v_fmamk_f32 v106, v84, 0x43020000, v85
    v_fmamk_f32 v107, v84, 0x43030000, v85
    ds_read_b128 v[52:55], v8 offset:2048
    s_setprio 2
    v_mfma_f32_16x16x32_bf16 v[184:187], v[32:35], v[124:127], v[184:187]
    ds_read_b128 v[56:59], v8 offset:4096
    v_mfma_f32_16x16x32_bf16 v[244:247], v[124:127], v[40:43], v[244:247]
    ds_read_b128 v[60:63], v8 offset:6144
    s_add_u32 m0, s60, 0x1a000
    s_add_u32 s14, s62, 0x180000
    buffer_load_dwordx4 v15, s[28:31], s14 offen nt lds
    v_cvt_pk_bf16_f32 v72, v104, v105
    v_mfma_f32_16x16x32_bf16 v[188:191], v[36:39], v[124:127], v[188:191]
    ds_read_b128 v[112:115], v8 offset:8192
    v_mfma_f32_16x16x32_bf16 v[252:255], v[124:127], v[44:47], v[252:255]
    s_waitcnt lgkmcnt(9)
    ds_read_b128 v[116:119], v8 offset:10240
    v_cos_f32 v106, v106
    v_cos_f32 v107, v107
    ds_read_b128 v[120:123], v8 offset:12288
    s_waitcnt lgkmcnt(6)
    v_mfma_f32_16x16x32_bf16 v[128:131], v[16:19], v[48:51], v[128:131]
    v_mfma_f32_16x16x32_bf16 v[192:195], v[48:51], v[24:27], v[192:195]
    ds_read_b128 v[124:127], v8 offset:14336
    v_fmamk_f32 v108, v84, 0x43040000, v85
    v_mfma_f32_16x16x32_bf16 v[132:135], v[20:23], v[48:51], v[132:135]
    v_mfma_f32_16x16x32_bf16 v[200:203], v[48:51], v[28:31], v[200:203]
    s_add_u32 m0, s60, 0x8000
    s_add_u32 s14, s61, 0x200
    buffer_load_dwordx4 v14, s[16:19], s14 offen lds
    v_fmamk_f32 v109, v84, 0x43050000, v85
    v_cvt_pk_bf16_f32 v73, v106, v107
    s_setprio 1
    s_waitcnt lgkmcnt(6)
    v_mfma_f32_16x16x32_bf16 v[136:139], v[16:19], v[52:55], v[136:139]
    v_mfma_f32_16x16x32_bf16 v[196:199], v[52:55], v[24:27], v[196:199]
    v_cos_f32 v108, v108
    v_cos_f32 v109, v109
    v_mfma_f32_16x16x32_bf16 v[140:143], v[20:23], v[52:55], v[140:143]
    v_mfma_f32_16x16x32_bf16 v[204:207], v[52:55], v[28:31], v[204:207]
    s_add_u32 m0, s60, 0xa000
    s_add_u32 s14, s61, 0x10200
    buffer_load_dwordx4 v14, s[16:19], s14 offen lds
    v_fmamk_f32 v110, v84, 0x43060000, v85
    s_waitcnt lgkmcnt(5)
    v_mfma_f32_16x16x32_bf16 v[144:147], v[16:19], v[56:59], v[144:147]
    v_mfma_f32_16x16x32_bf16 v[208:211], v[56:59], v[24:27], v[208:211]
    v_fmamk_f32 v111, v84, 0x43070000, v85
    v_cvt_pk_bf16_f32 v74, v108, v109
    v_mfma_f32_16x16x32_bf16 v[148:151], v[20:23], v[56:59], v[148:151]
    v_mfma_f32_16x16x32_bf16 v[216:219], v[56:59], v[28:31], v[216:219]
    v_cos_f32 v110, v110
    s_setprio 0
    s_waitcnt lgkmcnt(4)
    v_mfma_f32_16x16x32_bf16 v[152:155], v[16:19], v[60:63], v[152:155]
    v_mfma_f32_16x16x32_bf16 v[212:215], v[60:63], v[24:27], v[212:215]
    v_cos_f32 v111, v111
    s_nop 0
    v_cvt_pk_bf16_f32 v75, v110, v111
    v_mfma_f32_16x16x32_bf16 v[156:159], v[20:23], v[60:63], v[156:159]
    v_mfma_f32_16x16x32_bf16 v[220:223], v[60:63], v[28:31], v[220:223]
    s_waitcnt lgkmcnt(3)
    v_mfma_f32_16x16x32_bf16 v[160:163], v[16:19], v[112:115], v[160:163]
    v_mfma_f32_16x16x32_bf16 v[224:227], v[112:115], v[24:27], v[224:227]
    v_mfma_f32_16x16x32_bf16 v[164:167], v[20:23], v[112:115], v[164:167]
    v_mfma_f32_16x16x32_bf16 v[232:235], v[112:115], v[28:31], v[232:235]
    v_mfma_f32_16x16x32_bf16 v[76:79], v[64:67], v[72:75], v[76:79]
    v_mfma_f32_16x16x32_bf16 v[80:83], v[68:71], v[72:75], v[80:83]
    s_waitcnt vmcnt(7) lgkmcnt(0)
    s_barrier
    s_setprio 3
    v_mfma_f32_16x16x32_bf16 v[168:171], v[16:19], v[116:119], v[168:171]
    ds_read_b64_tr_b16 v[32:33], v0 offset:32768
    v_mfma_f32_16x16x32_bf16 v[228:231], v[116:119], v[24:27], v[228:231]
    ds_read_b64_tr_b16 v[34:35], v0 offset:33792
    s_add_u32 m0, s60, 0x1c000
    s_add_u32 s14, s62, 0x1c0000
    buffer_load_dwordx4 v15, s[24:27], s14 offen nt lds
    v_xor_b32 v87, 64, v86
    ds_read_b128 v[64:67], v87 offset:8192
    ds_read_b128 v[68:71], v87 offset:12288
    v_mfma_f32_16x16x32_bf16 v[172:175], v[20:23], v[116:119], v[172:175]
    ds_read_b64_tr_b16 v[36:37], v3 offset:32768
    v_mfma_f32_16x16x32_bf16 v[236:239], v[116:119], v[28:31], v[236:239]
    ds_read_b64_tr_b16 v[38:39], v3 offset:33792
    v_fma_f32 v96, v12, v104, -v96
    ds_read_b64_tr_b16 v[40:41], v0 offset:40960
    v_mfma_f32_16x16x32_bf16 v[176:179], v[16:19], v[120:123], v[176:179]
    ds_read_b64_tr_b16 v[42:43], v0 offset:41984
    v_mfma_f32_16x16x32_bf16 v[240:243], v[120:123], v[24:27], v[240:243]
    ds_read_b64_tr_b16 v[44:45], v3 offset:40960
    v_fma_f32 v97, v12, v105, -v97
    v_mfma_f32_16x16x32_bf16 v[180:183], v[20:23], v[120:123], v[180:183]
    ds_read_b64_tr_b16 v[46:47], v3 offset:41984
    v_mfma_f32_16x16x32_bf16 v[248:251], v[120:123], v[28:31], v[248:251]
    ds_read_b128 v[48:51], v9 offset:0
    s_add_u32 m0, s60, 0x1e000
    s_add_u32 s14, s62, 0x1c0000
    buffer_load_dwordx4 v15, s[28:31], s14 offen nt lds
    v_fma_f32 v98, v12, v106, -v98
    ds_read_b128 v[52:55], v9 offset:2048
    s_setprio 2
    v_mfma_f32_16x16x32_bf16 v[184:187], v[16:19], v[124:127], v[184:187]
    ds_read_b128 v[56:59], v9 offset:4096
    v_mfma_f32_16x16x32_bf16 v[244:247], v[124:127], v[24:27], v[244:247]
    ds_read_b128 v[60:63], v9 offset:6144
    v_fma_f32 v99, v12, v107, -v99
    v_mfma_f32_16x16x32_bf16 v[188:191], v[20:23], v[124:127], v[188:191]
    ds_read_b128 v[112:115], v9 offset:8192
    v_mfma_f32_16x16x32_bf16 v[252:255], v[124:127], v[28:31], v[252:255]
    s_waitcnt lgkmcnt(9)
    ds_read_b128 v[116:119], v9 offset:10240
    v_fma_f32 v100, v12, v108, -v100
    ds_read_b128 v[120:123], v9 offset:12288
    s_waitcnt lgkmcnt(6)
    v_mfma_f32_16x16x32_bf16 v[128:131], v[32:35], v[48:51], v[128:131]
    v_mfma_f32_16x16x32_bf16 v[192:195], v[48:51], v[40:43], v[192:195]
    ds_read_b128 v[124:127], v9 offset:14336
    s_add_u32 m0, s60, 0xc000
    s_add_u32 s14, s61, 0x20200
    buffer_load_dwordx4 v14, s[16:19], s14 offen lds
    v_fma_f32 v101, v12, v109, -v101
    v_mfma_f32_16x16x32_bf16 v[132:135], v[36:39], v[48:51], v[132:135]
    v_mfma_f32_16x16x32_bf16 v[200:203], v[48:51], v[44:47], v[200:203]
    v_fma_f32 v102, v12, v110, -v102
    s_setprio 1
    s_waitcnt lgkmcnt(6)
    v_mfma_f32_16x16x32_bf16 v[136:139], v[32:35], v[52:55], v[136:139]
    v_mfma_f32_16x16x32_bf16 v[196:199], v[52:55], v[40:43], v[196:199]
    v_fma_f32 v103, v12, v111, -v103
    v_mfma_f32_16x16x32_bf16 v[140:143], v[36:39], v[52:55], v[140:143]
    v_mfma_f32_16x16x32_bf16 v[204:207], v[52:55], v[44:47], v[204:207]
    s_add_u32 m0, s60, 0xe000
    s_add_u32 s14, s61, 0x30200
    buffer_load_dwordx4 v14, s[16:19], s14 offen lds
    v_cvt_pk_bf16_f32 v72, v96, v97
    s_waitcnt lgkmcnt(5)
    v_mfma_f32_16x16x32_bf16 v[144:147], v[32:35], v[56:59], v[144:147]
    v_mfma_f32_16x16x32_bf16 v[208:211], v[56:59], v[40:43], v[208:211]
    v_cvt_pk_bf16_f32 v73, v98, v99
    v_mfma_f32_16x16x32_bf16 v[148:151], v[36:39], v[56:59], v[148:151]
    v_mfma_f32_16x16x32_bf16 v[216:219], v[56:59], v[44:47], v[216:219]
    v_cvt_pk_bf16_f32 v74, v100, v101
    s_setprio 0
    s_waitcnt lgkmcnt(4)
    v_mfma_f32_16x16x32_bf16 v[152:155], v[32:35], v[60:63], v[152:155]
    v_mfma_f32_16x16x32_bf16 v[212:215], v[60:63], v[40:43], v[212:215]
    v_cvt_pk_bf16_f32 v75, v102, v103
    v_mfma_f32_16x16x32_bf16 v[156:159], v[36:39], v[60:63], v[156:159]
    v_mfma_f32_16x16x32_bf16 v[220:223], v[60:63], v[44:47], v[220:223]
    s_waitcnt lgkmcnt(3)
    v_mfma_f32_16x16x32_bf16 v[160:163], v[32:35], v[112:115], v[160:163]
    v_mfma_f32_16x16x32_bf16 v[224:227], v[112:115], v[40:43], v[224:227]
    v_mfma_f32_16x16x32_bf16 v[164:167], v[36:39], v[112:115], v[164:167]
    v_mfma_f32_16x16x32_bf16 v[232:235], v[112:115], v[44:47], v[232:235]
    v_mfma_f32_16x16x32_bf16 v[76:79], v[64:67], v[72:75], v[76:79]
    v_mfma_f32_16x16x32_bf16 v[80:83], v[68:71], v[72:75], v[80:83]
    s_waitcnt vmcnt(6) lgkmcnt(0)
    s_barrier
    s_setprio 3
    v_mfma_f32_16x16x32_bf16 v[168:171], v[32:35], v[116:119], v[168:171]
    ds_read_b64_tr_b16 v[16:17], v0 offset:0
    v_mfma_f32_16x16x32_bf16 v[228:231], v[116:119], v[40:43], v[228:231]
    ds_read_b64_tr_b16 v[18:19], v0 offset:1024
    s_add_u32 m0, s60, 0x20000
    s_add_u32 s14, s62, 0x200000
    buffer_load_dwordx4 v15, s[24:27], s14 offen nt lds
    v_xor_b32 v87, 128, v86
    ds_read_b128 v[64:67], v87 offset:8192
    ds_read_b128 v[68:71], v87 offset:12288
    v_mfma_f32_16x16x32_bf16 v[172:175], v[36:39], v[116:119], v[172:175]
    ds_read_b64_tr_b16 v[20:21], v3 offset:0
    v_mfma_f32_16x16x32_bf16 v[236:239], v[116:119], v[44:47], v[236:239]
    ds_read_b64_tr_b16 v[22:23], v3 offset:1024
    v_fma_f32 v104, v12, v96, -v104
    ds_read_b64_tr_b16 v[24:25], v0 offset:8192
    v_mfma_f32_16x16x32_bf16 v[176:179], v[32:35], v[120:123], v[176:179]
    ds_read_b64_tr_b16 v[26:27], v0 offset:9216
    v_mfma_f32_16x16x32_bf16 v[240:243], v[120:123], v[40:43], v[240:243]
    ds_read_b64_tr_b16 v[28:29], v3 offset:8192
    v_fma_f32 v105, v12, v97, -v105
    v_mfma_f32_16x16x32_bf16 v[180:183], v[36:39], v[120:123], v[180:183]
    ds_read_b64_tr_b16 v[30:31], v3 offset:9216
    v_mfma_f32_16x16x32_bf16 v[248:251], v[120:123], v[44:47], v[248:251]
    ds_read_b128 v[48:51], v6 offset:0
    s_add_u32 m0, s60, 0x22000
    s_add_u32 s14, s62, 0x200000
    buffer_load_dwordx4 v15, s[28:31], s14 offen nt lds
    v_fma_f32 v106, v12, v98, -v106
    ds_read_b128 v[52:55], v6 offset:2048
    s_setprio 2
    v_mfma_f32_16x16x32_bf16 v[184:187], v[32:35], v[124:127], v[184:187]
    ds_read_b128 v[56:59], v6 offset:4096
    v_mfma_f32_16x16x32_bf16 v[244:247], v[124:127], v[40:43], v[244:247]
    ds_read_b128 v[60:63], v6 offset:6144
    v_fma_f32 v107, v12, v99, -v107
    v_mfma_f32_16x16x32_bf16 v[188:191], v[36:39], v[124:127], v[188:191]
    ds_read_b128 v[112:115], v6 offset:8192
    v_mfma_f32_16x16x32_bf16 v[252:255], v[124:127], v[44:47], v[252:255]
    s_waitcnt lgkmcnt(9)
    ds_read_b128 v[116:119], v6 offset:10240
    v_fma_f32 v108, v12, v100, -v108
    ds_read_b128 v[120:123], v6 offset:12288
    s_waitcnt lgkmcnt(6)
    v_mfma_f32_16x16x32_bf16 v[128:131], v[16:19], v[48:51], v[128:131]
    v_mfma_f32_16x16x32_bf16 v[192:195], v[48:51], v[24:27], v[192:195]
    ds_read_b128 v[124:127], v6 offset:14336
    s_add_u32 m0, s60, 0x10000
    s_add_u32 s14, s61, 0x280
    buffer_load_dwordx4 v14, s[16:19], s14 offen lds
    v_fma_f32 v109, v12, v101, -v109
    v_mfma_f32_16x16x32_bf16 v[132:135], v[20:23], v[48:51], v[132:135]
    v_mfma_f32_16x16x32_bf16 v[200:203], v[48:51], v[28:31], v[200:203]
    v_fma_f32 v110, v12, v102, -v110
    s_setprio 1
    s_waitcnt lgkmcnt(6)
    v_mfma_f32_16x16x32_bf16 v[136:139], v[16:19], v[52:55], v[136:139]
    v_mfma_f32_16x16x32_bf16 v[196:199], v[52:55], v[24:27], v[196:199]
    v_fma_f32 v111, v12, v103, -v111
    v_mfma_f32_16x16x32_bf16 v[140:143], v[20:23], v[52:55], v[140:143]
    v_mfma_f32_16x16x32_bf16 v[204:207], v[52:55], v[28:31], v[204:207]
    s_add_u32 m0, s60, 0x12000
    s_add_u32 s14, s61, 0x10280
    buffer_load_dwordx4 v14, s[16:19], s14 offen lds
    v_cvt_pk_bf16_f32 v72, v104, v105
    s_waitcnt lgkmcnt(5)
    v_mfma_f32_16x16x32_bf16 v[144:147], v[16:19], v[56:59], v[144:147]
    v_mfma_f32_16x16x32_bf16 v[208:211], v[56:59], v[24:27], v[208:211]
    v_cvt_pk_bf16_f32 v73, v106, v107
    v_mfma_f32_16x16x32_bf16 v[148:151], v[20:23], v[56:59], v[148:151]
    v_mfma_f32_16x16x32_bf16 v[216:219], v[56:59], v[28:31], v[216:219]
    v_cvt_pk_bf16_f32 v74, v108, v109
    s_setprio 0
    s_waitcnt lgkmcnt(4)
    v_mfma_f32_16x16x32_bf16 v[152:155], v[16:19], v[60:63], v[152:155]
    v_mfma_f32_16x16x32_bf16 v[212:215], v[60:63], v[24:27], v[212:215]
    v_cvt_pk_bf16_f32 v75, v110, v111
    v_mfma_f32_16x16x32_bf16 v[156:159], v[20:23], v[60:63], v[156:159]
    v_mfma_f32_16x16x32_bf16 v[220:223], v[60:63], v[28:31], v[220:223]
    s_waitcnt lgkmcnt(3)
    v_mfma_f32_16x16x32_bf16 v[160:163], v[16:19], v[112:115], v[160:163]
    v_mfma_f32_16x16x32_bf16 v[224:227], v[112:115], v[24:27], v[224:227]
    v_mfma_f32_16x16x32_bf16 v[164:167], v[20:23], v[112:115], v[164:167]
    v_mfma_f32_16x16x32_bf16 v[232:235], v[112:115], v[28:31], v[232:235]
    v_and_b32 v94, 7, v1
    v_lshlrev_b32 v94, 7, v94
    v_lshrrev_b32 v95, 3, v1
    v_lshl_add_u32 v94, v95, 24, v94
    s_lshl_b32 s14, s2, 13
    s_add_u32 s14, s14, s60
    buffer_load_dword v13, v94, s[20:23], s14 offen
    v_mfma_f32_16x16x32_bf16 v[76:79], v[64:67], v[72:75], v[76:79]
    v_mfma_f32_16x16x32_bf16 v[80:83], v[68:71], v[72:75], v[80:83]
    s_waitcnt vmcnt(7) lgkmcnt(0)
    s_barrier
    s_setprio 3
    v_mfma_f32_16x16x32_bf16 v[168:171], v[16:19], v[116:119], v[168:171]
    ds_read_b64_tr_b16 v[32:33], v0 offset:16384
    v_mfma_f32_16x16x32_bf16 v[228:231], v[116:119], v[24:27], v[228:231]
    ds_read_b64_tr_b16 v[34:35], v0 offset:17408
    s_add_u32 m0, s60, 0x18000
    s_add_u32 s14, s62, 0x240000
    buffer_load_dwordx4 v15, s[24:27], s14 offen nt lds
    v_xor_b32 v87, 192, v86
    ds_read_b128 v[64:67], v87 offset:8192
    ds_read_b128 v[68:71], v87 offset:12288
    v_mfma_f32_16x16x32_bf16 v[172:175], v[20:23], v[116:119], v[172:175]
    ds_read_b64_tr_b16 v[36:37], v3 offset:16384
    v_mfma_f32_16x16x32_bf16 v[236:239], v[116:119], v[28:31], v[236:239]
    ds_read_b64_tr_b16 v[38:39], v3 offset:17408
    v_fma_f32 v96, v12, v104, -v96
    ds_read_b64_tr_b16 v[40:41], v0 offset:24576
    v_mfma_f32_16x16x32_bf16 v[176:179], v[16:19], v[120:123], v[176:179]
    ds_read_b64_tr_b16 v[42:43], v0 offset:25600
    v_mfma_f32_16x16x32_bf16 v[240:243], v[120:123], v[24:27], v[240:243]
    ds_read_b64_tr_b16 v[44:45], v3 offset:24576
    v_fma_f32 v97, v12, v105, -v97
    v_mfma_f32_16x16x32_bf16 v[180:183], v[20:23], v[120:123], v[180:183]
    ds_read_b64_tr_b16 v[46:47], v3 offset:25600
    v_mfma_f32_16x16x32_bf16 v[248:251], v[120:123], v[28:31], v[248:251]
    ds_read_b128 v[48:51], v7 offset:0
    s_add_u32 m0, s60, 0x1a000
    s_add_u32 s14, s62, 0x240000
    buffer_load_dwordx4 v15, s[28:31], s14 offen nt lds
    v_fma_f32 v98, v12, v106, -v98
    ds_read_b128 v[52:55], v7 offset:2048
    s_setprio 2
    v_mfma_f32_16x16x32_bf16 v[184:187], v[16:19], v[124:127], v[184:187]
    ds_read_b128 v[56:59], v7 offset:4096
    v_mfma_f32_16x16x32_bf16 v[244:247], v[124:127], v[24:27], v[244:247]
    ds_read_b128 v[60:63], v7 offset:6144
    v_fma_f32 v99, v12, v107, -v99
    v_mfma_f32_16x16x32_bf16 v[188:191], v[20:23], v[124:127], v[188:191]
    ds_read_b128 v[112:115], v7 offset:8192
    v_mfma_f32_16x16x32_bf16 v[252:255], v[124:127], v[28:31], v[252:255]
    s_waitcnt lgkmcnt(9)
    ds_read_b128 v[116:119], v7 offset:10240
    v_fma_f32 v100, v12, v108, -v100
    ds_read_b128 v[120:123], v7 offset:12288
    s_waitcnt lgkmcnt(6)
    v_mfma_f32_16x16x32_bf16 v[128:131], v[32:35], v[48:51], v[128:131]
    v_mfma_f32_16x16x32_bf16 v[192:195], v[48:51], v[40:43], v[192:195]
    ds_read_b128 v[124:127], v7 offset:14336
    s_add_u32 m0, s60, 0x14000
    s_add_u32 s14, s61, 0x20280
    buffer_load_dwordx4 v14, s[16:19], s14 offen lds
    v_fma_f32 v101, v12, v109, -v101
    v_mfma_f32_16x16x32_bf16 v[132:135], v[36:39], v[48:51], v[132:135]
    v_mfma_f32_16x16x32_bf16 v[200:203], v[48:51], v[44:47], v[200:203]
    v_fma_f32 v102, v12, v110, -v102
    s_setprio 1
    s_waitcnt lgkmcnt(6)
    v_mfma_f32_16x16x32_bf16 v[136:139], v[32:35], v[52:55], v[136:139]
    v_mfma_f32_16x16x32_bf16 v[196:199], v[52:55], v[40:43], v[196:199]
    v_fma_f32 v103, v12, v111, -v103
    v_mfma_f32_16x16x32_bf16 v[140:143], v[36:39], v[52:55], v[140:143]
    v_mfma_f32_16x16x32_bf16 v[204:207], v[52:55], v[44:47], v[204:207]
    s_add_u32 m0, s60, 0x16000
    s_add_u32 s14, s61, 0x30280
    buffer_load_dwordx4 v14, s[16:19], s14 offen lds
    v_cvt_pk_bf16_f32 v72, v96, v97
    s_waitcnt lgkmcnt(5)
    v_mfma_f32_16x16x32_bf16 v[144:147], v[32:35], v[56:59], v[144:147]
    v_mfma_f32_16x16x32_bf16 v[208:211], v[56:59], v[40:43], v[208:211]
    v_cvt_pk_bf16_f32 v73, v98, v99
    v_mfma_f32_16x16x32_bf16 v[148:151], v[36:39], v[56:59], v[148:151]
    v_mfma_f32_16x16x32_bf16 v[216:219], v[56:59], v[44:47], v[216:219]
    v_cvt_pk_bf16_f32 v74, v100, v101
    s_setprio 0
    s_waitcnt lgkmcnt(4)
    v_mfma_f32_16x16x32_bf16 v[152:155], v[32:35], v[60:63], v[152:155]
    v_mfma_f32_16x16x32_bf16 v[212:215], v[60:63], v[40:43], v[212:215]
    v_cvt_pk_bf16_f32 v75, v102, v103
    v_mfma_f32_16x16x32_bf16 v[156:159], v[36:39], v[60:63], v[156:159]
    v_mfma_f32_16x16x32_bf16 v[220:223], v[60:63], v[44:47], v[220:223]
    s_waitcnt lgkmcnt(3)
    v_mfma_f32_16x16x32_bf16 v[160:163], v[32:35], v[112:115], v[160:163]
    v_mfma_f32_16x16x32_bf16 v[224:227], v[112:115], v[40:43], v[224:227]
    v_mfma_f32_16x16x32_bf16 v[164:167], v[36:39], v[112:115], v[164:167]
    v_mfma_f32_16x16x32_bf16 v[232:235], v[112:115], v[44:47], v[232:235]
    v_mfma_f32_16x16x32_bf16 v[76:79], v[64:67], v[72:75], v[76:79]
    v_mfma_f32_16x16x32_bf16 v[80:83], v[68:71], v[72:75], v[80:83]
    s_waitcnt vmcnt(7) lgkmcnt(0)
    s_barrier
    s_setprio 3
    v_mfma_f32_16x16x32_bf16 v[168:171], v[32:35], v[116:119], v[168:171]
    ds_read_b64_tr_b16 v[16:17], v0 offset:32768
    v_mfma_f32_16x16x32_bf16 v[228:231], v[116:119], v[40:43], v[228:231]
    ds_read_b64_tr_b16 v[18:19], v0 offset:33792
    s_add_u32 m0, s60, 0x26000
    s_add_u32 s14, s71, 0x300
    buffer_load_dwordx4 v92, s[40:43], s14 offen nt lds
    v_xor_b32 v87, 0, v86
    ds_read_b128 v[64:67], v87 offset:0
    ds_read_b128 v[68:71], v87 offset:4096
    v_mfma_f32_16x16x32_bf16 v[172:175], v[36:39], v[116:119], v[172:175]
    ds_read_b64_tr_b16 v[20:21], v3 offset:32768
    v_mfma_f32_16x16x32_bf16 v[236:239], v[116:119], v[44:47], v[236:239]
    ds_read_b64_tr_b16 v[22:23], v3 offset:33792
    v_fma_f32 v104, v12, v96, -v104
    ds_read_b64_tr_b16 v[24:25], v0 offset:40960
    v_mfma_f32_16x16x32_bf16 v[176:179], v[32:35], v[120:123], v[176:179]
    ds_read_b64_tr_b16 v[26:27], v0 offset:41984
    v_mfma_f32_16x16x32_bf16 v[240:243], v[120:123], v[40:43], v[240:243]
    ds_read_b64_tr_b16 v[28:29], v3 offset:40960
    s_add_u32 m0, s60, 0x1c000
    s_add_u32 s14, s62, 0x280000
    buffer_load_dwordx4 v15, s[24:27], s14 offen nt lds
    v_fma_f32 v105, v12, v97, -v105
    v_mfma_f32_16x16x32_bf16 v[180:183], v[36:39], v[120:123], v[180:183]
    ds_read_b64_tr_b16 v[30:31], v3 offset:41984
    v_mfma_f32_16x16x32_bf16 v[248:251], v[120:123], v[44:47], v[248:251]
    ds_read_b128 v[48:51], v6 offset:32768
    v_fma_f32 v106, v12, v98, -v106
    ds_read_b128 v[52:55], v6 offset:34816
    s_setprio 2
    v_mfma_f32_16x16x32_bf16 v[184:187], v[32:35], v[124:127], v[184:187]
    ds_read_b128 v[56:59], v6 offset:36864
    v_mfma_f32_16x16x32_bf16 v[244:247], v[124:127], v[40:43], v[244:247]
    ds_read_b128 v[60:63], v6 offset:38912
    s_add_u32 m0, s60, 0x1e000
    s_add_u32 s14, s62, 0x280000
    buffer_load_dwordx4 v15, s[28:31], s14 offen nt lds
    v_fma_f32 v107, v12, v99, -v107
    v_mfma_f32_16x16x32_bf16 v[188:191], v[36:39], v[124:127], v[188:191]
    ds_read_b128 v[112:115], v6 offset:40960
    v_mfma_f32_16x16x32_bf16 v[252:255], v[124:127], v[44:47], v[252:255]
    s_waitcnt lgkmcnt(9)
    ds_read_b128 v[116:119], v6 offset:43008
    v_fma_f32 v108, v12, v100, -v108
    ds_read_b128 v[120:123], v6 offset:45056
    s_waitcnt lgkmcnt(6)
    v_mfma_f32_16x16x32_bf16 v[128:131], v[16:19], v[48:51], v[128:131]
    v_mfma_f32_16x16x32_bf16 v[192:195], v[48:51], v[24:27], v[192:195]
    ds_read_b128 v[124:127], v6 offset:47104
    v_fma_f32 v109, v12, v101, -v109
    v_mfma_f32_16x16x32_bf16 v[132:135], v[20:23], v[48:51], v[132:135]
    v_mfma_f32_16x16x32_bf16 v[200:203], v[48:51], v[28:31], v[200:203]
    s_add_u32 m0, s60, 0x0
    s_add_u32 s14, s61, 0x300
    buffer_load_dwordx4 v14, s[16:19], s14 offen lds
    v_fma_f32 v110, v12, v102, -v110
    s_setprio 1
    s_waitcnt lgkmcnt(6)
    v_mfma_f32_16x16x32_bf16 v[136:139], v[16:19], v[52:55], v[136:139]
    v_mfma_f32_16x16x32_bf16 v[196:199], v[52:55], v[24:27], v[196:199]
    v_fma_f32 v111, v12, v103, -v111
    v_mfma_f32_16x16x32_bf16 v[140:143], v[20:23], v[52:55], v[140:143]
    v_mfma_f32_16x16x32_bf16 v[204:207], v[52:55], v[28:31], v[204:207]
    s_add_u32 m0, s60, 0x2000
    s_add_u32 s14, s61, 0x10300
    buffer_load_dwordx4 v14, s[16:19], s14 offen lds
    v_cvt_pk_bf16_f32 v72, v104, v105
    s_waitcnt lgkmcnt(5)
    v_mfma_f32_16x16x32_bf16 v[144:147], v[16:19], v[56:59], v[144:147]
    v_mfma_f32_16x16x32_bf16 v[208:211], v[56:59], v[24:27], v[208:211]
    v_cvt_pk_bf16_f32 v73, v106, v107
    v_mfma_f32_16x16x32_bf16 v[148:151], v[20:23], v[56:59], v[148:151]
    v_mfma_f32_16x16x32_bf16 v[216:219], v[56:59], v[28:31], v[216:219]
    v_cvt_pk_bf16_f32 v74, v108, v109
    s_setprio 0
    s_waitcnt lgkmcnt(4)
    v_mfma_f32_16x16x32_bf16 v[152:155], v[16:19], v[60:63], v[152:155]
    v_mfma_f32_16x16x32_bf16 v[212:215], v[60:63], v[24:27], v[212:215]
    v_cvt_pk_bf16_f32 v75, v110, v111
    v_mfma_f32_16x16x32_bf16 v[156:159], v[20:23], v[60:63], v[156:159]
    v_mfma_f32_16x16x32_bf16 v[220:223], v[60:63], v[28:31], v[220:223]
    s_waitcnt lgkmcnt(3)
    v_mfma_f32_16x16x32_bf16 v[160:163], v[16:19], v[112:115], v[160:163]
    v_mfma_f32_16x16x32_bf16 v[224:227], v[112:115], v[24:27], v[224:227]
    v_mfma_f32_16x16x32_bf16 v[164:167], v[20:23], v[112:115], v[164:167]
    v_mfma_f32_16x16x32_bf16 v[232:235], v[112:115], v[28:31], v[232:235]
    v_bfe_u32 v94, v1, 1, 2
    v_lshlrev_b32 v94, 13, v94
    v_and_b32 v95, 1, v1
    v_lshl_add_u32 v94, v95, 7, v94
    v_lshrrev_b32 v95, 3, v1
    v_lshl_add_u32 v94, v95, 24, v94
    s_lshl_b32 s14, s5, 4
    s_add_u32 s14, s14, s3
    s_lshl_b32 s14, s14, 15
    s_add_u32 s14, s14, s62
    s_add_u32 s14, s14, 0x0
    buffer_load_dword v13, v94, s[32:35], s14 offen
    v_mfma_f32_16x16x32_bf16 v[76:79], v[64:67], v[72:75], v[76:79]
    v_mfma_f32_16x16x32_bf16 v[80:83], v[68:71], v[72:75], v[80:83]
    s_waitcnt vmcnt(8) lgkmcnt(0)
    s_barrier
    s_setprio 3
    v_mfma_f32_16x16x32_bf16 v[168:171], v[16:19], v[116:119], v[168:171]
    ds_read_b64_tr_b16 v[32:33], v0 offset:0
    v_mfma_f32_16x16x32_bf16 v[228:231], v[116:119], v[24:27], v[228:231]
    ds_read_b64_tr_b16 v[34:35], v0 offset:1024
    s_add_u32 m0, s60, 0x20000
    s_add_u32 s14, s62, 0x2c0000
    buffer_load_dwordx4 v15, s[24:27], s14 offen nt lds
    v_xor_b32 v87, 64, v86
    ds_read_b128 v[64:67], v87 offset:0
    ds_read_b128 v[68:71], v87 offset:4096
    v_mfma_f32_16x16x32_bf16 v[172:175], v[20:23], v[116:119], v[172:175]
    ds_read_b64_tr_b16 v[36:37], v3 offset:0
    v_mfma_f32_16x16x32_bf16 v[236:239], v[116:119], v[28:31], v[236:239]
    ds_read_b64_tr_b16 v[38:39], v3 offset:1024
    v_fma_f32 v96, v12, v104, -v96
    ds_read_b64_tr_b16 v[40:41], v0 offset:8192
    v_mfma_f32_16x16x32_bf16 v[176:179], v[16:19], v[120:123], v[176:179]
    ds_read_b64_tr_b16 v[42:43], v0 offset:9216
    v_mfma_f32_16x16x32_bf16 v[240:243], v[120:123], v[24:27], v[240:243]
    ds_read_b64_tr_b16 v[44:45], v3 offset:8192
    v_fma_f32 v97, v12, v105, -v97
    v_mfma_f32_16x16x32_bf16 v[180:183], v[20:23], v[120:123], v[180:183]
    ds_read_b64_tr_b16 v[46:47], v3 offset:9216
    v_mfma_f32_16x16x32_bf16 v[248:251], v[120:123], v[28:31], v[248:251]
    ds_read_b128 v[48:51], v7 offset:32768
    s_add_u32 m0, s60, 0x22000
    s_add_u32 s14, s62, 0x2c0000
    buffer_load_dwordx4 v15, s[28:31], s14 offen nt lds
    v_fma_f32 v98, v12, v106, -v98
    ds_read_b128 v[52:55], v7 offset:34816
    s_setprio 2
    v_mfma_f32_16x16x32_bf16 v[184:187], v[16:19], v[124:127], v[184:187]
    ds_read_b128 v[56:59], v7 offset:36864
    v_mfma_f32_16x16x32_bf16 v[244:247], v[124:127], v[24:27], v[244:247]
    ds_read_b128 v[60:63], v7 offset:38912
    v_fma_f32 v99, v12, v107, -v99
    v_mfma_f32_16x16x32_bf16 v[188:191], v[20:23], v[124:127], v[188:191]
    ds_read_b128 v[112:115], v7 offset:40960
    v_mfma_f32_16x16x32_bf16 v[252:255], v[124:127], v[28:31], v[252:255]
    s_waitcnt lgkmcnt(9)
    ds_read_b128 v[116:119], v7 offset:43008
    v_fma_f32 v100, v12, v108, -v100
    ds_read_b128 v[120:123], v7 offset:45056
    s_waitcnt lgkmcnt(6)
    v_mfma_f32_16x16x32_bf16 v[128:131], v[32:35], v[48:51], v[128:131]
    v_mfma_f32_16x16x32_bf16 v[192:195], v[48:51], v[40:43], v[192:195]
    ds_read_b128 v[124:127], v7 offset:47104
    s_add_u32 m0, s60, 0x4000
    s_add_u32 s14, s61, 0x20300
    buffer_load_dwordx4 v14, s[16:19], s14 offen lds
    v_fma_f32 v101, v12, v109, -v101
    v_mfma_f32_16x16x32_bf16 v[132:135], v[36:39], v[48:51], v[132:135]
    v_mfma_f32_16x16x32_bf16 v[200:203], v[48:51], v[44:47], v[200:203]
    v_fma_f32 v102, v12, v110, -v102
    s_setprio 1
    s_waitcnt lgkmcnt(6)
    v_mfma_f32_16x16x32_bf16 v[136:139], v[32:35], v[52:55], v[136:139]
    v_mfma_f32_16x16x32_bf16 v[196:199], v[52:55], v[40:43], v[196:199]
    v_fma_f32 v103, v12, v111, -v103
    v_mfma_f32_16x16x32_bf16 v[140:143], v[36:39], v[52:55], v[140:143]
    v_mfma_f32_16x16x32_bf16 v[204:207], v[52:55], v[44:47], v[204:207]
    s_add_u32 m0, s60, 0x6000
    s_add_u32 s14, s61, 0x30300
    buffer_load_dwordx4 v14, s[16:19], s14 offen lds
    v_cvt_pk_bf16_f32 v72, v96, v97
    s_waitcnt lgkmcnt(5)
    v_mfma_f32_16x16x32_bf16 v[144:147], v[32:35], v[56:59], v[144:147]
    v_mfma_f32_16x16x32_bf16 v[208:211], v[56:59], v[40:43], v[208:211]
    v_cvt_pk_bf16_f32 v73, v98, v99
    v_mfma_f32_16x16x32_bf16 v[148:151], v[36:39], v[56:59], v[148:151]
    v_mfma_f32_16x16x32_bf16 v[216:219], v[56:59], v[44:47], v[216:219]
    v_cvt_pk_bf16_f32 v74, v100, v101
    s_setprio 0
    s_waitcnt lgkmcnt(4)
    v_mfma_f32_16x16x32_bf16 v[152:155], v[32:35], v[60:63], v[152:155]
    v_mfma_f32_16x16x32_bf16 v[212:215], v[60:63], v[40:43], v[212:215]
    v_cvt_pk_bf16_f32 v75, v102, v103
    v_mfma_f32_16x16x32_bf16 v[156:159], v[36:39], v[60:63], v[156:159]
    v_mfma_f32_16x16x32_bf16 v[220:223], v[60:63], v[44:47], v[220:223]
    s_waitcnt lgkmcnt(3)
    v_mfma_f32_16x16x32_bf16 v[160:163], v[32:35], v[112:115], v[160:163]
    v_mfma_f32_16x16x32_bf16 v[224:227], v[112:115], v[40:43], v[224:227]
    v_mfma_f32_16x16x32_bf16 v[164:167], v[36:39], v[112:115], v[164:167]
    v_mfma_f32_16x16x32_bf16 v[232:235], v[112:115], v[44:47], v[232:235]
    v_mfma_f32_16x16x32_bf16 v[76:79], v[64:67], v[72:75], v[76:79]
    v_mfma_f32_16x16x32_bf16 v[80:83], v[68:71], v[72:75], v[80:83]
    s_waitcnt vmcnt(7) lgkmcnt(0)
    s_barrier
    s_setprio 3
    v_mfma_f32_16x16x32_bf16 v[168:171], v[32:35], v[116:119], v[168:171]
    ds_read_b64_tr_b16 v[16:17], v0 offset:16384
    v_mfma_f32_16x16x32_bf16 v[228:231], v[116:119], v[40:43], v[228:231]
    ds_read_b64_tr_b16 v[18:19], v0 offset:17408
    s_add_u32 m0, s60, 0x18000
    s_add_u32 s14, s62, 0x300000
    buffer_load_dwordx4 v15, s[24:27], s14 offen nt lds
    v_xor_b32 v87, 128, v86
    ds_read_b128 v[64:67], v87 offset:0
    ds_read_b128 v[68:71], v87 offset:4096
    v_mfma_f32_16x16x32_bf16 v[172:175], v[36:39], v[116:119], v[172:175]
    ds_read_b64_tr_b16 v[20:21], v3 offset:16384
    v_mfma_f32_16x16x32_bf16 v[236:239], v[116:119], v[44:47], v[236:239]
    ds_read_b64_tr_b16 v[22:23], v3 offset:17408
    v_fma_f32 v104, v12, v96, -v104
    ds_read_b64_tr_b16 v[24:25], v0 offset:24576
    v_mfma_f32_16x16x32_bf16 v[176:179], v[32:35], v[120:123], v[176:179]
    ds_read_b64_tr_b16 v[26:27], v0 offset:25600
    v_mfma_f32_16x16x32_bf16 v[240:243], v[120:123], v[40:43], v[240:243]
    ds_read_b64_tr_b16 v[28:29], v3 offset:24576
    v_fma_f32 v105, v12, v97, -v105
    v_mfma_f32_16x16x32_bf16 v[180:183], v[36:39], v[120:123], v[180:183]
    ds_read_b64_tr_b16 v[30:31], v3 offset:25600
    v_mfma_f32_16x16x32_bf16 v[248:251], v[120:123], v[44:47], v[248:251]
    ds_read_b128 v[48:51], v8 offset:0
    s_add_u32 m0, s60, 0x1a000
    s_add_u32 s14, s62, 0x300000
    buffer_load_dwordx4 v15, s[28:31], s14 offen nt lds
    v_fma_f32 v106, v12, v98, -v106
    ds_read_b128 v[52:55], v8 offset:2048
    s_setprio 2
    v_mfma_f32_16x16x32_bf16 v[184:187], v[32:35], v[124:127], v[184:187]
    ds_read_b128 v[56:59], v8 offset:4096
    v_mfma_f32_16x16x32_bf16 v[244:247], v[124:127], v[40:43], v[244:247]
    ds_read_b128 v[60:63], v8 offset:6144
    v_fma_f32 v107, v12, v99, -v107
    v_mfma_f32_16x16x32_bf16 v[188:191], v[36:39], v[124:127], v[188:191]
    ds_read_b128 v[112:115], v8 offset:8192
    v_mfma_f32_16x16x32_bf16 v[252:255], v[124:127], v[44:47], v[252:255]
    s_waitcnt lgkmcnt(9)
    ds_read_b128 v[116:119], v8 offset:10240
    v_fma_f32 v108, v12, v100, -v108
    ds_read_b128 v[120:123], v8 offset:12288
    s_waitcnt lgkmcnt(6)
    v_mfma_f32_16x16x32_bf16 v[128:131], v[16:19], v[48:51], v[128:131]
    v_mfma_f32_16x16x32_bf16 v[192:195], v[48:51], v[24:27], v[192:195]
    ds_read_b128 v[124:127], v8 offset:14336
    s_add_u32 m0, s60, 0x8000
    s_add_u32 s14, s61, 0x380
    buffer_load_dwordx4 v14, s[16:19], s14 offen lds
    v_fma_f32 v109, v12, v101, -v109
    v_mfma_f32_16x16x32_bf16 v[132:135], v[20:23], v[48:51], v[132:135]
    v_mfma_f32_16x16x32_bf16 v[200:203], v[48:51], v[28:31], v[200:203]
    v_fma_f32 v110, v12, v102, -v110
    s_setprio 1
    s_waitcnt lgkmcnt(6)
    v_mfma_f32_16x16x32_bf16 v[136:139], v[16:19], v[52:55], v[136:139]
    v_mfma_f32_16x16x32_bf16 v[196:199], v[52:55], v[24:27], v[196:199]
    v_fma_f32 v111, v12, v103, -v111
    v_mfma_f32_16x16x32_bf16 v[140:143], v[20:23], v[52:55], v[140:143]
    v_mfma_f32_16x16x32_bf16 v[204:207], v[52:55], v[28:31], v[204:207]
    s_add_u32 m0, s60, 0xa000
    s_add_u32 s14, s61, 0x10380
    buffer_load_dwordx4 v14, s[16:19], s14 offen lds
    v_cvt_pk_bf16_f32 v72, v104, v105
    s_waitcnt lgkmcnt(5)
    v_mfma_f32_16x16x32_bf16 v[144:147], v[16:19], v[56:59], v[144:147]
    v_mfma_f32_16x16x32_bf16 v[208:211], v[56:59], v[24:27], v[208:211]
    v_cvt_pk_bf16_f32 v73, v106, v107
    v_mfma_f32_16x16x32_bf16 v[148:151], v[20:23], v[56:59], v[148:151]
    v_mfma_f32_16x16x32_bf16 v[216:219], v[56:59], v[28:31], v[216:219]
    v_cvt_pk_bf16_f32 v74, v108, v109
    s_setprio 0
    s_waitcnt lgkmcnt(4)
    v_mfma_f32_16x16x32_bf16 v[152:155], v[16:19], v[60:63], v[152:155]
    v_mfma_f32_16x16x32_bf16 v[212:215], v[60:63], v[24:27], v[212:215]
    v_cvt_pk_bf16_f32 v75, v110, v111
    v_mfma_f32_16x16x32_bf16 v[156:159], v[20:23], v[60:63], v[156:159]
    v_mfma_f32_16x16x32_bf16 v[220:223], v[60:63], v[28:31], v[220:223]
    s_waitcnt lgkmcnt(3)
    v_mfma_f32_16x16x32_bf16 v[160:163], v[16:19], v[112:115], v[160:163]
    v_mfma_f32_16x16x32_bf16 v[224:227], v[112:115], v[24:27], v[224:227]
    v_mfma_f32_16x16x32_bf16 v[164:167], v[20:23], v[112:115], v[164:167]
    v_mfma_f32_16x16x32_bf16 v[232:235], v[112:115], v[28:31], v[232:235]
    v_bfe_u32 v94, v1, 1, 2
    v_lshlrev_b32 v94, 13, v94
    v_and_b32 v95, 1, v1
    v_lshl_add_u32 v94, v95, 7, v94
    v_lshrrev_b32 v95, 3, v1
    v_lshl_add_u32 v94, v95, 24, v94
    s_lshl_b32 s14, s5, 4
    s_add_u32 s14, s14, s3
    s_lshl_b32 s14, s14, 15
    s_add_u32 s14, s14, s62
    s_add_u32 s14, s14, 0x40000
    buffer_load_dword v13, v94, s[32:35], s14 offen
    v_mfma_f32_16x16x32_bf16 v[76:79], v[64:67], v[72:75], v[76:79]
    v_mfma_f32_16x16x32_bf16 v[80:83], v[68:71], v[72:75], v[80:83]
    s_waitcnt vmcnt(7) lgkmcnt(0)
    s_barrier
    s_setprio 3
    v_mfma_f32_16x16x32_bf16 v[168:171], v[16:19], v[116:119], v[168:171]
    ds_read_b64_tr_b16 v[32:33], v0 offset:32768
    v_mfma_f32_16x16x32_bf16 v[228:231], v[116:119], v[24:27], v[228:231]
    ds_read_b64_tr_b16 v[34:35], v0 offset:33792
    s_add_u32 m0, s60, 0x1c000
    s_add_u32 s14, s62, 0x340000
    buffer_load_dwordx4 v15, s[24:27], s14 offen nt lds
    v_xor_b32 v87, 192, v86
    ds_read_b128 v[64:67], v87 offset:0
    ds_read_b128 v[68:71], v87 offset:4096
    v_mfma_f32_16x16x32_bf16 v[172:175], v[20:23], v[116:119], v[172:175]
    ds_read_b64_tr_b16 v[36:37], v3 offset:32768
    v_mfma_f32_16x16x32_bf16 v[236:239], v[116:119], v[28:31], v[236:239]
    ds_read_b64_tr_b16 v[38:39], v3 offset:33792
    v_fma_f32 v96, v12, v104, -v96
    ds_read_b64_tr_b16 v[40:41], v0 offset:40960
    v_mfma_f32_16x16x32_bf16 v[176:179], v[16:19], v[120:123], v[176:179]
    ds_read_b64_tr_b16 v[42:43], v0 offset:41984
    v_mfma_f32_16x16x32_bf16 v[240:243], v[120:123], v[24:27], v[240:243]
    ds_read_b64_tr_b16 v[44:45], v3 offset:40960
    v_fma_f32 v97, v12, v105, -v97
    v_mfma_f32_16x16x32_bf16 v[180:183], v[20:23], v[120:123], v[180:183]
    ds_read_b64_tr_b16 v[46:47], v3 offset:41984
    v_mfma_f32_16x16x32_bf16 v[248:251], v[120:123], v[28:31], v[248:251]
    ds_read_b128 v[48:51], v9 offset:0
    s_add_u32 m0, s60, 0x1e000
    s_add_u32 s14, s62, 0x340000
    buffer_load_dwordx4 v15, s[28:31], s14 offen nt lds
    v_fma_f32 v98, v12, v106, -v98
    ds_read_b128 v[52:55], v9 offset:2048
    s_setprio 2
    v_mfma_f32_16x16x32_bf16 v[184:187], v[16:19], v[124:127], v[184:187]
    ds_read_b128 v[56:59], v9 offset:4096
    v_mfma_f32_16x16x32_bf16 v[244:247], v[124:127], v[24:27], v[244:247]
    ds_read_b128 v[60:63], v9 offset:6144
    v_fma_f32 v99, v12, v107, -v99
    v_mfma_f32_16x16x32_bf16 v[188:191], v[20:23], v[124:127], v[188:191]
    ds_read_b128 v[112:115], v9 offset:8192
    v_mfma_f32_16x16x32_bf16 v[252:255], v[124:127], v[28:31], v[252:255]
    s_waitcnt lgkmcnt(9)
    ds_read_b128 v[116:119], v9 offset:10240
    v_fma_f32 v100, v12, v108, -v100
    ds_read_b128 v[120:123], v9 offset:12288
    s_waitcnt lgkmcnt(6)
    v_mfma_f32_16x16x32_bf16 v[128:131], v[32:35], v[48:51], v[128:131]
    v_mfma_f32_16x16x32_bf16 v[192:195], v[48:51], v[40:43], v[192:195]
    ds_read_b128 v[124:127], v9 offset:14336
    s_add_u32 m0, s60, 0xc000
    s_add_u32 s14, s61, 0x20380
    buffer_load_dwordx4 v14, s[16:19], s14 offen lds
    v_fma_f32 v101, v12, v109, -v101
    v_mfma_f32_16x16x32_bf16 v[132:135], v[36:39], v[48:51], v[132:135]
    v_mfma_f32_16x16x32_bf16 v[200:203], v[48:51], v[44:47], v[200:203]
    v_fma_f32 v102, v12, v110, -v102
    s_setprio 1
    s_waitcnt lgkmcnt(6)
    v_mfma_f32_16x16x32_bf16 v[136:139], v[32:35], v[52:55], v[136:139]
    v_mfma_f32_16x16x32_bf16 v[196:199], v[52:55], v[40:43], v[196:199]
    v_fma_f32 v103, v12, v111, -v103
    v_mfma_f32_16x16x32_bf16 v[140:143], v[36:39], v[52:55], v[140:143]
    v_mfma_f32_16x16x32_bf16 v[204:207], v[52:55], v[44:47], v[204:207]
    s_add_u32 m0, s60, 0xe000
    s_add_u32 s14, s61, 0x30380
    buffer_load_dwordx4 v14, s[16:19], s14 offen lds
    v_cvt_pk_bf16_f32 v72, v96, v97
    s_waitcnt lgkmcnt(5)
    v_mfma_f32_16x16x32_bf16 v[144:147], v[32:35], v[56:59], v[144:147]
    v_mfma_f32_16x16x32_bf16 v[208:211], v[56:59], v[40:43], v[208:211]
    v_cvt_pk_bf16_f32 v73, v98, v99
    v_mfma_f32_16x16x32_bf16 v[148:151], v[36:39], v[56:59], v[148:151]
    v_mfma_f32_16x16x32_bf16 v[216:219], v[56:59], v[44:47], v[216:219]
    v_cvt_pk_bf16_f32 v74, v100, v101
    s_setprio 0
    s_waitcnt lgkmcnt(4)
    v_mfma_f32_16x16x32_bf16 v[152:155], v[32:35], v[60:63], v[152:155]
    v_mfma_f32_16x16x32_bf16 v[212:215], v[60:63], v[40:43], v[212:215]
    v_cvt_pk_bf16_f32 v75, v102, v103
    v_mfma_f32_16x16x32_bf16 v[156:159], v[36:39], v[60:63], v[156:159]
    v_mfma_f32_16x16x32_bf16 v[220:223], v[60:63], v[44:47], v[220:223]
    s_waitcnt lgkmcnt(3)
    v_mfma_f32_16x16x32_bf16 v[160:163], v[32:35], v[112:115], v[160:163]
    v_mfma_f32_16x16x32_bf16 v[224:227], v[112:115], v[40:43], v[224:227]
    v_mfma_f32_16x16x32_bf16 v[164:167], v[36:39], v[112:115], v[164:167]
    v_mfma_f32_16x16x32_bf16 v[232:235], v[112:115], v[44:47], v[232:235]
    v_mfma_f32_16x16x32_bf16 v[76:79], v[64:67], v[72:75], v[76:79]
    v_mfma_f32_16x16x32_bf16 v[80:83], v[68:71], v[72:75], v[80:83]
    s_waitcnt vmcnt(7) lgkmcnt(0)
    s_barrier
    s_setprio 3
    v_mfma_f32_16x16x32_bf16 v[168:171], v[32:35], v[116:119], v[168:171]
    ds_read_b64_tr_b16 v[16:17], v0 offset:0
    v_mfma_f32_16x16x32_bf16 v[228:231], v[116:119], v[40:43], v[228:231]
    ds_read_b64_tr_b16 v[18:19], v0 offset:1024
    s_add_u32 m0, s60, 0x20000
    s_add_u32 s14, s62, 0x380000
    buffer_load_dwordx4 v15, s[24:27], s14 offen nt lds
    v_xor_b32 v87, 0, v86
    ds_read_b128 v[64:67], v87 offset:8192
    ds_read_b128 v[68:71], v87 offset:12288
    v_mfma_f32_16x16x32_bf16 v[172:175], v[36:39], v[116:119], v[172:175]
    ds_read_b64_tr_b16 v[20:21], v3 offset:0
    v_mfma_f32_16x16x32_bf16 v[236:239], v[116:119], v[44:47], v[236:239]
    ds_read_b64_tr_b16 v[22:23], v3 offset:1024
    v_fma_f32 v104, v12, v96, -v104
    ds_read_b64_tr_b16 v[24:25], v0 offset:8192
    v_mfma_f32_16x16x32_bf16 v[176:179], v[32:35], v[120:123], v[176:179]
    ds_read_b64_tr_b16 v[26:27], v0 offset:9216
    v_mfma_f32_16x16x32_bf16 v[240:243], v[120:123], v[40:43], v[240:243]
    ds_read_b64_tr_b16 v[28:29], v3 offset:8192
    v_fma_f32 v105, v12, v97, -v105
    v_mfma_f32_16x16x32_bf16 v[180:183], v[36:39], v[120:123], v[180:183]
    ds_read_b64_tr_b16 v[30:31], v3 offset:9216
    v_mfma_f32_16x16x32_bf16 v[248:251], v[120:123], v[44:47], v[248:251]
    ds_read_b128 v[48:51], v6 offset:0
    s_add_u32 m0, s60, 0x22000
    s_add_u32 s14, s62, 0x380000
    buffer_load_dwordx4 v15, s[28:31], s14 offen nt lds
    v_fma_f32 v106, v12, v98, -v106
    ds_read_b128 v[52:55], v6 offset:2048
    s_setprio 2
    v_mfma_f32_16x16x32_bf16 v[184:187], v[32:35], v[124:127], v[184:187]
    ds_read_b128 v[56:59], v6 offset:4096
    v_mfma_f32_16x16x32_bf16 v[244:247], v[124:127], v[40:43], v[244:247]
    ds_read_b128 v[60:63], v6 offset:6144
    v_fma_f32 v107, v12, v99, -v107
    v_mfma_f32_16x16x32_bf16 v[188:191], v[36:39], v[124:127], v[188:191]
    ds_read_b128 v[112:115], v6 offset:8192
    v_mfma_f32_16x16x32_bf16 v[252:255], v[124:127], v[44:47], v[252:255]
    s_waitcnt lgkmcnt(9)
    ds_read_b128 v[116:119], v6 offset:10240
    v_fma_f32 v108, v12, v100, -v108
    ds_read_b128 v[120:123], v6 offset:12288
    s_waitcnt lgkmcnt(6)
    v_mfma_f32_16x16x32_bf16 v[128:131], v[16:19], v[48:51], v[128:131]
    v_mfma_f32_16x16x32_bf16 v[192:195], v[48:51], v[24:27], v[192:195]
    ds_read_b128 v[124:127], v6 offset:14336
    s_add_u32 m0, s60, 0x10000
    s_add_u32 s14, s63, 0x0
    buffer_load_dwordx4 v14, s[20:23], s14 offen lds
    v_fma_f32 v109, v12, v101, -v109
    v_mfma_f32_16x16x32_bf16 v[132:135], v[20:23], v[48:51], v[132:135]
    v_mfma_f32_16x16x32_bf16 v[200:203], v[48:51], v[28:31], v[200:203]
    v_fma_f32 v110, v12, v102, -v110
    s_setprio 1
    s_waitcnt lgkmcnt(6)
    v_mfma_f32_16x16x32_bf16 v[136:139], v[16:19], v[52:55], v[136:139]
    v_mfma_f32_16x16x32_bf16 v[196:199], v[52:55], v[24:27], v[196:199]
    v_fma_f32 v111, v12, v103, -v111
    v_mfma_f32_16x16x32_bf16 v[140:143], v[20:23], v[52:55], v[140:143]
    v_mfma_f32_16x16x32_bf16 v[204:207], v[52:55], v[28:31], v[204:207]
    s_add_u32 m0, s60, 0x12000
    s_add_u32 s14, s63, 0x10000
    buffer_load_dwordx4 v14, s[20:23], s14 offen lds
    v_cvt_pk_bf16_f32 v72, v104, v105
    s_waitcnt lgkmcnt(5)
    v_mfma_f32_16x16x32_bf16 v[144:147], v[16:19], v[56:59], v[144:147]
    v_mfma_f32_16x16x32_bf16 v[208:211], v[56:59], v[24:27], v[208:211]
    v_cvt_pk_bf16_f32 v73, v106, v107
    v_mfma_f32_16x16x32_bf16 v[148:151], v[20:23], v[56:59], v[148:151]
    v_mfma_f32_16x16x32_bf16 v[216:219], v[56:59], v[28:31], v[216:219]
    v_cvt_pk_bf16_f32 v74, v108, v109
    s_setprio 0
    s_waitcnt lgkmcnt(4)
    v_mfma_f32_16x16x32_bf16 v[152:155], v[16:19], v[60:63], v[152:155]
    v_mfma_f32_16x16x32_bf16 v[212:215], v[60:63], v[24:27], v[212:215]
    v_cvt_pk_bf16_f32 v75, v110, v111
    v_mfma_f32_16x16x32_bf16 v[156:159], v[20:23], v[60:63], v[156:159]
    v_mfma_f32_16x16x32_bf16 v[220:223], v[60:63], v[28:31], v[220:223]
    s_waitcnt lgkmcnt(3)
    v_mfma_f32_16x16x32_bf16 v[160:163], v[16:19], v[112:115], v[160:163]
    v_mfma_f32_16x16x32_bf16 v[224:227], v[112:115], v[24:27], v[224:227]
    v_mfma_f32_16x16x32_bf16 v[164:167], v[20:23], v[112:115], v[164:167]
    v_mfma_f32_16x16x32_bf16 v[232:235], v[112:115], v[28:31], v[232:235]
    v_and_b32 v94, 3, v1
    v_lshlrev_b32 v94, 7, v94
    v_bfe_u32 v95, v1, 2, 2
    v_lshl_add_u32 v94, v95, 10, v94
    v_lshrrev_b32 v95, 4, v1
    v_lshl_add_u32 v94, v95, 24, v94
    s_lshl_b32 s14, s3, 12
    s_add_u32 s14, s14, s74
    buffer_load_dword v13, v94, s[76:79], s14 offen
    v_mfma_f32_16x16x32_bf16 v[76:79], v[64:67], v[72:75], v[76:79]
    v_mfma_f32_16x16x32_bf16 v[80:83], v[68:71], v[72:75], v[80:83]
    s_waitcnt vmcnt(7) lgkmcnt(0)
    s_barrier
    s_setprio 3
    v_mfma_f32_16x16x32_bf16 v[168:171], v[16:19], v[116:119], v[168:171]
    ds_read_b64_tr_b16 v[32:33], v0 offset:16384
    v_mfma_f32_16x16x32_bf16 v[228:231], v[116:119], v[24:27], v[228:231]
    ds_read_b64_tr_b16 v[34:35], v0 offset:17408
    s_add_u32 m0, s60, 0x18000
    s_add_u32 s14, s62, 0x3c0000
    buffer_load_dwordx4 v15, s[24:27], s14 offen nt lds
    v_xor_b32 v87, 64, v86
    ds_read_b128 v[64:67], v87 offset:8192
    ds_read_b128 v[68:71], v87 offset:12288
    v_mfma_f32_16x16x32_bf16 v[172:175], v[20:23], v[116:119], v[172:175]
    ds_read_b64_tr_b16 v[36:37], v3 offset:16384
    v_mfma_f32_16x16x32_bf16 v[236:239], v[116:119], v[28:31], v[236:239]
    ds_read_b64_tr_b16 v[38:39], v3 offset:17408
    v_fma_f32 v96, v12, v104, -v96
    ds_read_b64_tr_b16 v[40:41], v0 offset:24576
    v_mfma_f32_16x16x32_bf16 v[176:179], v[16:19], v[120:123], v[176:179]
    ds_read_b64_tr_b16 v[42:43], v0 offset:25600
    v_mfma_f32_16x16x32_bf16 v[240:243], v[120:123], v[24:27], v[240:243]
    ds_read_b64_tr_b16 v[44:45], v3 offset:24576
    v_fma_f32 v97, v12, v105, -v97
    v_mfma_f32_16x16x32_bf16 v[180:183], v[20:23], v[120:123], v[180:183]
    ds_read_b64_tr_b16 v[46:47], v3 offset:25600
    v_mfma_f32_16x16x32_bf16 v[248:251], v[120:123], v[28:31], v[248:251]
    ds_read_b128 v[48:51], v7 offset:0
    s_add_u32 m0, s60, 0x1a000
    s_add_u32 s14, s62, 0x3c0000
    buffer_load_dwordx4 v15, s[28:31], s14 offen nt lds
    v_fma_f32 v98, v12, v106, -v98
    ds_read_b128 v[52:55], v7 offset:2048
    s_setprio 2
    v_mfma_f32_16x16x32_bf16 v[184:187], v[16:19], v[124:127], v[184:187]
    ds_read_b128 v[56:59], v7 offset:4096
    v_mfma_f32_16x16x32_bf16 v[244:247], v[124:127], v[24:27], v[244:247]
    ds_read_b128 v[60:63], v7 offset:6144
    v_fma_f32 v99, v12, v107, -v99
    v_mfma_f32_16x16x32_bf16 v[188:191], v[20:23], v[124:127], v[188:191]
    ds_read_b128 v[112:115], v7 offset:8192
    v_mfma_f32_16x16x32_bf16 v[252:255], v[124:127], v[28:31], v[252:255]
    s_waitcnt lgkmcnt(9)
    ds_read_b128 v[116:119], v7 offset:10240
    v_fma_f32 v100, v12, v108, -v100
    ds_read_b128 v[120:123], v7 offset:12288
    s_waitcnt lgkmcnt(6)
    v_mfma_f32_16x16x32_bf16 v[128:131], v[32:35], v[48:51], v[128:131]
    v_mfma_f32_16x16x32_bf16 v[192:195], v[48:51], v[40:43], v[192:195]
    ds_read_b128 v[124:127], v7 offset:14336
    s_add_u32 m0, s60, 0x14000
    s_add_u32 s14, s64, 0x0
    buffer_load_dwordx4 v14, s[20:23], s14 offen lds
    v_fma_f32 v101, v12, v109, -v101
    v_mfma_f32_16x16x32_bf16 v[132:135], v[36:39], v[48:51], v[132:135]
    v_mfma_f32_16x16x32_bf16 v[200:203], v[48:51], v[44:47], v[200:203]
    v_fma_f32 v102, v12, v110, -v102
    s_setprio 1
    s_waitcnt lgkmcnt(6)
    v_mfma_f32_16x16x32_bf16 v[136:139], v[32:35], v[52:55], v[136:139]
    v_mfma_f32_16x16x32_bf16 v[196:199], v[52:55], v[40:43], v[196:199]
    v_fma_f32 v103, v12, v111, -v103
    v_mfma_f32_16x16x32_bf16 v[140:143], v[36:39], v[52:55], v[140:143]
    v_mfma_f32_16x16x32_bf16 v[204:207], v[52:55], v[44:47], v[204:207]
    s_add_u32 m0, s60, 0x16000
    s_add_u32 s14, s64, 0x10000
    buffer_load_dwordx4 v14, s[20:23], s14 offen lds
    v_cvt_pk_bf16_f32 v72, v96, v97
    s_waitcnt lgkmcnt(5)
    v_mfma_f32_16x16x32_bf16 v[144:147], v[32:35], v[56:59], v[144:147]
    v_mfma_f32_16x16x32_bf16 v[208:211], v[56:59], v[40:43], v[208:211]
    v_cvt_pk_bf16_f32 v73, v98, v99
    v_mfma_f32_16x16x32_bf16 v[148:151], v[36:39], v[56:59], v[148:151]
    v_mfma_f32_16x16x32_bf16 v[216:219], v[56:59], v[44:47], v[216:219]
    v_cvt_pk_bf16_f32 v74, v100, v101
    s_setprio 0
    s_waitcnt lgkmcnt(4)
    v_mfma_f32_16x16x32_bf16 v[152:155], v[32:35], v[60:63], v[152:155]
    v_mfma_f32_16x16x32_bf16 v[212:215], v[60:63], v[40:43], v[212:215]
    v_cvt_pk_bf16_f32 v75, v102, v103
    v_mfma_f32_16x16x32_bf16 v[156:159], v[36:39], v[60:63], v[156:159]
    v_mfma_f32_16x16x32_bf16 v[220:223], v[60:63], v[44:47], v[220:223]
    s_waitcnt lgkmcnt(3)
    v_mfma_f32_16x16x32_bf16 v[160:163], v[32:35], v[112:115], v[160:163]
    v_mfma_f32_16x16x32_bf16 v[224:227], v[112:115], v[40:43], v[224:227]
    v_mfma_f32_16x16x32_bf16 v[164:167], v[36:39], v[112:115], v[164:167]
    v_mfma_f32_16x16x32_bf16 v[232:235], v[112:115], v[44:47], v[232:235]
    v_mfma_f32_16x16x32_bf16 v[76:79], v[64:67], v[72:75], v[76:79]
    v_mfma_f32_16x16x32_bf16 v[80:83], v[68:71], v[72:75], v[80:83]
    s_waitcnt vmcnt(7) lgkmcnt(0)
    s_barrier
    s_setprio 3
    v_mfma_f32_16x16x32_bf16 v[168:171], v[32:35], v[116:119], v[168:171]
    ds_read_b64_tr_b16 v[16:17], v0 offset:32768
    v_mfma_f32_16x16x32_bf16 v[228:231], v[116:119], v[40:43], v[228:231]
    ds_read_b64_tr_b16 v[18:19], v0 offset:33792
    s_add_u32 m0, s60, 0x1c000
    s_add_u32 s14, s62, 0x0
    buffer_load_dwordx4 v15, s[32:35], s14 offen lds
    v_xor_b32 v87, 128, v86
    ds_read_b128 v[64:67], v87 offset:8192
    ds_read_b128 v[68:71], v87 offset:12288
    v_mfma_f32_16x16x32_bf16 v[172:175], v[36:39], v[116:119], v[172:175]
    ds_read_b64_tr_b16 v[20:21], v3 offset:32768
    v_mfma_f32_16x16x32_bf16 v[236:239], v[116:119], v[44:47], v[236:239]
    ds_read_b64_tr_b16 v[22:23], v3 offset:33792
    v_fma_f32 v104, v12, v96, -v104
    ds_read_b64_tr_b16 v[24:25], v0 offset:40960
    v_mfma_f32_16x16x32_bf16 v[176:179], v[32:35], v[120:123], v[176:179]
    ds_read_b64_tr_b16 v[26:27], v0 offset:41984
    v_mfma_f32_16x16x32_bf16 v[240:243], v[120:123], v[40:43], v[240:243]
    ds_read_b64_tr_b16 v[28:29], v3 offset:40960
    v_fma_f32 v105, v12, v97, -v105
    v_mfma_f32_16x16x32_bf16 v[180:183], v[36:39], v[120:123], v[180:183]
    ds_read_b64_tr_b16 v[30:31], v3 offset:41984
    v_mfma_f32_16x16x32_bf16 v[248:251], v[120:123], v[44:47], v[248:251]
    ds_read_b128 v[48:51], v6 offset:32768
    s_add_u32 m0, s60, 0x1e000
    s_add_u32 s14, s62, 0x40000
    buffer_load_dwordx4 v15, s[32:35], s14 offen lds
    v_fma_f32 v106, v12, v98, -v106
    ds_read_b128 v[52:55], v6 offset:34816
    s_setprio 2
    v_mfma_f32_16x16x32_bf16 v[184:187], v[32:35], v[124:127], v[184:187]
    ds_read_b128 v[56:59], v6 offset:36864
    v_mfma_f32_16x16x32_bf16 v[244:247], v[124:127], v[40:43], v[244:247]
    ds_read_b128 v[60:63], v6 offset:38912
    v_fma_f32 v107, v12, v99, -v107
    v_mfma_f32_16x16x32_bf16 v[188:191], v[36:39], v[124:127], v[188:191]
    ds_read_b128 v[112:115], v6 offset:40960
    v_mfma_f32_16x16x32_bf16 v[252:255], v[124:127], v[44:47], v[252:255]
    s_waitcnt lgkmcnt(9)
    ds_read_b128 v[116:119], v6 offset:43008
    v_fma_f32 v108, v12, v100, -v108
    ds_read_b128 v[120:123], v6 offset:45056
    s_waitcnt lgkmcnt(6)
    v_mfma_f32_16x16x32_bf16 v[128:131], v[16:19], v[48:51], v[128:131]
    v_mfma_f32_16x16x32_bf16 v[192:195], v[48:51], v[24:27], v[192:195]
    ds_read_b128 v[124:127], v6 offset:47104
    s_add_u32 m0, s60, 0x0
    s_add_u32 s14, s63, 0x80
    buffer_load_dwordx4 v14, s[20:23], s14 offen lds
    v_fma_f32 v109, v12, v101, -v109
    v_mfma_f32_16x16x32_bf16 v[132:135], v[20:23], v[48:51], v[132:135]
    v_mfma_f32_16x16x32_bf16 v[200:203], v[48:51], v[28:31], v[200:203]
    v_fma_f32 v110, v12, v102, -v110
    s_setprio 1
    s_waitcnt lgkmcnt(6)
    v_mfma_f32_16x16x32_bf16 v[136:139], v[16:19], v[52:55], v[136:139]
    v_mfma_f32_16x16x32_bf16 v[196:199], v[52:55], v[24:27], v[196:199]
    v_fma_f32 v111, v12, v103, -v111
    v_mfma_f32_16x16x32_bf16 v[140:143], v[20:23], v[52:55], v[140:143]
    v_mfma_f32_16x16x32_bf16 v[204:207], v[52:55], v[28:31], v[204:207]
    s_add_u32 m0, s60, 0x2000
    s_add_u32 s14, s63, 0x10080
    buffer_load_dwordx4 v14, s[20:23], s14 offen lds
    v_cvt_pk_bf16_f32 v72, v104, v105
    s_waitcnt lgkmcnt(5)
    v_mfma_f32_16x16x32_bf16 v[144:147], v[16:19], v[56:59], v[144:147]
    v_mfma_f32_16x16x32_bf16 v[208:211], v[56:59], v[24:27], v[208:211]
    v_cvt_pk_bf16_f32 v73, v106, v107
    v_mfma_f32_16x16x32_bf16 v[148:151], v[20:23], v[56:59], v[148:151]
    v_mfma_f32_16x16x32_bf16 v[216:219], v[56:59], v[28:31], v[216:219]
    v_cvt_pk_bf16_f32 v74, v108, v109
    s_setprio 0
    s_waitcnt lgkmcnt(4)
    v_mfma_f32_16x16x32_bf16 v[152:155], v[16:19], v[60:63], v[152:155]
    v_mfma_f32_16x16x32_bf16 v[212:215], v[60:63], v[24:27], v[212:215]
    v_cvt_pk_bf16_f32 v75, v110, v111
    v_mfma_f32_16x16x32_bf16 v[156:159], v[20:23], v[60:63], v[156:159]
    v_mfma_f32_16x16x32_bf16 v[220:223], v[60:63], v[28:31], v[220:223]
    s_waitcnt lgkmcnt(3)
    v_mfma_f32_16x16x32_bf16 v[160:163], v[16:19], v[112:115], v[160:163]
    v_mfma_f32_16x16x32_bf16 v[224:227], v[112:115], v[24:27], v[224:227]
    v_mfma_f32_16x16x32_bf16 v[164:167], v[20:23], v[112:115], v[164:167]
    v_mfma_f32_16x16x32_bf16 v[232:235], v[112:115], v[28:31], v[232:235]
    v_mfma_f32_16x16x32_bf16 v[76:79], v[64:67], v[72:75], v[76:79]
    v_mfma_f32_16x16x32_bf16 v[80:83], v[68:71], v[72:75], v[80:83]
    s_waitcnt vmcnt(6) lgkmcnt(0)
    s_barrier
    s_setprio 3
    v_mfma_f32_16x16x32_bf16 v[168:171], v[16:19], v[116:119], v[168:171]
    ds_read_b64_tr_b16 v[32:33], v0 offset:0
    v_mfma_f32_16x16x32_bf16 v[228:231], v[116:119], v[24:27], v[228:231]
    ds_read_b64_tr_b16 v[34:35], v0 offset:1024
    s_add_u32 m0, s60, 0x20000
    s_add_u32 s14, s62, 0x80000
    buffer_load_dwordx4 v15, s[32:35], s14 offen lds
    v_xor_b32 v87, 192, v86
    ds_read_b128 v[64:67], v87 offset:8192
    ds_read_b128 v[68:71], v87 offset:12288
    v_mfma_f32_16x16x32_bf16 v[172:175], v[20:23], v[116:119], v[172:175]
    ds_read_b64_tr_b16 v[36:37], v3 offset:0
    v_mfma_f32_16x16x32_bf16 v[236:239], v[116:119], v[28:31], v[236:239]
    ds_read_b64_tr_b16 v[38:39], v3 offset:1024
    v_fma_f32 v96, v12, v104, -v96
    ds_read_b64_tr_b16 v[40:41], v0 offset:8192
    v_mfma_f32_16x16x32_bf16 v[176:179], v[16:19], v[120:123], v[176:179]
    ds_read_b64_tr_b16 v[42:43], v0 offset:9216
    v_mfma_f32_16x16x32_bf16 v[240:243], v[120:123], v[24:27], v[240:243]
    ds_read_b64_tr_b16 v[44:45], v3 offset:8192
    v_fma_f32 v97, v12, v105, -v97
    v_mfma_f32_16x16x32_bf16 v[180:183], v[20:23], v[120:123], v[180:183]
    ds_read_b64_tr_b16 v[46:47], v3 offset:9216
    v_mfma_f32_16x16x32_bf16 v[248:251], v[120:123], v[28:31], v[248:251]
    ds_read_b128 v[48:51], v7 offset:32768
    s_add_u32 m0, s60, 0x22000
    s_add_u32 s14, s62, 0xc0000
    buffer_load_dwordx4 v15, s[32:35], s14 offen lds
    v_fma_f32 v98, v12, v106, -v98
    ds_read_b128 v[52:55], v7 offset:34816
    s_setprio 2
    v_mfma_f32_16x16x32_bf16 v[184:187], v[16:19], v[124:127], v[184:187]
    ds_read_b128 v[56:59], v7 offset:36864
    v_mfma_f32_16x16x32_bf16 v[244:247], v[124:127], v[24:27], v[244:247]
    ds_read_b128 v[60:63], v7 offset:38912
    v_fma_f32 v99, v12, v107, -v99
    v_mfma_f32_16x16x32_bf16 v[188:191], v[20:23], v[124:127], v[188:191]
    ds_read_b128 v[112:115], v7 offset:40960
    v_mfma_f32_16x16x32_bf16 v[252:255], v[124:127], v[28:31], v[252:255]
    v_fma_f32 v100, v12, v108, -v100
    s_waitcnt lgkmcnt(4)
    v_mfma_f32_16x16x32_bf16 v[128:131], v[32:35], v[48:51], v[128:131]
    v_mfma_f32_16x16x32_bf16 v[192:195], v[48:51], v[40:43], v[192:195]
    s_add_u32 m0, s60, 0x4000
    s_add_u32 s14, s64, 0x80
    buffer_load_dwordx4 v14, s[20:23], s14 offen lds
    v_fma_f32 v101, v12, v109, -v101
    v_mfma_f32_16x16x32_bf16 v[132:135], v[36:39], v[48:51], v[132:135]
    v_mfma_f32_16x16x32_bf16 v[200:203], v[48:51], v[44:47], v[200:203]
    v_fma_f32 v102, v12, v110, -v102
    ds_read_b128 v[48:51], v7 offset:43008
    s_setprio 1
    s_waitcnt lgkmcnt(4)
    v_mfma_f32_16x16x32_bf16 v[136:139], v[32:35], v[52:55], v[136:139]
    v_mfma_f32_16x16x32_bf16 v[196:199], v[52:55], v[40:43], v[196:199]
    v_fma_f32 v103, v12, v111, -v103
    v_mfma_f32_16x16x32_bf16 v[140:143], v[36:39], v[52:55], v[140:143]
    v_mfma_f32_16x16x32_bf16 v[204:207], v[52:55], v[44:47], v[204:207]
    s_add_u32 m0, s60, 0x6000
    s_add_u32 s14, s64, 0x10080
    buffer_load_dwordx4 v14, s[20:23], s14 offen lds
    v_cvt_pk_bf16_f32 v72, v96, v97
    ds_read_b128 v[52:55], v7 offset:45056
    s_waitcnt lgkmcnt(4)
    v_mfma_f32_16x16x32_bf16 v[144:147], v[32:35], v[56:59], v[144:147]
    v_mfma_f32_16x16x32_bf16 v[208:211], v[56:59], v[40:43], v[208:211]
    v_cvt_pk_bf16_f32 v73, v98, v99
    v_mfma_f32_16x16x32_bf16 v[148:151], v[36:39], v[56:59], v[148:151]
    v_mfma_f32_16x16x32_bf16 v[216:219], v[56:59], v[44:47], v[216:219]
    v_cvt_pk_bf16_f32 v74, v100, v101
    ds_read_b128 v[56:59], v7 offset:47104
    s_setprio 0
    s_waitcnt lgkmcnt(4)
    v_mfma_f32_16x16x32_bf16 v[152:155], v[32:35], v[60:63], v[152:155]
    v_mfma_f32_16x16x32_bf16 v[212:215], v[60:63], v[40:43], v[212:215]
    v_cvt_pk_bf16_f32 v75, v102, v103
    v_mfma_f32_16x16x32_bf16 v[156:159], v[36:39], v[60:63], v[156:159]
    v_mfma_f32_16x16x32_bf16 v[220:223], v[60:63], v[44:47], v[220:223]
    s_waitcnt lgkmcnt(3)
    v_mfma_f32_16x16x32_bf16 v[160:163], v[32:35], v[112:115], v[160:163]
    v_mfma_f32_16x16x32_bf16 v[224:227], v[112:115], v[40:43], v[224:227]
    v_mfma_f32_16x16x32_bf16 v[164:167], v[36:39], v[112:115], v[164:167]
    v_mfma_f32_16x16x32_bf16 v[232:235], v[112:115], v[44:47], v[232:235]
    s_lshr_b32 s14, s3, 1
    s_lshl_b32 s14, s14, 6
    v_and_b32 v4, 15, v1
    v_add_u32 v4, s14, v4
    v_lshlrev_b32 v4, 7, v4
    v_bfe_u32 v8, v1, 1, 3
    v_lshrrev_b32 v9, 4, v1
    v_xor_b32 v8, v8, v9
    v_lshl_add_u32 v6, v8, 4, v4
    v_xor_b32 v7, 64, v6
    v_add_u32 v8, 0x10000, v6
    v_add_u32 v9, 0x10000, v7
    s_and_b32 s15, s3, 1
    s_lshl_b32 s15, s15, 1
    s_and_b32 s14, s3, 3
    s_xor_b32 s15, s15, s14
    s_lshl_b32 s15, s15, 6
    v_xor_b32 v0, s15, v0
    v_xor_b32 v3, 32, v0
    v_xor_b32 v10, 64, v0
    v_xor_b32 v11, 96, v0
    v_mfma_f32_16x16x32_bf16 v[76:79], v[64:67], v[72:75], v[76:79]
    v_mfma_f32_16x16x32_bf16 v[80:83], v[68:71], v[72:75], v[80:83]
    s_nop 6
    v_cvt_pk_bf16_f32 v76, v76, v77
    v_cvt_pk_bf16_f32 v77, v78, v79
    v_cvt_pk_bf16_f32 v78, v80, v81
    v_cvt_pk_bf16_f32 v79, v82, v83
    v_lshrrev_b32 v94, 2, v1
    v_and_b32 v95, 3, v1
    v_lshl_add_u32 v94, v95, 4, v94
    v_lshlrev_b32 v94, 2, v94
    ds_bpermute_b32 v72, v94, v76
    ds_bpermute_b32 v73, v94, v77
    ds_bpermute_b32 v74, v94, v78
    ds_bpermute_b32 v75, v94, v79
    s_waitcnt vmcnt(6) lgkmcnt(0)
    s_barrier
    s_setprio 3
    v_mfma_f32_16x16x32_bf16 v[168:171], v[32:35], v[48:51], v[168:171]
    ds_read_b64_tr_b16 v[16:17], v0 offset:16384
    v_mfma_f32_16x16x32_bf16 v[228:231], v[48:51], v[40:43], v[228:231]
    ds_read_b64_tr_b16 v[18:19], v0 offset:17408
    v_mfma_f32_16x16x32_bf16 v[172:175], v[36:39], v[48:51], v[172:175]
    ds_read_b64_tr_b16 v[20:21], v3 offset:16384
    v_mfma_f32_16x16x32_bf16 v[236:239], v[48:51], v[44:47], v[236:239]
    ds_read_b64_tr_b16 v[22:23], v3 offset:17408
    s_add_u32 m0, s60, 0x18000
    s_add_u32 s14, s62, 0x100000
    buffer_load_dwordx4 v15, s[32:35], s14 offen lds
    buffer_store_dwordx4 v[72:75], v93, s[44:47], s72 offen sc1
    ds_read_b64_tr_b16 v[24:25], v10 offset:16384
    v_mfma_f32_16x16x32_bf16 v[176:179], v[32:35], v[52:55], v[176:179]
    ds_read_b64_tr_b16 v[26:27], v10 offset:17408
    v_mfma_f32_16x16x32_bf16 v[240:243], v[52:55], v[40:43], v[240:243]
    ds_read_b64_tr_b16 v[28:29], v11 offset:16384
    v_mfma_f32_16x16x32_bf16 v[180:183], v[36:39], v[52:55], v[180:183]
    ds_read_b64_tr_b16 v[30:31], v11 offset:17408
    v_mfma_f32_16x16x32_bf16 v[248:251], v[52:55], v[44:47], v[248:251]
    ds_read_b128 v[60:63], v8 offset:0
    s_add_u32 m0, s60, 0x1a000
    s_add_u32 s14, s62, 0x140000
    buffer_load_dwordx4 v15, s[32:35], s14 offen lds
    ds_read_b128 v[48:51], v8 offset:2048
    s_setprio 2
    v_mfma_f32_16x16x32_bf16 v[184:187], v[32:35], v[56:59], v[184:187]
    ds_read_b128 v[52:55], v8 offset:4096
    v_mfma_f32_16x16x32_bf16 v[244:247], v[56:59], v[40:43], v[244:247]
    v_mfma_f32_16x16x32_bf16 v[188:191], v[36:39], v[56:59], v[188:191]
    v_mfma_f32_16x16x32_bf16 v[252:255], v[56:59], v[44:47], v[252:255]
    s_add_u32 m0, s60, 0x8000
    s_add_u32 s14, s63, 0x100
    buffer_load_dwordx4 v14, s[20:23], s14 offen lds
    ds_read_b128 v[56:59], v8 offset:6144
    s_waitcnt lgkmcnt(3)
    v_mfma_f32_16x16x32_bf16 v[64:67], v[16:19], v[60:63], 0
    v_mfma_f32_16x16x32_bf16 v[68:71], v[20:23], v[60:63], 0
    ds_read_b64_tr_b16 v[32:33], v0 offset:24576
    v_mfma_f32_16x16x32_bf16 v[72:75], v[24:27], v[60:63], 0
    v_mfma_f32_16x16x32_bf16 v[76:79], v[28:31], v[60:63], 0
    ds_read_b64_tr_b16 v[34:35], v0 offset:25600
    s_add_u32 m0, s60, 0xa000
    s_add_u32 s14, s63, 0x10100
    buffer_load_dwordx4 v14, s[20:23], s14 offen lds
    ds_read_b64_tr_b16 v[36:37], v3 offset:24576
    s_setprio 1
    s_waitcnt lgkmcnt(5)
    v_mfma_f32_16x16x32_bf16 v[80:83], v[16:19], v[48:51], 0
    v_mfma_f32_16x16x32_bf16 v[84:87], v[20:23], v[48:51], 0
    ds_read_b64_tr_b16 v[38:39], v3 offset:25600
    v_mfma_f32_16x16x32_bf16 v[88:91], v[24:27], v[48:51], 0
    v_mfma_f32_16x16x32_bf16 v[92:95], v[28:31], v[48:51], 0
    ds_read_b64_tr_b16 v[40:41], v10 offset:24576
    ds_read_b64_tr_b16 v[42:43], v10 offset:25600
    s_waitcnt lgkmcnt(7)
    v_mfma_f32_16x16x32_bf16 v[96:99], v[16:19], v[52:55], 0
    v_mfma_f32_16x16x32_bf16 v[100:103], v[20:23], v[52:55], 0
    ds_read_b64_tr_b16 v[44:45], v11 offset:24576
    s_add_u32 m0, s60, 0xc000
    s_add_u32 s14, s64, 0x100
    buffer_load_dwordx4 v14, s[20:23], s14 offen lds
    v_lshrrev_b32 v4, 5, v1
    v_and_b32 v5, 31, v1
    v_lshlrev_b32 v5, 4, v5
    v_lshl_add_u32 v4, v4, 10, v5
    s_add_u32 m0, s60, 0x24000
    s_lshl_b32 s14, s3, 11
    s_add_u32 s14, s14, s74
    buffer_load_dwordx4 v4, s[76:79], s14 offen lds
    s_add_u32 m0, s60, 0x26000
    s_lshl_b32 s14, s3, 11
    s_add_u32 s14, s14, s74
    s_add_u32 s14, s14, 0x4000
    buffer_load_dwordx4 v4, s[76:79], s14 offen lds
    v_mfma_f32_16x16x32_bf16 v[104:107], v[24:27], v[52:55], 0
    v_mfma_f32_16x16x32_bf16 v[108:111], v[28:31], v[52:55], 0
    ds_read_b64_tr_b16 v[46:47], v11 offset:25600
    ds_read_b128 v[60:63], v9 offset:0
    s_setprio 0
    s_waitcnt lgkmcnt(9)
    v_mfma_f32_16x16x32_bf16 v[112:115], v[16:19], v[56:59], 0
    v_mfma_f32_16x16x32_bf16 v[116:119], v[20:23], v[56:59], 0
    ds_read_b128 v[48:51], v9 offset:2048
    s_add_u32 m0, s60, 0xe000
    s_add_u32 s14, s64, 0x10100
    buffer_load_dwordx4 v14, s[20:23], s14 offen lds
    v_mfma_f32_16x16x32_bf16 v[120:123], v[24:27], v[56:59], 0
    v_mfma_f32_16x16x32_bf16 v[124:127], v[28:31], v[56:59], 0
    ds_read_b128 v[52:55], v9 offset:4096
    ds_read_b128 v[56:59], v9 offset:6144
    s_waitcnt lgkmcnt(3)
    v_mfma_f32_16x16x32_bf16 v[64:67], v[32:35], v[60:63], v[64:67]
    v_mfma_f32_16x16x32_bf16 v[68:71], v[36:39], v[60:63], v[68:71]
    v_mfma_f32_16x16x32_bf16 v[72:75], v[40:43], v[60:63], v[72:75]
    v_mfma_f32_16x16x32_bf16 v[76:79], v[44:47], v[60:63], v[76:79]
    s_waitcnt lgkmcnt(2)
    v_mfma_f32_16x16x32_bf16 v[80:83], v[32:35], v[48:51], v[80:83]
    v_mfma_f32_16x16x32_bf16 v[84:87], v[36:39], v[48:51], v[84:87]
    v_mfma_f32_16x16x32_bf16 v[88:91], v[40:43], v[48:51], v[88:91]
    v_mfma_f32_16x16x32_bf16 v[92:95], v[44:47], v[48:51], v[92:95]
    s_cmp_lt_u32 s3, 4
    s_cbranch_scc1 concat_fftw_4
    s_cmp_lg_u32 s2, 0
    s_cbranch_scc1 concat_plain_3
concat_fftw_4:
    s_waitcnt vmcnt(9) lgkmcnt(0)
    s_barrier
    s_setprio 3
    v_mfma_f32_16x16x32_bf16 v[96:99], v[32:35], v[52:55], v[96:99]
    ds_read_b64_tr_b16 v[16:17], v0 offset:32768
    v_mfma_f32_16x16x32_bf16 v[100:103], v[36:39], v[52:55], v[100:103]
    ds_read_b64_tr_b16 v[18:19], v0 offset:33792
    s_add_u32 m0, s60, 0x1c000
    s_add_u32 s14, s62, 0x180000
    buffer_load_dwordx4 v15, s[32:35], s14 offen lds
    v_cvt_pk_bf16_f32 v128, v128, v129
    v_cvt_pk_bf16_f32 v129, v130, v131
    v_mfma_f32_16x16x32_bf16 v[104:107], v[40:43], v[52:55], v[104:107]
    ds_read_b64_tr_b16 v[20:21], v3 offset:32768
    v_mfma_f32_16x16x32_bf16 v[108:111], v[44:47], v[52:55], v[108:111]
    ds_read_b64_tr_b16 v[22:23], v3 offset:33792
    v_cvt_pk_bf16_f32 v130, v132, v133
    ds_read_b64_tr_b16 v[24:25], v10 offset:32768
    v_mfma_f32_16x16x32_bf16 v[112:115], v[32:35], v[56:59], v[112:115]
    ds_read_b64_tr_b16 v[26:27], v10 offset:33792
    v_mfma_f32_16x16x32_bf16 v[116:119], v[36:39], v[56:59], v[116:119]
    ds_read_b64_tr_b16 v[28:29], v11 offset:32768
    s_add_u32 m0, s60, 0x1e000
    s_add_u32 s14, s62, 0x1c0000
    buffer_load_dwordx4 v15, s[32:35], s14 offen lds
    v_cvt_pk_bf16_f32 v131, v134, v135
    v_mfma_f32_16x16x32_bf16 v[120:123], v[40:43], v[56:59], v[120:123]
    ds_read_b64_tr_b16 v[30:31], v11 offset:33792
    v_mfma_f32_16x16x32_bf16 v[124:127], v[44:47], v[56:59], v[124:127]
    ds_read_b128 v[60:63], v6 offset:0
    s_add_u32 s15, s65, 0x0
    buffer_store_dwordx4 v[128:131], v2, s[36:39], s15 offen sc1
    ds_read_b128 v[48:51], v6 offset:2048
    s_setprio 2
    s_waitcnt lgkmcnt(1)
    v_mfma_f32_16x16x32_bf16 v[64:67], v[16:19], v[60:63], v[64:67]
    v_mfma_f32_16x16x32_bf16 v[68:71], v[20:23], v[60:63], v[68:71]
    ds_read_b128 v[52:55], v6 offset:4096
    s_add_u32 m0, s60, 0x10000
    s_add_u32 s14, s63, 0x180
    buffer_load_dwordx4 v14, s[20:23], s14 offen lds
    v_cvt_pk_bf16_f32 v136, v136, v137
    v_cvt_pk_bf16_f32 v137, v138, v139
    v_mfma_f32_16x16x32_bf16 v[72:75], v[24:27], v[60:63], v[72:75]
    v_mfma_f32_16x16x32_bf16 v[76:79], v[28:31], v[60:63], v[76:79]
    ds_read_b128 v[56:59], v6 offset:6144
    v_cvt_pk_bf16_f32 v138, v140, v141
    ds_read_b64_tr_b16 v[32:33], v0 offset:40960
    s_waitcnt lgkmcnt(3)
    v_mfma_f32_16x16x32_bf16 v[80:83], v[16:19], v[48:51], v[80:83]
    v_mfma_f32_16x16x32_bf16 v[84:87], v[20:23], v[48:51], v[84:87]
    ds_read_b64_tr_b16 v[34:35], v0 offset:41984
    s_add_u32 m0, s60, 0x12000
    s_add_u32 s14, s63, 0x10180
    buffer_load_dwordx4 v14, s[20:23], s14 offen lds
    v_cvt_pk_bf16_f32 v139, v142, v143
    v_mfma_f32_16x16x32_bf16 v[88:91], v[24:27], v[48:51], v[88:91]
    v_mfma_f32_16x16x32_bf16 v[92:95], v[28:31], v[48:51], v[92:95]
    ds_read_b64_tr_b16 v[36:37], v3 offset:40960
    s_add_u32 s15, s65, 0x1000
    buffer_store_dwordx4 v[136:139], v2, s[36:39], s15 offen sc1
    ds_read_b64_tr_b16 v[38:39], v3 offset:41984
    s_setprio 1
    s_waitcnt lgkmcnt(5)
    v_mfma_f32_16x16x32_bf16 v[96:99], v[16:19], v[52:55], v[96:99]
    v_mfma_f32_16x16x32_bf16 v[100:103], v[20:23], v[52:55], v[100:103]
    ds_read_b64_tr_b16 v[40:41], v10 offset:40960
    s_add_u32 m0, s60, 0x14000
    s_add_u32 s14, s64, 0x180
    buffer_load_dwordx4 v14, s[20:23], s14 offen lds
    v_cvt_pk_bf16_f32 v224, v224, v225
    v_cvt_pk_bf16_f32 v225, v226, v227
    v_mfma_f32_16x16x32_bf16 v[104:107], v[24:27], v[52:55], v[104:107]
    v_mfma_f32_16x16x32_bf16 v[108:111], v[28:31], v[52:55], v[108:111]
    ds_read_b64_tr_b16 v[42:43], v10 offset:41984
    v_cvt_pk_bf16_f32 v226, v228, v229
    ds_read_b64_tr_b16 v[44:45], v11 offset:40960
    s_waitcnt lgkmcnt(7)
    v_mfma_f32_16x16x32_bf16 v[112:115], v[16:19], v[56:59], v[112:115]
    v_mfma_f32_16x16x32_bf16 v[116:119], v[20:23], v[56:59], v[116:119]
    ds_read_b64_tr_b16 v[46:47], v11 offset:41984
    s_add_u32 m0, s60, 0x16000
    s_add_u32 s14, s64, 0x10180
    buffer_load_dwordx4 v14, s[20:23], s14 offen lds
    v_cvt_pk_bf16_f32 v227, v230, v231
    v_mfma_f32_16x16x32_bf16 v[120:123], v[24:27], v[56:59], v[120:123]
    v_mfma_f32_16x16x32_bf16 v[124:127], v[28:31], v[56:59], v[124:127]
    ds_read_b128 v[60:63], v7 offset:0
    s_add_u32 s15, s66, 0x8000
    buffer_store_dwordx4 v[224:227], v2, s[36:39], s15 offen sc1
    ds_read_b128 v[48:51], v7 offset:2048
    s_setprio 0
    s_waitcnt lgkmcnt(1)
    v_mfma_f32_16x16x32_bf16 v[64:67], v[32:35], v[60:63], v[64:67]
    v_mfma_f32_16x16x32_bf16 v[68:71], v[36:39], v[60:63], v[68:71]
    ds_read_b128 v[52:55], v7 offset:4096
    v_cvt_pk_bf16_f32 v232, v232, v233
    v_cvt_pk_bf16_f32 v233, v234, v235
    v_mfma_f32_16x16x32_bf16 v[72:75], v[40:43], v[60:63], v[72:75]
    v_mfma_f32_16x16x32_bf16 v[76:79], v[44:47], v[60:63], v[76:79]
    ds_read_b128 v[56:59], v7 offset:6144
    v_cvt_pk_bf16_f32 v234, v236, v237
    s_waitcnt lgkmcnt(2)
    v_mfma_f32_16x16x32_bf16 v[80:83], v[32:35], v[48:51], v[80:83]
    v_mfma_f32_16x16x32_bf16 v[84:87], v[36:39], v[48:51], v[84:87]
    v_cvt_pk_bf16_f32 v235, v238, v239
    v_mfma_f32_16x16x32_bf16 v[88:91], v[40:43], v[48:51], v[88:91]
    v_mfma_f32_16x16x32_bf16 v[92:95], v[44:47], v[48:51], v[92:95]
    s_add_u32 s15, s66, 0x8400
    buffer_store_dwordx4 v[232:235], v2, s[36:39], s15 offen sc1
    s_waitcnt vmcnt(10) lgkmcnt(0)
    s_barrier
    s_setprio 3
    v_mfma_f32_16x16x32_bf16 v[96:99], v[32:35], v[52:55], v[96:99]
    ds_read_b64_tr_b16 v[16:17], v0 offset:0
    v_mfma_f32_16x16x32_bf16 v[100:103], v[36:39], v[52:55], v[100:103]
    ds_read_b64_tr_b16 v[18:19], v0 offset:1024
    s_add_u32 m0, s60, 0x20000
    s_add_u32 s14, s62, 0x200000
    buffer_load_dwordx4 v15, s[32:35], s14 offen lds
    v_lshrrev_b32 v4, 2, v1
    v_lshlrev_b32 v4, 9, v4
    v_and_b32 v5, 3, v1
    v_lshl_add_u32 v4, v5, 3, v4
    s_lshl_b32 s14, s3, 6
    s_add_u32 s14, s14, 0x24000
    v_add_u32 v4, s14, v4
    ds_read_b64_tr_b16 v[132:133], v4 offset:0
    ds_read_b64_tr_b16 v[134:135], v4 offset:8192
    ds_read_b64_tr_b16 v[136:137], v4 offset:32
    ds_read_b64_tr_b16 v[138:139], v4 offset:8224
    s_add_u32 s76, s12, 0x4c00000
    s_addc_u32 s77, s13, 0
    s_mov_b32 s78, 0x400000
    s_mov_b32 s79, 0x20000
    v_cvt_pk_bf16_f32 v240, v240, v241
    v_cvt_pk_bf16_f32 v241, v242, v243
    v_mfma_f32_16x16x32_bf16 v[104:107], v[40:43], v[52:55], v[104:107]
    ds_read_b64_tr_b16 v[20:21], v3 offset:0
    v_mfma_f32_16x16x32_bf16 v[108:111], v[44:47], v[52:55], v[108:111]
    ds_read_b64_tr_b16 v[22:23], v3 offset:1024
    v_cvt_pk_bf16_f32 v242, v244, v245
    ds_read_b64_tr_b16 v[24:25], v10 offset:0
    v_mfma_f32_16x16x32_bf16 v[112:115], v[32:35], v[56:59], v[112:115]
    ds_read_b64_tr_b16 v[26:27], v10 offset:1024
    v_mfma_f32_16x16x32_bf16 v[116:119], v[36:39], v[56:59], v[116:119]
    ds_read_b64_tr_b16 v[28:29], v11 offset:0
    s_add_u32 m0, s60, 0x22000
    s_add_u32 s14, s62, 0x240000
    buffer_load_dwordx4 v15, s[32:35], s14 offen lds
    v_cvt_pk_bf16_f32 v243, v246, v247
    v_mfma_f32_16x16x32_bf16 v[120:123], v[40:43], v[56:59], v[120:123]
    ds_read_b64_tr_b16 v[30:31], v11 offset:1024
    v_mfma_f32_16x16x32_bf16 v[124:127], v[44:47], v[56:59], v[124:127]
    ds_read_b128 v[60:63], v6 offset:32768
    s_add_u32 s15, s66, 0xa000
    buffer_store_dwordx4 v[240:243], v2, s[36:39], s15 offen sc1
    ds_read_b128 v[48:51], v6 offset:34816
    s_setprio 2
    s_waitcnt lgkmcnt(1)
    v_mfma_f32_16x16x32_bf16 v[64:67], v[16:19], v[60:63], v[64:67]
    v_mfma_f32_16x16x32_bf16 v[68:71], v[20:23], v[60:63], v[68:71]
    ds_read_b128 v[52:55], v6 offset:36864
    s_add_u32 m0, s60, 0x0
    s_add_u32 s14, s63, 0x200
    buffer_load_dwordx4 v14, s[20:23], s14 offen lds
    v_cvt_pk_bf16_f32 v248, v248, v249
    v_cvt_pk_bf16_f32 v249, v250, v251
    v_mfma_f32_16x16x32_bf16 v[72:75], v[24:27], v[60:63], v[72:75]
    v_mfma_f32_16x16x32_bf16 v[76:79], v[28:31], v[60:63], v[76:79]
    ds_read_b128 v[56:59], v6 offset:38912
    v_cvt_pk_bf16_f32 v250, v252, v253
    ds_read_b64_tr_b16 v[32:33], v0 offset:8192
    s_waitcnt lgkmcnt(3)
    v_mfma_f32_16x16x32_bf16 v[80:83], v[16:19], v[48:51], v[80:83]
    v_mfma_f32_16x16x32_bf16 v[84:87], v[20:23], v[48:51], v[84:87]
    ds_read_b64_tr_b16 v[34:35], v0 offset:9216
    s_add_u32 m0, s60, 0x2000
    s_add_u32 s14, s63, 0x10200
    buffer_load_dwordx4 v14, s[20:23], s14 offen lds
    v_cvt_pk_bf16_f32 v251, v254, v255
    v_mfma_f32_16x16x32_bf16 v[88:91], v[24:27], v[48:51], v[88:91]
    v_mfma_f32_16x16x32_bf16 v[92:95], v[28:31], v[48:51], v[92:95]
    ds_read_b64_tr_b16 v[36:37], v3 offset:8192
    s_add_u32 s15, s66, 0xa400
    buffer_store_dwordx4 v[248:251], v2, s[36:39], s15 offen sc1
    ds_read_b64_tr_b16 v[38:39], v3 offset:9216
    s_setprio 1
    s_waitcnt lgkmcnt(5)
    v_mfma_f32_16x16x32_bf16 v[96:99], v[16:19], v[52:55], v[96:99]
    v_mfma_f32_16x16x32_bf16 v[100:103], v[20:23], v[52:55], v[100:103]
    ds_read_b64_tr_b16 v[40:41], v10 offset:8192
    s_add_u32 m0, s60, 0x4000
    s_add_u32 s14, s64, 0x200
    buffer_load_dwordx4 v14, s[20:23], s14 offen lds
    s_lshl_b32 s14, s2, 3
    s_add_u32 s14, s14, 4096
    s_add_u32 s14, s14, s7
    v_mov_b32 v4, s6
    v_mov_b32 v5, s6
    buffer_store_dwordx2 v[4:5], off, s[8:11], s14 sc1
    v_cvt_pk_bf16_f32 v144, v144, v145
    v_cvt_pk_bf16_f32 v145, v146, v147
    v_mfma_f32_16x16x32_bf16 v[104:107], v[24:27], v[52:55], v[104:107]
    v_mfma_f32_16x16x32_bf16 v[108:111], v[28:31], v[52:55], v[108:111]
    ds_read_b64_tr_b16 v[42:43], v10 offset:9216
    v_cvt_pk_bf16_f32 v146, v148, v149
    ds_read_b64_tr_b16 v[44:45], v11 offset:8192
    s_waitcnt lgkmcnt(7)
    v_mfma_f32_16x16x32_bf16 v[112:115], v[16:19], v[56:59], v[112:115]
    v_mfma_f32_16x16x32_bf16 v[116:119], v[20:23], v[56:59], v[116:119]
    ds_read_b64_tr_b16 v[46:47], v11 offset:9216
    s_add_u32 m0, s60, 0x6000
    s_add_u32 s14, s64, 0x10200
    buffer_load_dwordx4 v14, s[20:23], s14 offen lds
    v_cvt_pk_bf16_f32 v147, v150, v151
    v_mfma_f32_16x16x32_bf16 v[120:123], v[24:27], v[56:59], v[120:123]
    v_mfma_f32_16x16x32_bf16 v[124:127], v[28:31], v[56:59], v[124:127]
    ds_read_b128 v[60:63], v7 offset:32768
    s_add_u32 s15, s65, 0x2000
    buffer_store_dwordx4 v[144:147], v2, s[36:39], s15 offen sc1
    ds_read_b128 v[48:51], v7 offset:34816
    s_setprio 0
    s_waitcnt lgkmcnt(1)
    v_mfma_f32_16x16x32_bf16 v[64:67], v[32:35], v[60:63], v[64:67]
    v_mfma_f32_16x16x32_bf16 v[68:71], v[36:39], v[60:63], v[68:71]
    ds_read_b128 v[52:55], v7 offset:36864
    v_cvt_pk_bf16_f32 v152, v152, v153
    v_cvt_pk_bf16_f32 v153, v154, v155
    v_mfma_f32_16x16x32_bf16 v[72:75], v[40:43], v[60:63], v[72:75]
    v_mfma_f32_16x16x32_bf16 v[76:79], v[44:47], v[60:63], v[76:79]
    ds_read_b128 v[56:59], v7 offset:38912
    v_cvt_pk_bf16_f32 v154, v156, v157
    s_waitcnt lgkmcnt(2)
    v_mfma_f32_16x16x32_bf16 v[80:83], v[32:35], v[48:51], v[80:83]
    v_mfma_f32_16x16x32_bf16 v[84:87], v[36:39], v[48:51], v[84:87]
    v_cvt_pk_bf16_f32 v155, v158, v159
    v_mfma_f32_16x16x32_bf16 v[88:91], v[40:43], v[48:51], v[88:91]
    v_mfma_f32_16x16x32_bf16 v[92:95], v[44:47], v[48:51], v[92:95]
    s_add_u32 s15, s65, 0x3000
    buffer_store_dwordx4 v[152:155], v2, s[36:39], s15 offen sc1
    s_and_b32 s14, s2, 1
    s_lshl_b32 s14, s14, 2
    s_lshr_b32 s15, s3, 1
    s_add_u32 s14, s14, s15
    s_lshl_b32 s14, s14, 7
    s_lshr_b32 s15, s2, 1
    s_add_u32 s14, s14, s15
    s_lshl_b32 s14, s14, 1
    s_and_b32 s15, s3, 1
    s_add_u32 s14, s14, s15
    s_lshl_b32 s14, s14, 11
    buffer_store_dwordx4 v[132:135], v2, s[76:79], s14 offen offset:0 sc1
    buffer_store_dwordx4 v[136:139], v2, s[76:79], s14 offen offset:1024 sc1
    s_waitcnt vmcnt(15) lgkmcnt(0)
    s_barrier
    s_setprio 3
    v_mfma_f32_16x16x32_bf16 v[96:99], v[32:35], v[52:55], v[96:99]
    ds_read_b64_tr_b16 v[16:17], v0 offset:16384
    v_mfma_f32_16x16x32_bf16 v[100:103], v[36:39], v[52:55], v[100:103]
    ds_read_b64_tr_b16 v[18:19], v0 offset:17408
    s_add_u32 m0, s60, 0x18000
    s_add_u32 s14, s62, 0x280000
    buffer_load_dwordx4 v15, s[32:35], s14 offen lds
    v_cvt_pk_bf16_f32 v160, v160, v161
    v_cvt_pk_bf16_f32 v161, v162, v163
    v_mfma_f32_16x16x32_bf16 v[104:107], v[40:43], v[52:55], v[104:107]
    ds_read_b64_tr_b16 v[20:21], v3 offset:16384
    v_mfma_f32_16x16x32_bf16 v[108:111], v[44:47], v[52:55], v[108:111]
    ds_read_b64_tr_b16 v[22:23], v3 offset:17408
    v_cvt_pk_bf16_f32 v162, v164, v165
    ds_read_b64_tr_b16 v[24:25], v10 offset:16384
    v_mfma_f32_16x16x32_bf16 v[112:115], v[32:35], v[56:59], v[112:115]
    ds_read_b64_tr_b16 v[26:27], v10 offset:17408
    v_mfma_f32_16x16x32_bf16 v[116:119], v[36:39], v[56:59], v[116:119]
    ds_read_b64_tr_b16 v[28:29], v11 offset:16384
    s_add_u32 m0, s60, 0x1a000
    s_add_u32 s14, s62, 0x2c0000
    buffer_load_dwordx4 v15, s[32:35], s14 offen lds
    v_cvt_pk_bf16_f32 v163, v166, v167
    v_mfma_f32_16x16x32_bf16 v[120:123], v[40:43], v[56:59], v[120:123]
    ds_read_b64_tr_b16 v[30:31], v11 offset:17408
    v_mfma_f32_16x16x32_bf16 v[124:127], v[44:47], v[56:59], v[124:127]
    ds_read_b128 v[60:63], v8 offset:0
    s_add_u32 s15, s65, 0x8000
    buffer_store_dwordx4 v[160:163], v2, s[36:39], s15 offen sc1
    ds_read_b128 v[48:51], v8 offset:2048
    s_setprio 2
    s_waitcnt lgkmcnt(1)
    v_mfma_f32_16x16x32_bf16 v[64:67], v[16:19], v[60:63], v[64:67]
    v_mfma_f32_16x16x32_bf16 v[68:71], v[20:23], v[60:63], v[68:71]
    ds_read_b128 v[52:55], v8 offset:4096
    s_add_u32 m0, s60, 0x8000
    s_add_u32 s14, s63, 0x280
    buffer_load_dwordx4 v14, s[20:23], s14 offen lds
    v_cvt_pk_bf16_f32 v168, v168, v169
    v_cvt_pk_bf16_f32 v169, v170, v171
    v_mfma_f32_16x16x32_bf16 v[72:75], v[24:27], v[60:63], v[72:75]
    v_mfma_f32_16x16x32_bf16 v[76:79], v[28:31], v[60:63], v[76:79]
    ds_read_b128 v[56:59], v8 offset:6144
    v_cvt_pk_bf16_f32 v170, v172, v173
    ds_read_b64_tr_b16 v[32:33], v0 offset:24576
    s_waitcnt lgkmcnt(3)
    v_mfma_f32_16x16x32_bf16 v[80:83], v[16:19], v[48:51], v[80:83]
    v_mfma_f32_16x16x32_bf16 v[84:87], v[20:23], v[48:51], v[84:87]
    ds_read_b64_tr_b16 v[34:35], v0 offset:25600
    s_add_u32 m0, s60, 0xa000
    s_add_u32 s14, s63, 0x10280
    buffer_load_dwordx4 v14, s[20:23], s14 offen lds
    v_cvt_pk_bf16_f32 v171, v174, v175
    v_mfma_f32_16x16x32_bf16 v[88:91], v[24:27], v[48:51], v[88:91]
    v_mfma_f32_16x16x32_bf16 v[92:95], v[28:31], v[48:51], v[92:95]
    ds_read_b64_tr_b16 v[36:37], v3 offset:24576
    s_add_u32 s15, s65, 0x9000
    buffer_store_dwordx4 v[168:171], v2, s[36:39], s15 offen sc1
    ds_read_b64_tr_b16 v[38:39], v3 offset:25600
    s_setprio 1
    s_waitcnt lgkmcnt(5)
    v_mfma_f32_16x16x32_bf16 v[96:99], v[16:19], v[52:55], v[96:99]
    v_mfma_f32_16x16x32_bf16 v[100:103], v[20:23], v[52:55], v[100:103]
    ds_read_b64_tr_b16 v[40:41], v10 offset:24576
    s_add_u32 m0, s60, 0xc000
    s_add_u32 s14, s64, 0x280
    buffer_load_dwordx4 v14, s[20:23], s14 offen lds
    v_cvt_pk_bf16_f32 v176, v176, v177
    v_cvt_pk_bf16_f32 v177, v178, v179
    v_mfma_f32_16x16x32_bf16 v[104:107], v[24:27], v[52:55], v[104:107]
    v_mfma_f32_16x16x32_bf16 v[108:111], v[28:31], v[52:55], v[108:111]
    ds_read_b64_tr_b16 v[42:43], v10 offset:25600
    v_cvt_pk_bf16_f32 v178, v180, v181
    ds_read_b64_tr_b16 v[44:45], v11 offset:24576
    s_waitcnt lgkmcnt(7)
    v_mfma_f32_16x16x32_bf16 v[112:115], v[16:19], v[56:59], v[112:115]
    v_mfma_f32_16x16x32_bf16 v[116:119], v[20:23], v[56:59], v[116:119]
    ds_read_b64_tr_b16 v[46:47], v11 offset:25600
    s_add_u32 m0, s60, 0xe000
    s_add_u32 s14, s64, 0x10280
    buffer_load_dwordx4 v14, s[20:23], s14 offen lds
    v_cvt_pk_bf16_f32 v179, v182, v183
    v_mfma_f32_16x16x32_bf16 v[120:123], v[24:27], v[56:59], v[120:123]
    v_mfma_f32_16x16x32_bf16 v[124:127], v[28:31], v[56:59], v[124:127]
    ds_read_b128 v[60:63], v9 offset:0
    s_add_u32 s15, s65, 0xa000
    buffer_store_dwordx4 v[176:179], v2, s[36:39], s15 offen sc1
    ds_read_b128 v[48:51], v9 offset:2048
    s_setprio 0
    s_waitcnt lgkmcnt(1)
    v_mfma_f32_16x16x32_bf16 v[64:67], v[32:35], v[60:63], v[64:67]
    v_mfma_f32_16x16x32_bf16 v[68:71], v[36:39], v[60:63], v[68:71]
    ds_read_b128 v[52:55], v9 offset:4096
    v_cvt_pk_bf16_f32 v184, v184, v185
    v_cvt_pk_bf16_f32 v185, v186, v187
    v_mfma_f32_16x16x32_bf16 v[72:75], v[40:43], v[60:63], v[72:75]
    v_mfma_f32_16x16x32_bf16 v[76:79], v[44:47], v[60:63], v[76:79]
    ds_read_b128 v[56:59], v9 offset:6144
    v_cvt_pk_bf16_f32 v186, v188, v189
    s_waitcnt lgkmcnt(2)
    v_mfma_f32_16x16x32_bf16 v[80:83], v[32:35], v[48:51], v[80:83]
    v_mfma_f32_16x16x32_bf16 v[84:87], v[36:39], v[48:51], v[84:87]
    v_cvt_pk_bf16_f32 v187, v190, v191
    v_mfma_f32_16x16x32_bf16 v[88:91], v[40:43], v[48:51], v[88:91]
    v_mfma_f32_16x16x32_bf16 v[92:95], v[44:47], v[48:51], v[92:95]
    s_add_u32 s15, s65, 0xb000
    buffer_store_dwordx4 v[184:187], v2, s[36:39], s15 offen sc1
    s_waitcnt vmcnt(14) lgkmcnt(0)
    s_barrier
    s_setprio 3
    v_mfma_f32_16x16x32_bf16 v[96:99], v[32:35], v[52:55], v[96:99]
    ds_read_b64_tr_b16 v[16:17], v0 offset:32768
    v_mfma_f32_16x16x32_bf16 v[100:103], v[36:39], v[52:55], v[100:103]
    ds_read_b64_tr_b16 v[18:19], v0 offset:33792
    s_add_u32 m0, s60, 0x1c000
    s_add_u32 s14, s62, 0x300000
    buffer_load_dwordx4 v15, s[32:35], s14 offen lds
    v_cvt_pk_bf16_f32 v192, v192, v193
    v_cvt_pk_bf16_f32 v193, v194, v195
    v_mfma_f32_16x16x32_bf16 v[104:107], v[40:43], v[52:55], v[104:107]
    ds_read_b64_tr_b16 v[20:21], v3 offset:32768
    v_mfma_f32_16x16x32_bf16 v[108:111], v[44:47], v[52:55], v[108:111]
    ds_read_b64_tr_b16 v[22:23], v3 offset:33792
    v_cvt_pk_bf16_f32 v194, v196, v197
    ds_read_b64_tr_b16 v[24:25], v10 offset:32768
    v_mfma_f32_16x16x32_bf16 v[112:115], v[32:35], v[56:59], v[112:115]
    ds_read_b64_tr_b16 v[26:27], v10 offset:33792
    v_mfma_f32_16x16x32_bf16 v[116:119], v[36:39], v[56:59], v[116:119]
    ds_read_b64_tr_b16 v[28:29], v11 offset:32768
    s_add_u32 m0, s60, 0x1e000
    s_add_u32 s14, s62, 0x340000
    buffer_load_dwordx4 v15, s[32:35], s14 offen lds
    v_cvt_pk_bf16_f32 v195, v198, v199
    v_mfma_f32_16x16x32_bf16 v[120:123], v[40:43], v[56:59], v[120:123]
    ds_read_b64_tr_b16 v[30:31], v11 offset:33792
    v_mfma_f32_16x16x32_bf16 v[124:127], v[44:47], v[56:59], v[124:127]
    ds_read_b128 v[60:63], v6 offset:0
    s_add_u32 s15, s66, 0x0
    buffer_store_dwordx4 v[192:195], v2, s[36:39], s15 offen sc1
    ds_read_b128 v[48:51], v6 offset:2048
    s_setprio 2
    s_waitcnt lgkmcnt(1)
    v_mfma_f32_16x16x32_bf16 v[64:67], v[16:19], v[60:63], v[64:67]
    v_mfma_f32_16x16x32_bf16 v[68:71], v[20:23], v[60:63], v[68:71]
    ds_read_b128 v[52:55], v6 offset:4096
    s_add_u32 m0, s60, 0x10000
    s_add_u32 s14, s63, 0x300
    buffer_load_dwordx4 v14, s[20:23], s14 offen lds
    v_cvt_pk_bf16_f32 v200, v200, v201
    v_cvt_pk_bf16_f32 v201, v202, v203
    v_mfma_f32_16x16x32_bf16 v[72:75], v[24:27], v[60:63], v[72:75]
    v_mfma_f32_16x16x32_bf16 v[76:79], v[28:31], v[60:63], v[76:79]
    ds_read_b128 v[56:59], v6 offset:6144
    v_cvt_pk_bf16_f32 v202, v204, v205
    ds_read_b64_tr_b16 v[32:33], v0 offset:40960
    s_waitcnt lgkmcnt(3)
    v_mfma_f32_16x16x32_bf16 v[80:83], v[16:19], v[48:51], v[80:83]
    v_mfma_f32_16x16x32_bf16 v[84:87], v[20:23], v[48:51], v[84:87]
    ds_read_b64_tr_b16 v[34:35], v0 offset:41984
    s_add_u32 m0, s60, 0x12000
    s_add_u32 s14, s63, 0x10300
    buffer_load_dwordx4 v14, s[20:23], s14 offen lds
    v_cvt_pk_bf16_f32 v203, v206, v207
    v_mfma_f32_16x16x32_bf16 v[88:91], v[24:27], v[48:51], v[88:91]
    v_mfma_f32_16x16x32_bf16 v[92:95], v[28:31], v[48:51], v[92:95]
    ds_read_b64_tr_b16 v[36:37], v3 offset:40960
    s_add_u32 s15, s66, 0x400
    buffer_store_dwordx4 v[200:203], v2, s[36:39], s15 offen sc1
    ds_read_b64_tr_b16 v[38:39], v3 offset:41984
    s_setprio 1
    s_waitcnt lgkmcnt(5)
    v_mfma_f32_16x16x32_bf16 v[96:99], v[16:19], v[52:55], v[96:99]
    v_mfma_f32_16x16x32_bf16 v[100:103], v[20:23], v[52:55], v[100:103]
    ds_read_b64_tr_b16 v[40:41], v10 offset:40960
    s_add_u32 m0, s60, 0x14000
    s_add_u32 s14, s64, 0x300
    buffer_load_dwordx4 v14, s[20:23], s14 offen lds
    v_cvt_pk_bf16_f32 v208, v208, v209
    v_cvt_pk_bf16_f32 v209, v210, v211
    v_mfma_f32_16x16x32_bf16 v[104:107], v[24:27], v[52:55], v[104:107]
    v_mfma_f32_16x16x32_bf16 v[108:111], v[28:31], v[52:55], v[108:111]
    ds_read_b64_tr_b16 v[42:43], v10 offset:41984
    v_cvt_pk_bf16_f32 v210, v212, v213
    ds_read_b64_tr_b16 v[44:45], v11 offset:40960
    s_waitcnt lgkmcnt(7)
    v_mfma_f32_16x16x32_bf16 v[112:115], v[16:19], v[56:59], v[112:115]
    v_mfma_f32_16x16x32_bf16 v[116:119], v[20:23], v[56:59], v[116:119]
    ds_read_b64_tr_b16 v[46:47], v11 offset:41984
    s_add_u32 m0, s60, 0x16000
    s_add_u32 s14, s64, 0x10300
    buffer_load_dwordx4 v14, s[20:23], s14 offen lds
    v_cvt_pk_bf16_f32 v211, v214, v215
    v_mfma_f32_16x16x32_bf16 v[120:123], v[24:27], v[56:59], v[120:123]
    v_mfma_f32_16x16x32_bf16 v[124:127], v[28:31], v[56:59], v[124:127]
    ds_read_b128 v[60:63], v7 offset:0
    s_add_u32 s15, s66, 0x2000
    buffer_store_dwordx4 v[208:211], v2, s[36:39], s15 offen sc1
    ds_read_b128 v[48:51], v7 offset:2048
    s_setprio 0
    s_waitcnt lgkmcnt(1)
    v_mfma_f32_16x16x32_bf16 v[64:67], v[32:35], v[60:63], v[64:67]
    v_mfma_f32_16x16x32_bf16 v[68:71], v[36:39], v[60:63], v[68:71]
    ds_read_b128 v[52:55], v7 offset:4096
    v_cvt_pk_bf16_f32 v216, v216, v217
    v_cvt_pk_bf16_f32 v217, v218, v219
    v_mfma_f32_16x16x32_bf16 v[72:75], v[40:43], v[60:63], v[72:75]
    v_mfma_f32_16x16x32_bf16 v[76:79], v[44:47], v[60:63], v[76:79]
    ds_read_b128 v[56:59], v7 offset:6144
    v_cvt_pk_bf16_f32 v218, v220, v221
    s_waitcnt lgkmcnt(2)
    v_mfma_f32_16x16x32_bf16 v[80:83], v[32:35], v[48:51], v[80:83]
    v_mfma_f32_16x16x32_bf16 v[84:87], v[36:39], v[48:51], v[84:87]
    v_cvt_pk_bf16_f32 v219, v222, v223
    v_mfma_f32_16x16x32_bf16 v[88:91], v[40:43], v[48:51], v[88:91]
    v_mfma_f32_16x16x32_bf16 v[92:95], v[44:47], v[48:51], v[92:95]
    s_add_u32 s15, s66, 0x2400
    buffer_store_dwordx4 v[216:219], v2, s[36:39], s15 offen sc1
    s_waitcnt vmcnt(12) lgkmcnt(0)
    s_barrier
    s_setprio 3
    v_mfma_f32_16x16x32_bf16 v[96:99], v[32:35], v[52:55], v[96:99]
    ds_read_b64_tr_b16 v[16:17], v0 offset:0
    v_mfma_f32_16x16x32_bf16 v[100:103], v[36:39], v[52:55], v[100:103]
    ds_read_b64_tr_b16 v[18:19], v0 offset:1024
    s_add_u32 m0, s60, 0x20000
    s_add_u32 s14, s62, 0x380000
    buffer_load_dwordx4 v15, s[32:35], s14 offen lds
    s_add_u32 s40, s12, 0x4000000
    s_addc_u32 s41, s13, 0
    s_mov_b32 s42, 0x200000
    s_mov_b32 s43, 0x20000
    s_add_u32 s44, s12, 0x4200000
    s_addc_u32 s45, s13, 0
    s_mov_b32 s46, 0x200000
    s_mov_b32 s47, 0x20000
    s_add_u32 s48, s12, 0x4400000
    s_addc_u32 s49, s13, 0
    s_mov_b32 s50, 0x202000
    s_mov_b32 s51, 0x20000
    s_and_b32 s54, s3, 3
    s_lshl_b32 s52, s2, 13
    s_add_u32 s53, s52, 64
    s_mov_b32 s58, s52
    s_add_u32 s59, s52, 0x1000
    s_mov_b32 s56, s52
    s_mov_b32 s55, 0x3ab504f3
    s_cmp_eq_u32 s2, 0
    s_cselect_b32 s53, 0x40000000, s53
    s_cselect_b32 s59, 0x40000000, s59
    s_cselect_b32 s55, 0x3a800000, s55
    s_bitcmp1_b32 s3, 2
    s_cselect_b32 s52, 64, s52
    s_cselect_b32 s58, 0x1000, s58
    s_cselect_b32 s56, 0x200000, s56
    v_and_b32 v228, 15, v1
    v_lshrrev_b32 v229, 4, v1
    v_lshrrev_b32 v246, 2, v228
    v_lshl_add_u32 v246, v229, 4, v246
    s_lshl_b32 s57, s54, 2
    v_add_u32 v246, s57, v246
    v_lshlrev_b32 v246, 7, v246
    v_and_b32 v247, 3, v1
    v_lshl_add_u32 v246, v247, 4, v246
    v_add_u32 v247, s57, v229
    v_lshlrev_b32 v247, 9, v247
    v_lshl_add_u32 v247, v228, 4, v247
    v_cvt_f32_u32 v228, v228
    v_lshlrev_b32 v229, 2, v229
    v_cvt_f32_u32 v229, v229
    s_lshl_b32 s57, s54, 4
    v_cvt_f32_u32 v236, s57
    v_add_f32 v230, 0x00000000, v228
    v_mul_f32 v230, 0x3d000000, v230
    v_mul_f32 v231, v230, v229
    v_fmamk_f32 v236, v230, 0x00000000, v231
    v_mfma_f32_16x16x32_bf16 v[104:107], v[40:43], v[52:55], v[104:107]
    ds_read_b64_tr_b16 v[20:21], v3 offset:0
    v_mfma_f32_16x16x32_bf16 v[108:111], v[44:47], v[52:55], v[108:111]
    ds_read_b64_tr_b16 v[22:23], v3 offset:1024
    v_fmamk_f32 v237, v230, 0x3f800000, v231
    v_cos_f32 v238, v236
    v_cos_f32 v239, v237
    v_sin_f32 v244, v236
    ds_read_b64_tr_b16 v[24:25], v10 offset:0
    v_mfma_f32_16x16x32_bf16 v[112:115], v[32:35], v[56:59], v[112:115]
    ds_read_b64_tr_b16 v[26:27], v10 offset:1024
    v_mfma_f32_16x16x32_bf16 v[116:119], v[36:39], v[56:59], v[116:119]
    ds_read_b64_tr_b16 v[28:29], v11 offset:0
    s_add_u32 m0, s60, 0x22000
    s_add_u32 s14, s62, 0x3c0000
    buffer_load_dwordx4 v15, s[32:35], s14 offen lds
    v_sin_f32 v245, v237
    v_mul_f32 v238, s55, v238
    v_mul_f32 v239, s55, v239
    v_mul_f32 v244, s55, v244
    v_mul_f32 v245, s55, v245
    v_mfma_f32_16x16x32_bf16 v[120:123], v[40:43], v[56:59], v[120:123]
    ds_read_b64_tr_b16 v[30:31], v11 offset:1024
    v_mfma_f32_16x16x32_bf16 v[124:127], v[44:47], v[56:59], v[124:127]
    ds_read_b128 v[60:63], v6 offset:32768
    v_cvt_pk_bf16_f32 v128, v238, v239
    v_cvt_pk_bf16_f32 v136, v244, v245
    v_fmamk_f32 v236, v230, 0x40000000, v231
    v_fmamk_f32 v237, v230, 0x40400000, v231
    ds_read_b128 v[48:51], v6 offset:34816
    s_setprio 2
    s_waitcnt lgkmcnt(1)
    v_mfma_f32_16x16x32_bf16 v[64:67], v[16:19], v[60:63], v[64:67]
    v_mfma_f32_16x16x32_bf16 v[68:71], v[20:23], v[60:63], v[68:71]
    ds_read_b128 v[52:55], v6 offset:36864
    s_add_u32 m0, s60, 0x0
    s_add_u32 s14, s63, 0x380
    buffer_load_dwordx4 v14, s[20:23], s14 offen lds
    v_cos_f32 v238, v236
    v_cos_f32 v239, v237
    v_sin_f32 v244, v236
    v_sin_f32 v245, v237
    v_mul_f32 v238, s55, v238
    v_mfma_f32_16x16x32_bf16 v[72:75], v[24:27], v[60:63], v[72:75]
    v_mfma_f32_16x16x32_bf16 v[76:79], v[28:31], v[60:63], v[76:79]
    ds_read_b128 v[56:59], v6 offset:38912
    v_mul_f32 v239, s55, v239
    v_mul_f32 v244, s55, v244
    v_mul_f32 v245, s55, v245
    v_cvt_pk_bf16_f32 v129, v238, v239
    ds_read_b64_tr_b16 v[32:33], v0 offset:8192
    s_waitcnt lgkmcnt(3)
    v_mfma_f32_16x16x32_bf16 v[80:83], v[16:19], v[48:51], v[80:83]
    v_mfma_f32_16x16x32_bf16 v[84:87], v[20:23], v[48:51], v[84:87]
    ds_read_b64_tr_b16 v[34:35], v0 offset:9216
    s_add_u32 m0, s60, 0x2000
    s_add_u32 s14, s63, 0x10380
    buffer_load_dwordx4 v14, s[20:23], s14 offen lds
    v_cvt_pk_bf16_f32 v137, v244, v245
    v_fmamk_f32 v236, v230, 0x41800000, v231
    v_fmamk_f32 v237, v230, 0x41880000, v231
    v_cos_f32 v238, v236
    v_cos_f32 v239, v237
    v_mfma_f32_16x16x32_bf16 v[88:91], v[24:27], v[48:51], v[88:91]
    v_mfma_f32_16x16x32_bf16 v[92:95], v[28:31], v[48:51], v[92:95]
    ds_read_b64_tr_b16 v[36:37], v3 offset:8192
    v_sin_f32 v244, v236
    v_sin_f32 v245, v237
    v_mul_f32 v238, s55, v238
    v_mul_f32 v239, s55, v239
    ds_read_b64_tr_b16 v[38:39], v3 offset:9216
    s_setprio 1
    s_waitcnt lgkmcnt(5)
    v_mfma_f32_16x16x32_bf16 v[96:99], v[16:19], v[52:55], v[96:99]
    v_mfma_f32_16x16x32_bf16 v[100:103], v[20:23], v[52:55], v[100:103]
    ds_read_b64_tr_b16 v[40:41], v10 offset:8192
    s_add_u32 m0, s60, 0x4000
    s_add_u32 s14, s64, 0x380
    buffer_load_dwordx4 v14, s[20:23], s14 offen lds
    v_mul_f32 v244, s55, v244
    v_mul_f32 v245, s55, v245
    v_cvt_pk_bf16_f32 v130, v238, v239
    v_cvt_pk_bf16_f32 v138, v244, v245
    v_fmamk_f32 v236, v230, 0x41900000, v231
    v_mfma_f32_16x16x32_bf16 v[104:107], v[24:27], v[52:55], v[104:107]
    v_mfma_f32_16x16x32_bf16 v[108:111], v[28:31], v[52:55], v[108:111]
    ds_read_b64_tr_b16 v[42:43], v10 offset:9216
    v_fmamk_f32 v237, v230, 0x41980000, v231
    v_cos_f32 v238, v236
    v_cos_f32 v239, v237
    v_sin_f32 v244, v236
    ds_read_b64_tr_b16 v[44:45], v11 offset:8192
    s_waitcnt lgkmcnt(7)
    v_mfma_f32_16x16x32_bf16 v[112:115], v[16:19], v[56:59], v[112:115]
    v_mfma_f32_16x16x32_bf16 v[116:119], v[20:23], v[56:59], v[116:119]
    ds_read_b64_tr_b16 v[46:47], v11 offset:9216
    s_add_u32 m0, s60, 0x6000
    s_add_u32 s14, s64, 0x10380
    buffer_load_dwordx4 v14, s[20:23], s14 offen lds
    v_sin_f32 v245, v237
    v_mul_f32 v238, s55, v238
    v_mul_f32 v239, s55, v239
    v_mul_f32 v244, s55, v244
    v_mul_f32 v245, s55, v245
    v_mfma_f32_16x16x32_bf16 v[120:123], v[24:27], v[56:59], v[120:123]
    v_mfma_f32_16x16x32_bf16 v[124:127], v[28:31], v[56:59], v[124:127]
    ds_read_b128 v[60:63], v7 offset:32768
    v_cvt_pk_bf16_f32 v131, v238, v239
    v_cvt_pk_bf16_f32 v139, v244, v245
    s_lshl_b32 s57, s54, 4
    v_cvt_f32_u32 v236, s57
    v_add_f32 v230, 0x41800000, v228
    v_mul_f32 v230, 0x3d000000, v230
    v_mul_f32 v231, v230, v229
    v_fmamk_f32 v236, v230, 0x00000000, v231
    ds_read_b128 v[48:51], v7 offset:34816
    s_setprio 0
    s_waitcnt lgkmcnt(1)
    v_mfma_f32_16x16x32_bf16 v[64:67], v[32:35], v[60:63], v[64:67]
    v_mfma_f32_16x16x32_bf16 v[68:71], v[36:39], v[60:63], v[68:71]
    ds_read_b128 v[52:55], v7 offset:36864
    v_fmamk_f32 v237, v230, 0x3f800000, v231
    v_cos_f32 v238, v236
    v_cos_f32 v239, v237
    v_sin_f32 v244, v236
    v_sin_f32 v245, v237
    v_mfma_f32_16x16x32_bf16 v[72:75], v[40:43], v[60:63], v[72:75]
    v_mfma_f32_16x16x32_bf16 v[76:79], v[44:47], v[60:63], v[76:79]
    ds_read_b128 v[56:59], v7 offset:38912
    v_mul_f32 v238, s55, v238
    v_mul_f32 v239, s55, v239
    v_mul_f32 v244, s55, v244
    v_mul_f32 v245, s55, v245
    s_waitcnt lgkmcnt(2)
    v_mfma_f32_16x16x32_bf16 v[80:83], v[32:35], v[48:51], v[80:83]
    v_mfma_f32_16x16x32_bf16 v[84:87], v[36:39], v[48:51], v[84:87]
    v_cvt_pk_bf16_f32 v132, v238, v239
    v_cvt_pk_bf16_f32 v140, v244, v245
    v_fmamk_f32 v236, v230, 0x40000000, v231
    v_fmamk_f32 v237, v230, 0x40400000, v231
    v_cos_f32 v238, v236
    v_mfma_f32_16x16x32_bf16 v[88:91], v[40:43], v[48:51], v[88:91]
    v_mfma_f32_16x16x32_bf16 v[92:95], v[44:47], v[48:51], v[92:95]
    v_cos_f32 v239, v237
    v_sin_f32 v244, v236
    v_sin_f32 v245, v237
    v_mul_f32 v238, s55, v238
    s_waitcnt vmcnt(8) lgkmcnt(0)
    s_barrier
    s_setprio 3
    v_mfma_f32_16x16x32_bf16 v[96:99], v[32:35], v[52:55], v[96:99]
    ds_read_b64_tr_b16 v[16:17], v0 offset:16384
    v_mfma_f32_16x16x32_bf16 v[100:103], v[36:39], v[52:55], v[100:103]
    ds_read_b64_tr_b16 v[18:19], v0 offset:17408
    v_mul_f32 v239, s55, v239
    v_mul_f32 v244, s55, v244
    v_mul_f32 v245, s55, v245
    v_cvt_pk_bf16_f32 v133, v238, v239
    v_cvt_pk_bf16_f32 v141, v244, v245
    v_mfma_f32_16x16x32_bf16 v[104:107], v[40:43], v[52:55], v[104:107]
    ds_read_b64_tr_b16 v[20:21], v3 offset:16384
    v_mfma_f32_16x16x32_bf16 v[108:111], v[44:47], v[52:55], v[108:111]
    ds_read_b64_tr_b16 v[22:23], v3 offset:17408
    v_fmamk_f32 v236, v230, 0x41800000, v231
    v_fmamk_f32 v237, v230, 0x41880000, v231
    v_cos_f32 v238, v236
    v_cos_f32 v239, v237
    ds_read_b64_tr_b16 v[24:25], v10 offset:16384
    v_mfma_f32_16x16x32_bf16 v[112:115], v[32:35], v[56:59], v[112:115]
    ds_read_b64_tr_b16 v[26:27], v10 offset:17408
    v_mfma_f32_16x16x32_bf16 v[116:119], v[36:39], v[56:59], v[116:119]
    ds_read_b64_tr_b16 v[28:29], v11 offset:16384
    v_sin_f32 v244, v236
    v_sin_f32 v245, v237
    v_mul_f32 v238, s55, v238
    v_mul_f32 v239, s55, v239
    v_mul_f32 v244, s55, v244
    v_mfma_f32_16x16x32_bf16 v[120:123], v[40:43], v[56:59], v[120:123]
    ds_read_b64_tr_b16 v[30:31], v11 offset:17408
    v_mfma_f32_16x16x32_bf16 v[124:127], v[44:47], v[56:59], v[124:127]
    ds_read_b128 v[60:63], v8 offset:0
    v_mul_f32 v245, s55, v245
    v_cvt_pk_bf16_f32 v134, v238, v239
    v_cvt_pk_bf16_f32 v142, v244, v245
    v_fmamk_f32 v236, v230, 0x41900000, v231
    ds_read_b128 v[48:51], v8 offset:2048
    s_setprio 2
    s_waitcnt lgkmcnt(1)
    v_mfma_f32_16x16x32_bf16 v[64:67], v[16:19], v[60:63], v[64:67]
    v_mfma_f32_16x16x32_bf16 v[68:71], v[20:23], v[60:63], v[68:71]
    ds_read_b128 v[52:55], v8 offset:4096
    v_fmamk_f32 v237, v230, 0x41980000, v231
    v_cos_f32 v238, v236
    v_cos_f32 v239, v237
    v_sin_f32 v244, v236
    v_sin_f32 v245, v237
    v_mfma_f32_16x16x32_bf16 v[72:75], v[24:27], v[60:63], v[72:75]
    v_mfma_f32_16x16x32_bf16 v[76:79], v[28:31], v[60:63], v[76:79]
    ds_read_b128 v[56:59], v8 offset:6144
    v_mul_f32 v238, s55, v238
    v_mul_f32 v239, s55, v239
    v_mul_f32 v244, s55, v244
    v_mul_f32 v245, s55, v245
    ds_read_b64_tr_b16 v[32:33], v0 offset:24576
    s_waitcnt lgkmcnt(3)
    v_mfma_f32_16x16x32_bf16 v[80:83], v[16:19], v[48:51], v[80:83]
    v_mfma_f32_16x16x32_bf16 v[84:87], v[20:23], v[48:51], v[84:87]
    ds_read_b64_tr_b16 v[34:35], v0 offset:25600
    v_cvt_pk_bf16_f32 v135, v238, v239
    v_cvt_pk_bf16_f32 v143, v244, v245
    s_lshl_b32 s57, s54, 4
    v_cvt_f32_u32 v236, s57
    v_add_f32 v230, v228, v236
    v_mul_f32 v230, 0x3c800000, v230
    v_mul_f32 v231, v230, v229
    v_fmamk_f32 v236, v230, 0x00000000, v231
    v_fmamk_f32 v237, v230, 0x3f800000, v231
    v_mfma_f32_16x16x32_bf16 v[88:91], v[24:27], v[48:51], v[88:91]
    v_mfma_f32_16x16x32_bf16 v[92:95], v[28:31], v[48:51], v[92:95]
    ds_read_b64_tr_b16 v[36:37], v3 offset:24576
    v_cos_f32 v238, v236
    v_cos_f32 v239, v237
    v_sin_f32 v244, v236
    v_sin_f32 v245, v237
    ds_read_b64_tr_b16 v[38:39], v3 offset:25600
    s_setprio 1
    s_waitcnt lgkmcnt(5)
    v_mfma_f32_16x16x32_bf16 v[96:99], v[16:19], v[52:55], v[96:99]
    v_mfma_f32_16x16x32_bf16 v[100:103], v[20:23], v[52:55], v[100:103]
    ds_read_b64_tr_b16 v[40:41], v10 offset:24576
    v_cvt_pk_bf16_f32 v144, v238, v239
    v_cvt_pk_bf16_f32 v152, v244, v245
    v_fmamk_f32 v236, v230, 0x40000000, v231
    v_fmamk_f32 v237, v230, 0x40400000, v231
    v_cos_f32 v238, v236
    v_mfma_f32_16x16x32_bf16 v[104:107], v[24:27], v[52:55], v[104:107]
    v_mfma_f32_16x16x32_bf16 v[108:111], v[28:31], v[52:55], v[108:111]
    ds_read_b64_tr_b16 v[42:43], v10 offset:25600
    v_cos_f32 v239, v237
    v_sin_f32 v244, v236
    v_sin_f32 v245, v237
    v_cvt_pk_bf16_f32 v145, v238, v239
    ds_read_b64_tr_b16 v[44:45], v11 offset:24576
    s_waitcnt lgkmcnt(7)
    v_mfma_f32_16x16x32_bf16 v[112:115], v[16:19], v[56:59], v[112:115]
    v_mfma_f32_16x16x32_bf16 v[116:119], v[20:23], v[56:59], v[116:119]
    ds_read_b64_tr_b16 v[46:47], v11 offset:25600
    v_cvt_pk_bf16_f32 v153, v244, v245
    v_fmamk_f32 v236, v230, 0x41800000, v231
    v_fmamk_f32 v237, v230, 0x41880000, v231
    v_cos_f32 v238, v236
    v_cos_f32 v239, v237
    v_mfma_f32_16x16x32_bf16 v[120:123], v[24:27], v[56:59], v[120:123]
    v_mfma_f32_16x16x32_bf16 v[124:127], v[28:31], v[56:59], v[124:127]
    ds_read_b128 v[60:63], v9 offset:0
    v_sin_f32 v244, v236
    v_sin_f32 v245, v237
    v_cvt_pk_bf16_f32 v146, v238, v239
    v_cvt_pk_bf16_f32 v154, v244, v245
    ds_read_b128 v[48:51], v9 offset:2048
    s_setprio 0
    s_waitcnt lgkmcnt(1)
    v_mfma_f32_16x16x32_bf16 v[64:67], v[32:35], v[60:63], v[64:67]
    v_mfma_f32_16x16x32_bf16 v[68:71], v[36:39], v[60:63], v[68:71]
    ds_read_b128 v[52:55], v9 offset:4096
    v_fmamk_f32 v236, v230, 0x41900000, v231
    v_fmamk_f32 v237, v230, 0x41980000, v231
    v_cos_f32 v238, v236
    v_cos_f32 v239, v237
    v_sin_f32 v244, v236
    v_mfma_f32_16x16x32_bf16 v[72:75], v[40:43], v[60:63], v[72:75]
    v_mfma_f32_16x16x32_bf16 v[76:79], v[44:47], v[60:63], v[76:79]
    ds_read_b128 v[56:59], v9 offset:6144
    v_sin_f32 v245, v237
    v_cvt_pk_bf16_f32 v147, v238, v239
    v_cvt_pk_bf16_f32 v155, v244, v245
    v_fmamk_f32 v236, v230, 0x42000000, v231
    s_waitcnt lgkmcnt(2)
    v_mfma_f32_16x16x32_bf16 v[80:83], v[32:35], v[48:51], v[80:83]
    v_mfma_f32_16x16x32_bf16 v[84:87], v[36:39], v[48:51], v[84:87]
    v_fmamk_f32 v237, v230, 0x42040000, v231
    v_cos_f32 v238, v236
    v_cos_f32 v239, v237
    v_sin_f32 v244, v236
    v_sin_f32 v245, v237
    v_mfma_f32_16x16x32_bf16 v[88:91], v[40:43], v[48:51], v[88:91]
    v_mfma_f32_16x16x32_bf16 v[92:95], v[44:47], v[48:51], v[92:95]
    v_cvt_pk_bf16_f32 v148, v238, v239
    v_cvt_pk_bf16_f32 v156, v244, v245
    v_fmamk_f32 v236, v230, 0x42080000, v231
    v_fmamk_f32 v237, v230, 0x420c0000, v231
    v_lshlrev_b32 v248, 3, v1
    s_mov_b32 s15, 4096
    buffer_load_dwordx2 v[252:253], v248, s[8:11], s15 offen offset:0 sc1
    buffer_load_dwordx2 v[254:255], v248, s[8:11], s15 offen offset:512 sc1
    buffer_load_dwordx2 v[14:15], v248, s[8:11], s15 offen offset:1024 sc1
    buffer_load_dwordx2 v[12:13], v248, s[8:11], s15 offen offset:1536 sc1
    s_waitcnt vmcnt(4) lgkmcnt(0)
    s_barrier
    s_setprio 3
    v_mfma_f32_16x16x32_bf16 v[96:99], v[32:35], v[52:55], v[96:99]
    ds_read_b64_tr_b16 v[16:17], v0 offset:32768
    v_mfma_f32_16x16x32_bf16 v[100:103], v[36:39], v[52:55], v[100:103]
    ds_read_b64_tr_b16 v[18:19], v0 offset:33792
    s_lshl_b32 s14, s4, 7
    s_lshl_b32 s15, s5, 3
    s_add_u32 s14, s14, s15
    s_add_u32 s14, s14, 12288
    s_add_u32 s14, s14, s7
    v_mov_b32 v4, s6
    v_mov_b32 v5, s6
    buffer_store_dwordx2 v[4:5], off, s[8:11], s14 sc1
    v_cos_f32 v238, v236
    v_cos_f32 v239, v237
    v_sin_f32 v244, v236
    v_sin_f32 v245, v237
    v_mfma_f32_16x16x32_bf16 v[104:107], v[40:43], v[52:55], v[104:107]
    ds_read_b64_tr_b16 v[20:21], v3 offset:32768
    v_mfma_f32_16x16x32_bf16 v[108:111], v[44:47], v[52:55], v[108:111]
    ds_read_b64_tr_b16 v[22:23], v3 offset:33792
    v_cvt_pk_bf16_f32 v149, v238, v239
    v_cvt_pk_bf16_f32 v157, v244, v245
    v_fmamk_f32 v236, v230, 0x42400000, v231
    v_fmamk_f32 v237, v230, 0x42440000, v231
    v_cos_f32 v238, v236
    ds_read_b64_tr_b16 v[24:25], v10 offset:32768
    v_mfma_f32_16x16x32_bf16 v[112:115], v[32:35], v[56:59], v[112:115]
    ds_read_b64_tr_b16 v[26:27], v10 offset:33792
    v_mfma_f32_16x16x32_bf16 v[116:119], v[36:39], v[56:59], v[116:119]
    ds_read_b64_tr_b16 v[28:29], v11 offset:32768
    v_cos_f32 v239, v237
    v_sin_f32 v244, v236
    v_sin_f32 v245, v237
    v_cvt_pk_bf16_f32 v150, v238, v239
    v_mfma_f32_16x16x32_bf16 v[120:123], v[40:43], v[56:59], v[120:123]
    ds_read_b64_tr_b16 v[30:31], v11 offset:33792
    v_mfma_f32_16x16x32_bf16 v[124:127], v[44:47], v[56:59], v[124:127]
    ds_read_b128 v[60:63], v6 offset:0
    v_cvt_pk_bf16_f32 v158, v244, v245
    v_fmamk_f32 v236, v230, 0x42480000, v231
    v_fmamk_f32 v237, v230, 0x424c0000, v231
    v_cos_f32 v238, v236
    v_cos_f32 v239, v237
    ds_read_b128 v[48:51], v6 offset:2048
    s_setprio 2
    s_waitcnt lgkmcnt(1)
    v_mfma_f32_16x16x32_bf16 v[64:67], v[16:19], v[60:63], v[64:67]
    v_mfma_f32_16x16x32_bf16 v[68:71], v[20:23], v[60:63], v[68:71]
    ds_read_b128 v[52:55], v6 offset:4096
    v_sin_f32 v244, v236
    v_sin_f32 v245, v237
    v_cvt_pk_bf16_f32 v151, v238, v239
    v_cvt_pk_bf16_f32 v159, v244, v245
    s_lshl_b32 s57, s54, 4
    v_cvt_f32_u32 v236, s57
    v_add_f32 v230, 0x00000000, v228
    v_mul_f32 v230, 0x3a000000, v230
    v_add_f32 v236, v236, v229
    v_mul_f32 v231, v230, v236
    v_mfma_f32_16x16x32_bf16 v[72:75], v[24:27], v[60:63], v[72:75]
    v_mfma_f32_16x16x32_bf16 v[76:79], v[28:31], v[60:63], v[76:79]
    ds_read_b128 v[56:59], v6 offset:6144
    v_fmamk_f32 v236, v230, 0x00000000, v231
    v_fmamk_f32 v237, v230, 0x3f800000, v231
    v_fmamk_f32 v238, v230, 0x40000000, v231
    v_fmamk_f32 v239, v230, 0x40400000, v231
    ds_read_b64_tr_b16 v[32:33], v0 offset:40960
    s_waitcnt lgkmcnt(3)
    v_mfma_f32_16x16x32_bf16 v[80:83], v[16:19], v[48:51], v[80:83]
    v_mfma_f32_16x16x32_bf16 v[84:87], v[20:23], v[48:51], v[84:87]
    ds_read_b64_tr_b16 v[34:35], v0 offset:41984
    v_cos_f32 v160, v236
    v_sin_f32 v168, v236
    v_cos_f32 v161, v237
    v_sin_f32 v169, v237
    v_cos_f32 v162, v238
    v_mfma_f32_16x16x32_bf16 v[88:91], v[24:27], v[48:51], v[88:91]
    v_mfma_f32_16x16x32_bf16 v[92:95], v[28:31], v[48:51], v[92:95]
    ds_read_b64_tr_b16 v[36:37], v3 offset:40960
    v_sin_f32 v170, v238
    v_cos_f32 v163, v239
    v_sin_f32 v171, v239
    s_lshl_b32 s57, s54, 4
    v_cvt_f32_u32 v236, s57
    v_add_f32 v230, 0x41800000, v228
    v_mul_f32 v230, 0x3a000000, v230
    v_add_f32 v236, v236, v229
    v_mul_f32 v231, v230, v236
    ds_read_b64_tr_b16 v[38:39], v3 offset:41984
    s_setprio 1
    s_waitcnt lgkmcnt(5)
    v_mfma_f32_16x16x32_bf16 v[96:99], v[16:19], v[52:55], v[96:99]
    v_mfma_f32_16x16x32_bf16 v[100:103], v[20:23], v[52:55], v[100:103]
    ds_read_b64_tr_b16 v[40:41], v10 offset:40960
    v_fmamk_f32 v236, v230, 0x00000000, v231
    v_fmamk_f32 v237, v230, 0x3f800000, v231
    v_fmamk_f32 v238, v230, 0x40000000, v231
    v_fmamk_f32 v239, v230, 0x40400000, v231
    v_cos_f32 v164, v236
    v_mfma_f32_16x16x32_bf16 v[104:107], v[24:27], v[52:55], v[104:107]
    v_mfma_f32_16x16x32_bf16 v[108:111], v[28:31], v[52:55], v[108:111]
    ds_read_b64_tr_b16 v[42:43], v10 offset:41984
    v_sin_f32 v172, v236
    v_cos_f32 v165, v237
    v_sin_f32 v173, v237
    v_cos_f32 v166, v238
    v_sin_f32 v174, v238
    ds_read_b64_tr_b16 v[44:45], v11 offset:40960
    s_waitcnt lgkmcnt(7)
    v_mfma_f32_16x16x32_bf16 v[112:115], v[16:19], v[56:59], v[112:115]
    v_mfma_f32_16x16x32_bf16 v[116:119], v[20:23], v[56:59], v[116:119]
    ds_read_b64_tr_b16 v[46:47], v11 offset:41984
    v_cos_f32 v167, v239
    v_sin_f32 v175, v239
    s_lshl_b32 s57, s54, 4
    v_cvt_f32_u32 v236, s57
    v_add_f32 v230, v228, v236
    v_mul_f32 v230, 0x3a000000, v230
    v_mul_f32 v231, v230, v229
    v_fmamk_f32 v236, v230, 0x00000000, v231
    v_mfma_f32_16x16x32_bf16 v[120:123], v[24:27], v[56:59], v[120:123]
    v_mfma_f32_16x16x32_bf16 v[124:127], v[28:31], v[56:59], v[124:127]
    ds_read_b128 v[60:63], v7 offset:0
    v_fmamk_f32 v237, v230, 0x3f800000, v231
    v_fmamk_f32 v238, v230, 0x40000000, v231
    v_fmamk_f32 v239, v230, 0x40400000, v231
    v_cos_f32 v176, v236
    v_sin_f32 v184, v236
    ds_read_b128 v[48:51], v7 offset:2048
    s_setprio 0
    s_waitcnt lgkmcnt(1)
    v_mfma_f32_16x16x32_bf16 v[64:67], v[32:35], v[60:63], v[64:67]
    v_mfma_f32_16x16x32_bf16 v[68:71], v[36:39], v[60:63], v[68:71]
    ds_read_b128 v[52:55], v7 offset:4096
    v_cos_f32 v177, v237
    v_sin_f32 v185, v237
    v_cos_f32 v178, v238
    v_sin_f32 v186, v238
    v_cos_f32 v179, v239
    v_mfma_f32_16x16x32_bf16 v[72:75], v[40:43], v[60:63], v[72:75]
    v_mfma_f32_16x16x32_bf16 v[76:79], v[44:47], v[60:63], v[76:79]
    ds_read_b128 v[56:59], v7 offset:6144
    v_sin_f32 v187, v239
    v_fmamk_f32 v236, v230, 0x41800000, v231
    v_fmamk_f32 v237, v230, 0x41880000, v231
    v_fmamk_f32 v238, v230, 0x41900000, v231
    s_waitcnt lgkmcnt(2)
    v_mfma_f32_16x16x32_bf16 v[80:83], v[32:35], v[48:51], v[80:83]
    v_mfma_f32_16x16x32_bf16 v[84:87], v[36:39], v[48:51], v[84:87]
    v_fmamk_f32 v239, v230, 0x41980000, v231
    v_cos_f32 v180, v236
    v_sin_f32 v188, v236
    v_cos_f32 v181, v237
    v_sin_f32 v189, v237
    v_mfma_f32_16x16x32_bf16 v[88:91], v[40:43], v[48:51], v[88:91]
    v_mfma_f32_16x16x32_bf16 v[92:95], v[44:47], v[48:51], v[92:95]
    v_cos_f32 v182, v238
    v_sin_f32 v190, v238
    v_cos_f32 v183, v239
    v_sin_f32 v191, v239
    s_waitcnt vmcnt(1)
    v_xor_b32 v252, s6, v252
    v_xor_b32 v253, s6, v253
    v_xor_b32 v254, s6, v254
    v_xor_b32 v255, s6, v255
    v_xor_b32 v14, s6, v14
    v_xor_b32 v15, s6, v15
    v_xor_b32 v12, s6, v12
    v_xor_b32 v13, s6, v13
    v_or_b32 v252, v252, v253
    v_or_b32 v252, v252, v255
    v_or_b32 v252, v252, v254
    v_or_b32 v252, v252, v15
    v_or_b32 v252, v252, v14
    v_or_b32 v252, v252, v13
    v_or_b32 v252, v252, v12
    v_cmp_ne_u32 vcc, 0, v252
    s_nop 0
    s_cbranch_vccnz concat_pslow_6
concat_pback_7:
    buffer_load_dwordx4 v[196:199], v246, s[40:43], s52 offen sc1
    buffer_load_dwordx4 v[204:207], v246, s[40:43], s53 offen sc1
    buffer_load_dwordx4 v[212:215], v247, s[48:51], s56 offen offset:0 sc1
    buffer_load_dwordx4 v[220:223], v247, s[48:51], s56 offen offset:256 sc1
    s_waitcnt lgkmcnt(0)
    s_barrier
    s_setprio 3
    v_mfma_f32_16x16x32_bf16 v[96:99], v[32:35], v[52:55], v[96:99]
    v_mfma_f32_16x16x32_bf16 v[100:103], v[36:39], v[52:55], v[100:103]
    s_and_b32 s20, s3, 3
    s_lshr_b32 s21, s3, 2
    s_lshl_b32 s14, s5, 1
    s_add_u32 s23, s14, 2
    s_sub_u32 s24, 15, s14
    s_cmp_eq_u32 s21, 0
    s_cselect_b32 s24, 0, s24
    s_cselect_b32 s23, s23, 30
    s_cselect_b32 s25, s14, 15
    s_lshl_b32 s26, s4, 20
    s_lshl_b32 s14, s20, 12
    s_add_u32 s26, s26, s14
    s_lshl_b32 s27, s21, 16
    v_add_u32 v3, s27, v2
    s_add_u32 s27, s27, s14
    s_lshl_b32 s33, 1, s23
    s_lshr_b32 s32, s33, 1
    s_lshl_b32 s34, 3, s25
    s_lshr_b32 s34, s34, 1
    s_or_b32 s34, s34, s32
    s_or_b32 s34, s34, s33
    s_cmp_eq_u32 s3, 0
    s_cselect_b32 s71, 0x600, 0
    s_or_b32 s34, s34, s71
    s_lshl_b32 s14, s20, 13
    s_add_u32 s14, s14, 0x20000
    s_mov_b32 s75, s14
    v_and_b32 v11, 7, v1
    v_lshlrev_b32 v11, 3, v11
    s_lshl_b32 s74, s4, 7
    s_add_u32 s74, s74, 12288
    v_mfma_f32_16x16x32_bf16 v[104:107], v[40:43], v[52:55], v[104:107]
    v_mfma_f32_16x16x32_bf16 v[108:111], v[44:47], v[52:55], v[108:111]
    v_mfma_f32_16x16x32_bf16 v[112:115], v[32:35], v[56:59], v[112:115]
    v_mfma_f32_16x16x32_bf16 v[116:119], v[36:39], v[56:59], v[116:119]
    v_mfma_f32_16x16x32_bf16 v[120:123], v[40:43], v[56:59], v[120:123]
    v_mfma_f32_16x16x32_bf16 v[124:127], v[44:47], v[56:59], v[124:127]
hand_1:
    s_setprio 0
    v_mul_f32 v64, s73, v64
    v_mul_f32 v65, s73, v65
    v_cvt_pk_bf16_f32 v64, v64, v65
    v_mul_f32 v66, s73, v66
    v_mul_f32 v67, s73, v67
    v_cvt_pk_bf16_f32 v65, v66, v67
    v_mul_f32 v68, s73, v68
    v_mul_f32 v69, s73, v69
    v_cvt_pk_bf16_f32 v66, v68, v69
    v_mul_f32 v70, s73, v70
    v_mul_f32 v71, s73, v71
    v_cvt_pk_bf16_f32 v67, v70, v71
    v_mul_f32 v72, s73, v72
    v_mul_f32 v73, s73, v73
    v_cvt_pk_bf16_f32 v68, v72, v73
    v_mul_f32 v74, s73, v74
    v_mul_f32 v75, s73, v75
    v_cvt_pk_bf16_f32 v69, v74, v75
    v_mul_f32 v76, s73, v76
    v_mul_f32 v77, s73, v77
    v_cvt_pk_bf16_f32 v70, v76, v77
    v_mul_f32 v78, s73, v78
    v_mul_f32 v79, s73, v79
    v_cvt_pk_bf16_f32 v71, v78, v79
    v_mul_f32 v80, s73, v80
    v_mul_f32 v81, s73, v81
    v_cvt_pk_bf16_f32 v72, v80, v81
    v_mul_f32 v82, s73, v82
    v_mul_f32 v83, s73, v83
    v_cvt_pk_bf16_f32 v73, v82, v83
    v_mul_f32 v84, s73, v84
    v_mul_f32 v85, s73, v85
    v_cvt_pk_bf16_f32 v74, v84, v85
    v_mul_f32 v86, s73, v86
    v_mul_f32 v87, s73, v87
    v_cvt_pk_bf16_f32 v75, v86, v87
    v_mul_f32 v88, s73, v88
    v_mul_f32 v89, s73, v89
    v_cvt_pk_bf16_f32 v76, v88, v89
    v_mul_f32 v90, s73, v90
    v_mul_f32 v91, s73, v91
    v_cvt_pk_bf16_f32 v77, v90, v91
    v_mul_f32 v92, s73, v92
    v_mul_f32 v93, s73, v93
    v_cvt_pk_bf16_f32 v78, v92, v93
    v_mul_f32 v94, s73, v94
    v_mul_f32 v95, s73, v95
    v_cvt_pk_bf16_f32 v79, v94, v95
    v_mul_f32 v96, s73, v96
    v_mul_f32 v97, s73, v97
    v_cvt_pk_bf16_f32 v80, v96, v97
    v_mul_f32 v98, s73, v98
    v_mul_f32 v99, s73, v99
    v_cvt_pk_bf16_f32 v81, v98, v99
    v_mul_f32 v100, s73, v100
    v_mul_f32 v101, s73, v101
    v_cvt_pk_bf16_f32 v82, v100, v101
    v_mul_f32 v102, s73, v102
    v_mul_f32 v103, s73, v103
    v_cvt_pk_bf16_f32 v83, v102, v103
    v_mul_f32 v104, s73, v104
    v_mul_f32 v105, s73, v105
    v_cvt_pk_bf16_f32 v84, v104, v105
    v_mul_f32 v106, s73, v106
    v_mul_f32 v107, s73, v107
    v_cvt_pk_bf16_f32 v85, v106, v107
    v_mul_f32 v108, s73, v108
    v_mul_f32 v109, s73, v109
    v_cvt_pk_bf16_f32 v86, v108, v109
    v_mul_f32 v110, s73, v110
    v_mul_f32 v111, s73, v111
    v_cvt_pk_bf16_f32 v87, v110, v111
    v_mul_f32 v112, s73, v112
    v_mul_f32 v113, s73, v113
    v_cvt_pk_bf16_f32 v88, v112, v113
    v_mul_f32 v114, s73, v114
    v_mul_f32 v115, s73, v115
    v_cvt_pk_bf16_f32 v89, v114, v115
    v_mul_f32 v116, s73, v116
    v_mul_f32 v117, s73, v117
    v_cvt_pk_bf16_f32 v90, v116, v117
    v_mul_f32 v118, s73, v118
    v_mul_f32 v119, s73, v119
    v_cvt_pk_bf16_f32 v91, v118, v119
    v_mul_f32 v120, s73, v120
    v_mul_f32 v121, s73, v121
    v_cvt_pk_bf16_f32 v92, v120, v121
    v_mul_f32 v122, s73, v122
    v_mul_f32 v123, s73, v123
    v_cvt_pk_bf16_f32 v93, v122, v123
    v_mul_f32 v124, s73, v124
    v_mul_f32 v125, s73, v125
    v_cvt_pk_bf16_f32 v94, v124, v125
    v_mul_f32 v126, s73, v126
    v_mul_f32 v127, s73, v127
    v_cvt_pk_bf16_f32 v95, v126, v127
    buffer_load_dwordx2 v[6:7], v11, s[8:11], s74 offen offset:0 sc1
    s_lshr_b32 s14, s20, 1
    s_lshl_b32 s15, s14, 14
    s_add_u32 s15, s15, 0x20000
    s_lshl_b32 s14, s14, 16
    s_add_u32 s14, s14, 0x8000
    s_cmp_eq_u32 s21, 0
    s_cselect_b32 s14, s14, s15
    s_and_b32 s15, s20, 1
    s_lshl_b32 s35, s15, 11
    s_add_u32 s35, s35, s14
    v_add_u32 v9, s35, v2
    v_add_u32 v5, s75, v2
    ds_write_b128 v9, v[64:67] offset:0
    ds_write_b128 v9, v[68:71] offset:1024
    ds_write_b128 v9, v[72:75] offset:4096
    ds_write_b128 v9, v[76:79] offset:5120
    ds_write_b128 v9, v[80:83] offset:8192
    ds_write_b128 v9, v[84:87] offset:9216
    ds_write_b128 v9, v[88:91] offset:12288
    ds_write_b128 v9, v[92:95] offset:13312
    s_lshl_b32 s15, s15, 13
    s_add_u32 s14, s14, s15
    v_add_u32 v9, s14, v2
    v_xor_b32 v16, 0x80008000, v136
    v_xor_b32 v17, 0x80008000, v137
    v_xor_b32 v18, 0x80008000, v138
    v_xor_b32 v19, 0x80008000, v139
    v_xor_b32 v20, 0x80008000, v140
    v_xor_b32 v21, 0x80008000, v141
    v_xor_b32 v22, 0x80008000, v142
    v_xor_b32 v23, 0x80008000, v143
    s_waitcnt vmcnt(3)
    v_mfma_f32_16x16x32_bf16 v[224:227], v[196:199], v[128:131], 0
    v_mfma_f32_16x16x32_bf16 v[232:235], v[196:199], v[16:19], 0
    v_mfma_f32_16x16x32_bf16 v[228:231], v[196:199], v[132:135], 0
    v_mfma_f32_16x16x32_bf16 v[236:239], v[196:199], v[20:23], 0
    v_mfma_f32_16x16x32_bf16 v[224:227], v[204:207], v[136:139], v[224:227]
    v_mfma_f32_16x16x32_bf16 v[232:235], v[204:207], v[128:131], v[232:235]
    v_mfma_f32_16x16x32_bf16 v[228:231], v[204:207], v[140:143], v[228:231]
    v_mfma_f32_16x16x32_bf16 v[236:239], v[204:207], v[132:135], v[236:239]
    v_xor_b32 v24, 0x80008000, v152
    v_xor_b32 v25, 0x80008000, v153
    v_xor_b32 v26, 0x80008000, v154
    v_xor_b32 v27, 0x80008000, v155
    v_xor_b32 v28, 0x80008000, v156
    v_xor_b32 v29, 0x80008000, v157
    v_xor_b32 v30, 0x80008000, v158
    v_xor_b32 v31, 0x80008000, v159
    s_lshr_b32 s57, s3, 2
    s_lshl_b32 s57, s57, 16
    v_add_u32 v13, s57, v2
    s_lshr_b32 s57, s54, 1
    s_lshl_b32 s57, s57, 7
    s_and_b32 s52, s54, 1
    s_add_u32 s57, s57, s52
    s_lshl_b32 s57, s57, 3
    v_add_u32 v12, s57, v13
    v_mul_f32 v192, v224, v160
    v_mul_f32 v194, v232, v160
    v_mul_f32 v193, v225, v161
    v_mul_f32 v195, v233, v161
    v_fma_f32 v192, v232, v168, v192
    v_fma_f32 v194, -v224, v168, v194
    v_fma_f32 v193, v233, v169, v193
    v_fma_f32 v195, -v225, v169, v195
    v_cvt_pk_bf16_f32 v240, v192, v193
    v_cvt_pk_bf16_f32 v244, v194, v195
    v_mul_f32 v252, v226, v162
    v_mul_f32 v254, v234, v162
    v_mul_f32 v253, v227, v163
    v_mul_f32 v255, v235, v163
    v_fma_f32 v252, v234, v170, v252
    v_fma_f32 v254, -v226, v170, v254
    v_fma_f32 v253, v235, v171, v253
    v_fma_f32 v255, -v227, v171, v255
    v_cvt_pk_bf16_f32 v241, v252, v253
    v_cvt_pk_bf16_f32 v245, v254, v255
    v_mul_f32 v192, v228, v164
    v_mul_f32 v194, v236, v164
    v_mul_f32 v193, v229, v165
    v_mul_f32 v195, v237, v165
    v_fma_f32 v192, v236, v172, v192
    v_fma_f32 v194, -v228, v172, v194
    v_fma_f32 v193, v237, v173, v193
    v_fma_f32 v195, -v229, v173, v195
    v_cvt_pk_bf16_f32 v242, v192, v193
    v_cvt_pk_bf16_f32 v246, v194, v195
    v_mul_f32 v252, v230, v166
    v_mul_f32 v254, v238, v166
    v_mul_f32 v253, v231, v167
    v_mul_f32 v255, v239, v167
    v_fma_f32 v252, v238, v174, v252
    v_fma_f32 v254, -v230, v174, v254
    v_fma_f32 v253, v239, v175, v253
    v_fma_f32 v255, -v231, v175, v255
    v_cvt_pk_bf16_f32 v243, v252, v253
    v_cvt_pk_bf16_f32 v247, v254, v255
    ds_write_b64 v12, v[240:241] offset:49152
    ds_write_b64 v12, v[242:243] offset:51200
    ds_write_b64 v12, v[244:245] offset:53248
    ds_write_b64 v12, v[246:247] offset:55296
    s_waitcnt lgkmcnt(0)
    s_waitcnt vmcnt(0)
    v_xor_b32 v6, s6, v6
    v_xor_b32 v7, s6, v7
    v_or_b32 v6, v6, v7
    v_cmp_ne_u32 vcc, 0, v6
    s_nop 0
    s_cbranch_vccnz concat_pslow_8
concat_pback_9:
    s_mov_b32 s22, 0
    v_add_u32 v8, 3, v1
    v_and_b32 v8, 63, v8
    v_add_u32 v4, s24, v8
    v_subrev_u32 v10, s23, v8
    v_cmp_gt_u32 vcc, s23, v8
    s_nop 1
    v_cndmask_b32 v4, v10, v4, vcc
    v_lshlrev_b32 v4, 15, v4
    v_add_u32 v4, s26, v4
    s_lshl_b32 s72, s5, 3
    s_add_u32 s72, s72, s3
    s_lshl_b32 s72, s72, 16
    s_add_u32 s72, s72, 0x4c00000
    s_add_u32 s14, s72, 20480
    v_writelane_b32 v4, s14, 14
    s_nop 0
    v_readlane_b32 s28, v4, 61
    s_add_u32 m0, s27, 0x0
    s_nop 3
    buffer_load_dwordx4 v2, s[36:39], s28 offen offset:0 sc1 lds
    buffer_load_dwordx4 v2, s[36:39], s28 offen offset:1024 sc1 lds
    buffer_load_dwordx4 v2, s[36:39], s28 offen offset:2048 sc1 lds
    buffer_load_dwordx4 v2, s[36:39], s28 offen offset:3072 sc1 lds
    s_add_u32 s75, s28, 0x4000
    v_readlane_b32 s28, v4, 62
    s_add_u32 m0, s27, 0x4000
    s_nop 3
    buffer_load_dwordx4 v2, s[36:39], s28 offen offset:0 sc1 lds
    buffer_load_dwordx4 v2, s[36:39], s28 offen offset:1024 sc1 lds
    buffer_load_dwordx4 v2, s[36:39], s28 offen offset:2048 sc1 lds
    buffer_load_dwordx4 v2, s[36:39], s28 offen offset:3072 sc1 lds
    s_add_u32 s29, s28, 0x4000
    v_mov_b32 v64, 0
    v_mov_b32 v65, 0
    v_mov_b32 v66, 0
    v_mov_b32 v67, 0
    v_mov_b32 v68, 0
    v_mov_b32 v69, 0
    v_mov_b32 v70, 0
    v_mov_b32 v71, 0
    v_mov_b32 v72, 0
    v_mov_b32 v73, 0
    v_mov_b32 v74, 0
    v_mov_b32 v75, 0
    v_mov_b32 v76, 0
    v_mov_b32 v77, 0
    v_mov_b32 v78, 0
    v_mov_b32 v79, 0
    v_mov_b32 v80, 0
    v_mov_b32 v81, 0
    v_mov_b32 v82, 0
    v_mov_b32 v83, 0
    v_mov_b32 v84, 0
    v_mov_b32 v85, 0
    v_mov_b32 v86, 0
    v_mov_b32 v87, 0
    v_mov_b32 v88, 0
    v_mov_b32 v89, 0
    v_mov_b32 v90, 0
    v_mov_b32 v91, 0
    v_mov_b32 v92, 0
    v_mov_b32 v93, 0
    v_mov_b32 v94, 0
    v_mov_b32 v95, 0
    s_barrier
    ds_read_b128 v[32:35], v9 offset:0
    ds_read_b128 v[36:39], v9 offset:1024
    ds_read_b128 v[40:43], v9 offset:2048
    ds_read_b128 v[44:47], v9 offset:3072
    ds_read_b128 v[48:51], v9 offset:4096
    ds_read_b128 v[52:55], v9 offset:5120
    ds_read_b128 v[56:59], v9 offset:6144
    ds_read_b128 v[60:63], v9 offset:7168
    ds_read_b128 v[96:99], v13 offset:49152
    ds_read_b128 v[112:115], v13 offset:53248
    ds_read_b128 v[104:107], v13 offset:51200
    ds_read_b128 v[120:123], v13 offset:55296
    ds_read_b128 v[100:103], v13 offset:50176
    ds_read_b128 v[116:119], v13 offset:54272
    ds_read_b128 v[108:111], v13 offset:52224
    s_waitcnt lgkmcnt(9)
    ds_read_b128 v[124:127], v13 offset:56320
    v_lshlrev_b32 v160, 16, v212
    v_and_b32 v168, 0xffff0000, v212
    v_lshlrev_b32 v161, 16, v213
    v_and_b32 v169, 0xffff0000, v213
    v_lshlrev_b32 v162, 16, v214
    v_and_b32 v170, 0xffff0000, v214
    v_lshlrev_b32 v163, 16, v215
    v_and_b32 v171, 0xffff0000, v215
    v_lshlrev_b32 v164, 16, v220
    v_and_b32 v172, 0xffff0000, v220
    v_lshlrev_b32 v165, 16, v221
    v_and_b32 v173, 0xffff0000, v221
    v_lshlrev_b32 v166, 16, v222
    v_and_b32 v174, 0xffff0000, v222
    v_lshlrev_b32 v167, 16, v223
    v_and_b32 v175, 0xffff0000, v223
    s_waitcnt lgkmcnt(6)
    v_mfma_f32_16x16x32_bf16 v[224:227], v[144:147], v[96:99], 0
    v_mfma_f32_16x16x32_bf16 v[232:235], v[24:27], v[96:99], 0
    v_mfma_f32_16x16x32_bf16 v[224:227], v[152:155], v[112:115], v[224:227]
    v_mfma_f32_16x16x32_bf16 v[232:235], v[144:147], v[112:115], v[232:235]
    s_waitcnt lgkmcnt(4)
    v_mfma_f32_16x16x32_bf16 v[228:231], v[144:147], v[104:107], 0
    v_mfma_f32_16x16x32_bf16 v[236:239], v[24:27], v[104:107], 0
    v_mfma_f32_16x16x32_bf16 v[228:231], v[152:155], v[120:123], v[228:231]
    v_mfma_f32_16x16x32_bf16 v[236:239], v[144:147], v[120:123], v[236:239]
    s_waitcnt lgkmcnt(2)
    v_mfma_f32_16x16x32_bf16 v[224:227], v[148:151], v[100:103], v[224:227]
    v_mfma_f32_16x16x32_bf16 v[232:235], v[28:31], v[100:103], v[232:235]
    v_mfma_f32_16x16x32_bf16 v[224:227], v[156:159], v[116:119], v[224:227]
    v_mfma_f32_16x16x32_bf16 v[232:235], v[148:151], v[116:119], v[232:235]
    s_waitcnt lgkmcnt(0)
    v_mfma_f32_16x16x32_bf16 v[228:231], v[148:151], v[108:111], v[228:231]
    v_mfma_f32_16x16x32_bf16 v[236:239], v[28:31], v[108:111], v[236:239]
    v_mfma_f32_16x16x32_bf16 v[228:231], v[156:159], v[124:127], v[228:231]
    v_mfma_f32_16x16x32_bf16 v[236:239], v[148:151], v[124:127], v[236:239]
    s_nop 1
    v_mul_f32 v192, v224, v160
    v_mul_f32 v194, v232, v160
    v_mul_f32 v193, v225, v161
    v_mul_f32 v195, v233, v161
    v_fma_f32 v192, -v232, v168, v192
    v_fma_f32 v194, v224, v168, v194
    v_fma_f32 v193, -v233, v169, v193
    v_fma_f32 v195, v225, v169, v195
    v_cvt_pk_bf16_f32 v240, v192, v193
    v_cvt_pk_bf16_f32 v244, v194, v195
    v_mul_f32 v252, v226, v162
    v_mul_f32 v254, v234, v162
    v_mul_f32 v253, v227, v163
    v_mul_f32 v255, v235, v163
    v_fma_f32 v252, -v234, v170, v252
    v_fma_f32 v254, v226, v170, v254
    v_fma_f32 v253, -v235, v171, v253
    v_fma_f32 v255, v227, v171, v255
    v_cvt_pk_bf16_f32 v241, v252, v253
    v_cvt_pk_bf16_f32 v245, v254, v255
    v_mul_f32 v192, v228, v164
    v_mul_f32 v194, v236, v164
    v_mul_f32 v193, v229, v165
    v_mul_f32 v195, v237, v165
    v_fma_f32 v192, -v236, v172, v192
    v_fma_f32 v194, v228, v172, v194
    v_fma_f32 v193, -v237, v173, v193
    v_fma_f32 v195, v229, v173, v195
    v_cvt_pk_bf16_f32 v242, v192, v193
    v_cvt_pk_bf16_f32 v246, v194, v195
    v_mul_f32 v252, v230, v166
    v_mul_f32 v254, v238, v166
    v_mul_f32 v253, v231, v167
    v_mul_f32 v255, v239, v167
    v_fma_f32 v252, -v238, v174, v252
    v_fma_f32 v254, v230, v174, v254
    v_fma_f32 v253, -v239, v175, v253
    v_fma_f32 v255, v231, v175, v255
    v_cvt_pk_bf16_f32 v243, v252, v253
    v_cvt_pk_bf16_f32 v247, v254, v255
    ds_write_b64 v12, v[240:241] offset:57344
    ds_write_b64 v12, v[242:243] offset:59392
    ds_write_b64 v12, v[244:245] offset:61440
    ds_write_b64 v12, v[246:247] offset:63488
    s_waitcnt lgkmcnt(0)
    s_barrier
    s_add_u32 m0, s27, 0x8000
    s_nop 0
    buffer_load_dwordx4 v2, s[36:39], s75 offen offset:0 sc1 lds
    buffer_load_dwordx4 v2, s[36:39], s75 offen offset:1024 sc1 lds
    buffer_load_dwordx4 v2, s[36:39], s75 offen offset:2048 sc1 lds
    buffer_load_dwordx4 v2, s[36:39], s75 offen offset:3072 sc1 lds
    ds_read_b128 v[96:99], v13 offset:57344
    ds_read_b128 v[112:115], v13 offset:61440
    ds_read_b128 v[104:107], v13 offset:59392
    ds_read_b128 v[120:123], v13 offset:63488
    ds_read_b128 v[100:103], v13 offset:58368
    ds_read_b128 v[116:119], v13 offset:62464
    ds_read_b128 v[108:111], v13 offset:60416
    ds_read_b128 v[124:127], v13 offset:64512
    s_waitcnt lgkmcnt(6)
    v_mfma_f32_16x16x32_bf16 v[224:227], v[96:99], v[144:147], 0
    v_mfma_f32_16x16x32_bf16 v[232:235], v[96:99], v[152:155], 0
    v_mfma_f32_16x16x32_bf16 v[224:227], v[112:115], v[24:27], v[224:227]
    v_mfma_f32_16x16x32_bf16 v[232:235], v[112:115], v[144:147], v[232:235]
    s_waitcnt lgkmcnt(4)
    v_mfma_f32_16x16x32_bf16 v[228:231], v[104:107], v[144:147], 0
    v_mfma_f32_16x16x32_bf16 v[236:239], v[104:107], v[152:155], 0
    v_mfma_f32_16x16x32_bf16 v[228:231], v[120:123], v[24:27], v[228:231]
    v_mfma_f32_16x16x32_bf16 v[236:239], v[120:123], v[144:147], v[236:239]
    s_waitcnt lgkmcnt(2)
    v_mfma_f32_16x16x32_bf16 v[224:227], v[100:103], v[148:151], v[224:227]
    v_mfma_f32_16x16x32_bf16 v[232:235], v[100:103], v[156:159], v[232:235]
    v_mfma_f32_16x16x32_bf16 v[224:227], v[116:119], v[28:31], v[224:227]
    v_mfma_f32_16x16x32_bf16 v[232:235], v[116:119], v[148:151], v[232:235]
    s_waitcnt lgkmcnt(0)
    v_mfma_f32_16x16x32_bf16 v[228:231], v[108:111], v[148:151], v[228:231]
    v_mfma_f32_16x16x32_bf16 v[236:239], v[108:111], v[156:159], v[236:239]
    v_mfma_f32_16x16x32_bf16 v[228:231], v[124:127], v[28:31], v[228:231]
    v_mfma_f32_16x16x32_bf16 v[236:239], v[124:127], v[148:151], v[236:239]
    s_nop 1
    v_mul_f32 v192, v224, v176
    v_mul_f32 v194, v232, v176
    v_mul_f32 v193, v225, v177
    v_mul_f32 v195, v233, v177
    v_fma_f32 v192, -v232, v184, v192
    v_fma_f32 v194, v224, v184, v194
    v_fma_f32 v193, -v233, v185, v193
    v_fma_f32 v195, v225, v185, v195
    v_cvt_pk_bf16_f32 v240, v192, v193
    v_cvt_pk_bf16_f32 v244, v194, v195
    v_mul_f32 v252, v226, v178
    v_mul_f32 v254, v234, v178
    v_mul_f32 v253, v227, v179
    v_mul_f32 v255, v235, v179
    v_fma_f32 v252, -v234, v186, v252
    v_fma_f32 v254, v226, v186, v254
    v_fma_f32 v253, -v235, v187, v253
    v_fma_f32 v255, v227, v187, v255
    v_cvt_pk_bf16_f32 v241, v252, v253
    v_cvt_pk_bf16_f32 v245, v254, v255
    v_mul_f32 v192, v228, v180
    v_mul_f32 v194, v236, v180
    v_mul_f32 v193, v229, v181
    v_mul_f32 v195, v237, v181
    v_fma_f32 v192, -v236, v188, v192
    v_fma_f32 v194, v228, v188, v194
    v_fma_f32 v193, -v237, v189, v193
    v_fma_f32 v195, v229, v189, v195
    v_cvt_pk_bf16_f32 v242, v192, v193
    v_cvt_pk_bf16_f32 v246, v194, v195
    v_mul_f32 v252, v230, v182
    v_mul_f32 v254, v238, v182
    v_mul_f32 v253, v231, v183
    v_mul_f32 v255, v239, v183
    v_fma_f32 v252, -v238, v190, v252
    v_fma_f32 v254, v230, v190, v254
    v_fma_f32 v253, -v239, v191, v253
    v_fma_f32 v255, v231, v191, v255
    v_cvt_pk_bf16_f32 v243, v252, v253
    v_cvt_pk_bf16_f32 v247, v254, v255
    s_nop 0
    v_mfma_f32_16x16x32_bf16 v[224:227], v[240:243], v[128:131], 0
    v_mfma_f32_16x16x32_bf16 v[232:235], v[240:243], v[136:139], 0
    v_mfma_f32_16x16x32_bf16 v[228:231], v[240:243], v[132:135], 0
    v_mfma_f32_16x16x32_bf16 v[236:239], v[240:243], v[140:143], 0
    v_mfma_f32_16x16x32_bf16 v[224:227], v[244:247], v[16:19], v[224:227]
    v_mfma_f32_16x16x32_bf16 v[232:235], v[244:247], v[128:131], v[232:235]
    v_mfma_f32_16x16x32_bf16 v[228:231], v[244:247], v[20:23], v[228:231]
    v_mfma_f32_16x16x32_bf16 v[236:239], v[244:247], v[132:135], v[236:239]
    s_lshl_b32 s57, s54, 10
    v_add_u32 v12, s57, v2
    s_nop 2
    v_cvt_pk_bf16_f32 v96, v224, v225
    v_cvt_pk_bf16_f32 v97, v226, v227
    v_cvt_pk_bf16_f32 v98, v228, v229
    v_cvt_pk_bf16_f32 v99, v230, v231
    buffer_store_dwordx4 v[96:99], v12, s[44:47], s58 offen sc1
    v_cvt_pk_bf16_f32 v100, v232, v233
    v_cvt_pk_bf16_f32 v101, v234, v235
    v_cvt_pk_bf16_f32 v102, v236, v237
    v_cvt_pk_bf16_f32 v103, v238, v239
    buffer_store_dwordx4 v[100:103], v12, s[44:47], s59 offen sc1
    s_load_dwordx2 s[66:67], s[0:1], 72
    s_add_u32 s16, s12, 0x3000000
    s_addc_u32 s17, s13, 0
    s_mov_b32 s18, 0x1000000
    s_mov_b32 s19, 0x20000
    s_lshl_b32 s14, s5, 2
    s_add_u32 s30, s14, s20
    s_lshl_b32 s30, s30, 5
    s_add_u32 s30, s30, s4
    s_lshl_b32 s30, s30, 13
    s_sub_u32 s31, 60, s14
    s_add_u32 s31, s31, s20
    s_lshl_b32 s31, s31, 5
    s_add_u32 s31, s31, s4
    s_lshl_b32 s31, s31, 13
    v_and_b32 v0, 15, v1
    v_lshrrev_b32 v9, 4, v1
    v_lshlrev_b32 v9, 2, v9
    v_sub_u32 v0, v0, v9
    v_mov_b32 v28, 0x3f803f80
    v_mov_b32 v29, 0x3f803f80
    v_mov_b32 v30, 0x3f803f80
    v_mov_b32 v31, 0x3f803f80
    v_mov_b32 v24, 0
    v_mov_b32 v25, 0
    v_mov_b32 v16, 0
    v_mov_b32 v17, 0
    v_mov_b32 v18, 0
    v_mov_b32 v19, 0
    v_mov_b32 v20, 0
    v_mov_b32 v21, 0
    v_mov_b32 v22, 0
    v_mov_b32 v23, 0
    v_mov_b32 v96, 0
    v_mov_b32 v97, 0
    v_mov_b32 v98, 0
    v_mov_b32 v99, 0
    v_mov_b32 v100, 0
    v_mov_b32 v101, 0
    v_mov_b32 v102, 0
    v_mov_b32 v103, 0
    v_mov_b32 v104, 0
    v_mov_b32 v105, 0
    v_mov_b32 v106, 0
    v_mov_b32 v107, 0
    v_mov_b32 v108, 0
    v_mov_b32 v109, 0
    v_mov_b32 v110, 0
    v_mov_b32 v111, 0
    v_mov_b32 v112, 0
    v_mov_b32 v113, 0
    v_mov_b32 v114, 0
    v_mov_b32 v115, 0
    v_mov_b32 v116, 0
    v_mov_b32 v117, 0
    v_mov_b32 v118, 0
    v_mov_b32 v119, 0
    v_mov_b32 v120, 0
    v_mov_b32 v121, 0
    v_mov_b32 v122, 0
    v_mov_b32 v123, 0
    v_mov_b32 v124, 0
    v_mov_b32 v125, 0
    v_mov_b32 v126, 0
    v_mov_b32 v127, 0
    s_waitcnt vmcnt(6) lgkmcnt(0)
    s_mov_b32 s52, s66
    s_mov_b32 s53, s67
    s_mov_b32 s54, 0x400000
    s_mov_b32 s55, 0x20000
    s_barrier
    ds_read_b128 v[216:219], v3 offset:0
    ds_read_b128 v[220:223], v3 offset:1024
    ds_read_b128 v[224:227], v3 offset:2048
    ds_read_b128 v[228:231], v3 offset:3072
    ds_read_b128 v[232:235], v3 offset:4096
    ds_read_b128 v[236:239], v3 offset:5120
    s_waitcnt lgkmcnt(4)
    v_mfma_f32_16x16x32_bf16 v[128:131], v[216:219], v[32:35], v[16:19]
    v_mfma_f32_16x16x32_bf16 v[128:131], v[220:223], v[36:39], v[128:131]
    ds_read_b128 v[240:243], v3 offset:6144
    s_add_u32 m0, s27, 0xc000
    s_nop 0
    buffer_load_dwordx4 v2, s[36:39], s29 offen offset:0 sc1 lds
    v_mfma_f32_16x16x32_bf16 v[136:139], v[216:219], v[48:51], v[20:23]
    v_mfma_f32_16x16x32_bf16 v[136:139], v[220:223], v[52:55], v[136:139]
    ds_read_b128 v[244:247], v3 offset:7168
    buffer_load_dwordx4 v2, s[36:39], s29 offen offset:1024 sc1 lds
    s_waitcnt lgkmcnt(4)
    v_mfma_f32_16x16x32_bf16 v[128:131], v[224:227], v[40:43], v[128:131]
    v_mfma_f32_16x16x32_bf16 v[128:131], v[228:231], v[44:47], v[128:131]
    ds_read_b128 v[216:219], v3 offset:8192
    buffer_load_dwordx4 v2, s[36:39], s29 offen offset:2048 sc1 lds
    v_mfma_f32_16x16x32_bf16 v[136:139], v[224:227], v[56:59], v[136:139]
    v_mfma_f32_16x16x32_bf16 v[136:139], v[228:231], v[60:63], v[136:139]
    ds_read_b128 v[220:223], v3 offset:9216
    buffer_load_dwordx4 v2, s[36:39], s29 offen offset:3072 sc1 lds
    s_waitcnt lgkmcnt(4)
    v_mfma_f32_16x16x32_bf16 v[132:135], v[232:235], v[32:35], v[16:19]
    v_mfma_f32_16x16x32_bf16 v[132:135], v[236:239], v[36:39], v[132:135]
    ds_read_b128 v[224:227], v3 offset:10240
    v_mfma_f32_16x16x32_bf16 v[140:143], v[232:235], v[48:51], v[20:23]
    v_mfma_f32_16x16x32_bf16 v[140:143], v[236:239], v[52:55], v[140:143]
    ds_read_b128 v[228:231], v3 offset:11264
    s_waitcnt lgkmcnt(4)
    v_mfma_f32_16x16x32_bf16 v[132:135], v[240:243], v[40:43], v[132:135]
    v_mfma_f32_16x16x32_bf16 v[132:135], v[244:247], v[44:47], v[132:135]
    ds_read_b128 v[232:235], v3 offset:12288
    v_mfma_f32_16x16x32_bf16 v[140:143], v[240:243], v[56:59], v[140:143]
    v_mfma_f32_16x16x32_bf16 v[140:143], v[244:247], v[60:63], v[140:143]
    ds_read_b128 v[236:239], v3 offset:13312
    s_waitcnt lgkmcnt(4)
    v_mfma_f32_16x16x32_bf16 v[144:147], v[216:219], v[32:35], v[16:19]
    v_mfma_f32_16x16x32_bf16 v[144:147], v[220:223], v[36:39], v[144:147]
    ds_read_b128 v[240:243], v3 offset:14336
    v_mfma_f32_16x16x32_bf16 v[152:155], v[216:219], v[48:51], v[20:23]
    v_mfma_f32_16x16x32_bf16 v[152:155], v[220:223], v[52:55], v[152:155]
    ds_read_b128 v[244:247], v3 offset:15360
    s_waitcnt lgkmcnt(4)
    v_mfma_f32_16x16x32_bf16 v[144:147], v[224:227], v[40:43], v[144:147]
    v_mfma_f32_16x16x32_bf16 v[144:147], v[228:231], v[44:47], v[144:147]
    v_mfma_f32_16x16x32_bf16 v[152:155], v[224:227], v[56:59], v[152:155]
    v_mfma_f32_16x16x32_bf16 v[152:155], v[228:231], v[60:63], v[152:155]
    s_waitcnt lgkmcnt(2)
    v_mfma_f32_16x16x32_bf16 v[148:151], v[232:235], v[32:35], v[16:19]
    v_mfma_f32_16x16x32_bf16 v[148:151], v[236:239], v[36:39], v[148:151]
    v_mfma_f32_16x16x32_bf16 v[156:159], v[232:235], v[48:51], v[20:23]
    v_mfma_f32_16x16x32_bf16 v[156:159], v[236:239], v[52:55], v[156:159]
    s_waitcnt lgkmcnt(0)
    v_mfma_f32_16x16x32_bf16 v[148:151], v[240:243], v[40:43], v[148:151]
    v_mfma_f32_16x16x32_bf16 v[148:151], v[244:247], v[44:47], v[148:151]
    v_mfma_f32_16x16x32_bf16 v[156:159], v[240:243], v[56:59], v[156:159]
    v_mfma_f32_16x16x32_bf16 v[156:159], v[244:247], v[60:63], v[156:159]
    s_waitcnt vmcnt(4) lgkmcnt(0)
    s_barrier
    s_lshl_b32 s14, s2, 3
    s_add_u32 s14, s14, 8192
    s_add_u32 s14, s14, s7
    v_mov_b32 v12, s6
    v_mov_b32 v13, s6
    buffer_store_dwordx2 v[12:13], off, s[8:11], s14 sc1
    v_readlane_b32 s28, v4, 63
    ds_read_b128 v[216:219], v3 offset:16384
    ds_read_b128 v[220:223], v3 offset:17408
    ds_read_b128 v[224:227], v3 offset:18432
    ds_read_b128 v[228:231], v3 offset:19456
    s_nop 7
    s_add_u32 s14, s22, 0
    s_sub_u32 s15, s14, s25
    s_cmp_lt_u32 s15, 2
    s_cbranch_scc0 concat_nomask_10
    s_lshl_b32 s15, s15, 2
    s_lshl_b32 s35, s20, 1
    s_sub_i32 s15, s15, s35
    v_mov_b32 v13, 0xff800000
    v_cmp_gt_i32 s[40:41], 0, v0
    v_cmp_gt_i32 s[42:43], 1, v0
    v_cmp_gt_i32 s[44:45], 2, v0
    v_cmp_gt_i32 s[46:47], 3, v0
    s_cmp_lt_i32 s15, 0
    s_cbranch_scc1 concat_mnext_11
    s_cmp_gt_i32 s15, 0
    s_cbranch_scc1 concat_mfull_12
    v_cndmask_b32 v128, v128, v13, s[40:41]
    v_cndmask_b32 v129, v129, v13, s[42:43]
    v_cndmask_b32 v130, v130, v13, s[44:45]
    v_cndmask_b32 v131, v131, v13, s[46:47]
    s_branch concat_mnext_11
concat_mfull_12:
    v_mov_b32 v128, v13
    v_mov_b32 v129, v13
    v_mov_b32 v130, v13
    v_mov_b32 v131, v13
concat_mnext_11:
    s_cmp_lt_i32 s15, 1
    s_cbranch_scc1 concat_mnext_13
    s_cmp_gt_i32 s15, 1
    s_cbranch_scc1 concat_mfull_14
    v_cndmask_b32 v136, v136, v13, s[40:41]
    v_cndmask_b32 v137, v137, v13, s[42:43]
    v_cndmask_b32 v138, v138, v13, s[44:45]
    v_cndmask_b32 v139, v139, v13, s[46:47]
    s_branch concat_mnext_13
concat_mfull_14:
    v_mov_b32 v136, v13
    v_mov_b32 v137, v13
    v_mov_b32 v138, v13
    v_mov_b32 v139, v13
concat_mnext_13:
    s_cmp_lt_i32 s15, -1
    s_cbranch_scc1 concat_mnext_15
    s_cmp_gt_i32 s15, -1
    s_cbranch_scc1 concat_mfull_16
    v_cndmask_b32 v132, v132, v13, s[40:41]
    v_cndmask_b32 v133, v133, v13, s[42:43]
    v_cndmask_b32 v134, v134, v13, s[44:45]
    v_cndmask_b32 v135, v135, v13, s[46:47]
    s_branch concat_mnext_15
concat_mfull_16:
    v_mov_b32 v132, v13
    v_mov_b32 v133, v13
    v_mov_b32 v134, v13
    v_mov_b32 v135, v13
concat_mnext_15:
    s_cmp_lt_i32 s15, 0
    s_cbranch_scc1 concat_mnext_17
    s_cmp_gt_i32 s15, 0
    s_cbranch_scc1 concat_mfull_18
    v_cndmask_b32 v140, v140, v13, s[40:41]
    v_cndmask_b32 v141, v141, v13, s[42:43]
    v_cndmask_b32 v142, v142, v13, s[44:45]
    v_cndmask_b32 v143, v143, v13, s[46:47]
    s_branch concat_mnext_17
concat_mfull_18:
    v_mov_b32 v140, v13
    v_mov_b32 v141, v13
    v_mov_b32 v142, v13
    v_mov_b32 v143, v13
concat_mnext_17:
    s_cmp_lt_i32 s15, -2
    s_cbranch_scc1 concat_mnext_19
    s_cmp_gt_i32 s15, -2
    s_cbranch_scc1 concat_mfull_20
    v_cndmask_b32 v144, v144, v13, s[40:41]
    v_cndmask_b32 v145, v145, v13, s[42:43]
    v_cndmask_b32 v146, v146, v13, s[44:45]
    v_cndmask_b32 v147, v147, v13, s[46:47]
    s_branch concat_mnext_19
concat_mfull_20:
    v_mov_b32 v144, v13
    v_mov_b32 v145, v13
    v_mov_b32 v146, v13
    v_mov_b32 v147, v13
concat_mnext_19:
    s_cmp_lt_i32 s15, -1
    s_cbranch_scc1 concat_mnext_21
    s_cmp_gt_i32 s15, -1
    s_cbranch_scc1 concat_mfull_22
    v_cndmask_b32 v152, v152, v13, s[40:41]
    v_cndmask_b32 v153, v153, v13, s[42:43]
    v_cndmask_b32 v154, v154, v13, s[44:45]
    v_cndmask_b32 v155, v155, v13, s[46:47]
    s_branch concat_mnext_21
concat_mfull_22:
    v_mov_b32 v152, v13
    v_mov_b32 v153, v13
    v_mov_b32 v154, v13
    v_mov_b32 v155, v13
concat_mnext_21:
    s_cmp_lt_i32 s15, -3
    s_cbranch_scc1 concat_mnext_23
    s_cmp_gt_i32 s15, -3
    s_cbranch_scc1 concat_mfull_24
    v_cndmask_b32 v148, v148, v13, s[40:41]
    v_cndmask_b32 v149, v149, v13, s[42:43]
    v_cndmask_b32 v150, v150, v13, s[44:45]
    v_cndmask_b32 v151, v151, v13, s[46:47]
    s_branch concat_mnext_23
concat_mfull_24:
    v_mov_b32 v148, v13
    v_mov_b32 v149, v13
    v_mov_b32 v150, v13
    v_mov_b32 v151, v13
concat_mnext_23:
    s_cmp_lt_i32 s15, -2
    s_cbranch_scc1 concat_mnext_25
    s_cmp_gt_i32 s15, -2
    s_cbranch_scc1 concat_mfull_26
    v_cndmask_b32 v156, v156, v13, s[40:41]
    v_cndmask_b32 v157, v157, v13, s[42:43]
    v_cndmask_b32 v158, v158, v13, s[44:45]
    v_cndmask_b32 v159, v159, v13, s[46:47]
    s_branch concat_mnext_25
concat_mfull_26:
    v_mov_b32 v156, v13
    v_mov_b32 v157, v13
    v_mov_b32 v158, v13
    v_mov_b32 v159, v13
concat_mnext_25:
concat_nomask_10:
    s_cmp_eq_u32 s14, 0
    s_cbranch_scc1 concat_doinit_28
    s_cmp_lg_u32 s14, s23
    s_cbranch_scc1 concat_noinit_27
concat_doinit_28:
    v_max3_f32 v14, v128, v129, v130
    v_max3_f32 v15, v136, v137, v138
    v_max3_f32 v14, v14, v131, v132
    v_max3_f32 v15, v15, v139, v140
    v_max3_f32 v14, v14, v133, v134
    v_max3_f32 v15, v15, v141, v142
    v_max3_f32 v14, v14, v135, v144
    v_max3_f32 v15, v15, v143, v152
    v_max3_f32 v14, v14, v145, v146
    v_max3_f32 v15, v15, v153, v154
    v_max3_f32 v14, v14, v147, v148
    v_max3_f32 v15, v15, v155, v156
    v_max3_f32 v14, v14, v149, v150
    v_max3_f32 v15, v15, v157, v158
    v_max_f32 v14, v14, v151
    v_max_f32 v15, v15, v159
    v_mov_b32 v10, v14
    v_mov_b32 v11, v15
    s_nop 0
    v_permlane16_swap_b32 v14, v10
    v_permlane16_swap_b32 v15, v11
    v_max_f32 v14, v14, v10
    v_max_f32 v15, v15, v11
    v_mov_b32 v10, v14
    v_mov_b32 v11, v15
    s_nop 0
    v_permlane32_swap_b32 v14, v10
    v_permlane32_swap_b32 v15, v11
    v_max_f32 v14, v14, v10
    v_max_f32 v15, v15, v11
    v_sub_f32 v128, v128, v14
    v_sub_f32 v129, v129, v14
    v_sub_f32 v130, v130, v14
    v_sub_f32 v131, v131, v14
    v_sub_f32 v132, v132, v14
    v_sub_f32 v133, v133, v14
    v_sub_f32 v134, v134, v14
    v_sub_f32 v135, v135, v14
    v_sub_f32 v144, v144, v14
    v_sub_f32 v145, v145, v14
    v_sub_f32 v146, v146, v14
    v_sub_f32 v147, v147, v14
    v_sub_f32 v148, v148, v14
    v_sub_f32 v149, v149, v14
    v_sub_f32 v150, v150, v14
    v_sub_f32 v151, v151, v14
    v_sub_f32 v16, 0, v14
    v_sub_f32 v17, 0, v14
    v_sub_f32 v18, 0, v14
    v_sub_f32 v19, 0, v14
    v_sub_f32 v136, v136, v15
    v_sub_f32 v137, v137, v15
    v_sub_f32 v138, v138, v15
    v_sub_f32 v139, v139, v15
    v_sub_f32 v140, v140, v15
    v_sub_f32 v141, v141, v15
    v_sub_f32 v142, v142, v15
    v_sub_f32 v143, v143, v15
    v_sub_f32 v152, v152, v15
    v_sub_f32 v153, v153, v15
    v_sub_f32 v154, v154, v15
    v_sub_f32 v155, v155, v15
    v_sub_f32 v156, v156, v15
    v_sub_f32 v157, v157, v15
    v_sub_f32 v158, v158, v15
    v_sub_f32 v159, v159, v15
    v_sub_f32 v20, 0, v15
    v_sub_f32 v21, 0, v15
    v_sub_f32 v22, 0, v15
    v_sub_f32 v23, 0, v15
concat_noinit_27:
    v_exp_f32 v10, v128
    v_exp_f32 v11, v129
    v_exp_f32 v12, v130
    v_exp_f32 v13, v131
    v_cvt_pk_bf16_f32 v192, v10, v11
    v_exp_f32 v10, v132
    v_exp_f32 v11, v133
    v_cvt_pk_bf16_f32 v193, v12, v13
    v_exp_f32 v12, v134
    v_exp_f32 v13, v135
    v_cvt_pk_bf16_f32 v194, v10, v11
    v_exp_f32 v10, v136
    v_exp_f32 v11, v137
    v_cvt_pk_bf16_f32 v195, v12, v13
    v_exp_f32 v12, v138
    v_exp_f32 v13, v139
    v_cvt_pk_bf16_f32 v196, v10, v11
    v_exp_f32 v10, v140
    v_exp_f32 v11, v141
    v_cvt_pk_bf16_f32 v197, v12, v13
    v_exp_f32 v12, v142
    v_exp_f32 v13, v143
    v_cvt_pk_bf16_f32 v198, v10, v11
    v_cvt_pk_bf16_f32 v199, v12, v13
    s_branch concat_gjoin_5
concat_plain_3:
    s_waitcnt vmcnt(9) lgkmcnt(0)
    s_barrier
    s_setprio 3
    v_mfma_f32_16x16x32_bf16 v[96:99], v[32:35], v[52:55], v[96:99]
    ds_read_b64_tr_b16 v[16:17], v0 offset:32768
    v_mfma_f32_16x16x32_bf16 v[100:103], v[36:39], v[52:55], v[100:103]
    ds_read_b64_tr_b16 v[18:19], v0 offset:33792
    s_add_u32 m0, s60, 0x1c000
    s_add_u32 s14, s62, 0x180000
    buffer_load_dwordx4 v15, s[32:35], s14 offen lds
    v_cvt_pk_bf16_f32 v128, v128, v129
    v_cvt_pk_bf16_f32 v129, v130, v131
    v_mfma_f32_16x16x32_bf16 v[104:107], v[40:43], v[52:55], v[104:107]
    ds_read_b64_tr_b16 v[20:21], v3 offset:32768
    v_mfma_f32_16x16x32_bf16 v[108:111], v[44:47], v[52:55], v[108:111]
    ds_read_b64_tr_b16 v[22:23], v3 offset:33792
    v_cvt_pk_bf16_f32 v130, v132, v133
    ds_read_b64_tr_b16 v[24:25], v10 offset:32768
    v_mfma_f32_16x16x32_bf16 v[112:115], v[32:35], v[56:59], v[112:115]
    ds_read_b64_tr_b16 v[26:27], v10 offset:33792
    v_mfma_f32_16x16x32_bf16 v[116:119], v[36:39], v[56:59], v[116:119]
    ds_read_b64_tr_b16 v[28:29], v11 offset:32768
    s_add_u32 m0, s60, 0x1e000
    s_add_u32 s14, s62, 0x1c0000
    buffer_load_dwordx4 v15, s[32:35], s14 offen lds
    v_cvt_pk_bf16_f32 v131, v134, v135
    v_mfma_f32_16x16x32_bf16 v[120:123], v[40:43], v[56:59], v[120:123]
    ds_read_b64_tr_b16 v[30:31], v11 offset:33792
    v_mfma_f32_16x16x32_bf16 v[124:127], v[44:47], v[56:59], v[124:127]
    ds_read_b128 v[60:63], v6 offset:0
    s_add_u32 s15, s65, 0x0
    buffer_store_dwordx4 v[128:131], v2, s[36:39], s15 offen sc1
    ds_read_b128 v[48:51], v6 offset:2048
    s_setprio 2
    s_waitcnt lgkmcnt(1)
    v_mfma_f32_16x16x32_bf16 v[64:67], v[16:19], v[60:63], v[64:67]
    v_mfma_f32_16x16x32_bf16 v[68:71], v[20:23], v[60:63], v[68:71]
    ds_read_b128 v[52:55], v6 offset:4096
    s_add_u32 m0, s60, 0x10000
    s_add_u32 s14, s63, 0x180
    buffer_load_dwordx4 v14, s[20:23], s14 offen lds
    v_cvt_pk_bf16_f32 v136, v136, v137
    v_cvt_pk_bf16_f32 v137, v138, v139
    v_mfma_f32_16x16x32_bf16 v[72:75], v[24:27], v[60:63], v[72:75]
    v_mfma_f32_16x16x32_bf16 v[76:79], v[28:31], v[60:63], v[76:79]
    ds_read_b128 v[56:59], v6 offset:6144
    v_cvt_pk_bf16_f32 v138, v140, v141
    ds_read_b64_tr_b16 v[32:33], v0 offset:40960
    s_waitcnt lgkmcnt(3)
    v_mfma_f32_16x16x32_bf16 v[80:83], v[16:19], v[48:51], v[80:83]
    v_mfma_f32_16x16x32_bf16 v[84:87], v[20:23], v[48:51], v[84:87]
    ds_read_b64_tr_b16 v[34:35], v0 offset:41984
    s_add_u32 m0, s60, 0x12000
    s_add_u32 s14, s63, 0x10180
    buffer_load_dwordx4 v14, s[20:23], s14 offen lds
    v_cvt_pk_bf16_f32 v139, v142, v143
    v_mfma_f32_16x16x32_bf16 v[88:91], v[24:27], v[48:51], v[88:91]
    v_mfma_f32_16x16x32_bf16 v[92:95], v[28:31], v[48:51], v[92:95]
    ds_read_b64_tr_b16 v[36:37], v3 offset:40960
    s_add_u32 s15, s65, 0x1000
    buffer_store_dwordx4 v[136:139], v2, s[36:39], s15 offen sc1
    ds_read_b64_tr_b16 v[38:39], v3 offset:41984
    s_setprio 1
    s_waitcnt lgkmcnt(5)
    v_mfma_f32_16x16x32_bf16 v[96:99], v[16:19], v[52:55], v[96:99]
    v_mfma_f32_16x16x32_bf16 v[100:103], v[20:23], v[52:55], v[100:103]
    ds_read_b64_tr_b16 v[40:41], v10 offset:40960
    s_add_u32 m0, s60, 0x14000
    s_add_u32 s14, s64, 0x180
    buffer_load_dwordx4 v14, s[20:23], s14 offen lds
    v_cvt_pk_bf16_f32 v224, v224, v225
    v_cvt_pk_bf16_f32 v225, v226, v227
    v_mfma_f32_16x16x32_bf16 v[104:107], v[24:27], v[52:55], v[104:107]
    v_mfma_f32_16x16x32_bf16 v[108:111], v[28:31], v[52:55], v[108:111]
    ds_read_b64_tr_b16 v[42:43], v10 offset:41984
    v_cvt_pk_bf16_f32 v226, v228, v229
    ds_read_b64_tr_b16 v[44:45], v11 offset:40960
    s_waitcnt lgkmcnt(7)
    v_mfma_f32_16x16x32_bf16 v[112:115], v[16:19], v[56:59], v[112:115]
    v_mfma_f32_16x16x32_bf16 v[116:119], v[20:23], v[56:59], v[116:119]
    ds_read_b64_tr_b16 v[46:47], v11 offset:41984
    s_add_u32 m0, s60, 0x16000
    s_add_u32 s14, s64, 0x10180
    buffer_load_dwordx4 v14, s[20:23], s14 offen lds
    v_cvt_pk_bf16_f32 v227, v230, v231
    v_mfma_f32_16x16x32_bf16 v[120:123], v[24:27], v[56:59], v[120:123]
    v_mfma_f32_16x16x32_bf16 v[124:127], v[28:31], v[56:59], v[124:127]
    ds_read_b128 v[60:63], v7 offset:0
    s_add_u32 s15, s66, 0x8000
    buffer_store_dwordx4 v[224:227], v2, s[36:39], s15 offen sc1
    ds_read_b128 v[48:51], v7 offset:2048
    s_setprio 0
    s_waitcnt lgkmcnt(1)
    v_mfma_f32_16x16x32_bf16 v[64:67], v[32:35], v[60:63], v[64:67]
    v_mfma_f32_16x16x32_bf16 v[68:71], v[36:39], v[60:63], v[68:71]
    ds_read_b128 v[52:55], v7 offset:4096
    v_cvt_pk_bf16_f32 v232, v232, v233
    v_cvt_pk_bf16_f32 v233, v234, v235
    v_mfma_f32_16x16x32_bf16 v[72:75], v[40:43], v[60:63], v[72:75]
    v_mfma_f32_16x16x32_bf16 v[76:79], v[44:47], v[60:63], v[76:79]
    ds_read_b128 v[56:59], v7 offset:6144
    v_cvt_pk_bf16_f32 v234, v236, v237
    s_waitcnt lgkmcnt(2)
    v_mfma_f32_16x16x32_bf16 v[80:83], v[32:35], v[48:51], v[80:83]
    v_mfma_f32_16x16x32_bf16 v[84:87], v[36:39], v[48:51], v[84:87]
    v_cvt_pk_bf16_f32 v235, v238, v239
    v_mfma_f32_16x16x32_bf16 v[88:91], v[40:43], v[48:51], v[88:91]
    v_mfma_f32_16x16x32_bf16 v[92:95], v[44:47], v[48:51], v[92:95]
    s_add_u32 s15, s66, 0x8400
    buffer_store_dwordx4 v[232:235], v2, s[36:39], s15 offen sc1
    s_waitcnt vmcnt(10) lgkmcnt(0)
    s_barrier
    s_setprio 3
    v_mfma_f32_16x16x32_bf16 v[96:99], v[32:35], v[52:55], v[96:99]
    ds_read_b64_tr_b16 v[16:17], v0 offset:0
    v_mfma_f32_16x16x32_bf16 v[100:103], v[36:39], v[52:55], v[100:103]
    ds_read_b64_tr_b16 v[18:19], v0 offset:1024
    s_add_u32 m0, s60, 0x20000
    s_add_u32 s14, s62, 0x200000
    buffer_load_dwordx4 v15, s[32:35], s14 offen lds
    v_lshrrev_b32 v4, 2, v1
    v_lshlrev_b32 v4, 9, v4
    v_and_b32 v5, 3, v1
    v_lshl_add_u32 v4, v5, 3, v4
    s_lshl_b32 s14, s3, 6
    s_add_u32 s14, s14, 0x24000
    v_add_u32 v4, s14, v4
    ds_read_b64_tr_b16 v[132:133], v4 offset:0
    ds_read_b64_tr_b16 v[134:135], v4 offset:8192
    ds_read_b64_tr_b16 v[136:137], v4 offset:32
    ds_read_b64_tr_b16 v[138:139], v4 offset:8224
    s_add_u32 s76, s12, 0x4c00000
    s_addc_u32 s77, s13, 0
    s_mov_b32 s78, 0x400000
    s_mov_b32 s79, 0x20000
    v_cvt_pk_bf16_f32 v240, v240, v241
    v_cvt_pk_bf16_f32 v241, v242, v243
    v_mfma_f32_16x16x32_bf16 v[104:107], v[40:43], v[52:55], v[104:107]
    ds_read_b64_tr_b16 v[20:21], v3 offset:0
    v_mfma_f32_16x16x32_bf16 v[108:111], v[44:47], v[52:55], v[108:111]
    ds_read_b64_tr_b16 v[22:23], v3 offset:1024
    v_cvt_pk_bf16_f32 v242, v244, v245
    ds_read_b64_tr_b16 v[24:25], v10 offset:0
    v_mfma_f32_16x16x32_bf16 v[112:115], v[32:35], v[56:59], v[112:115]
    ds_read_b64_tr_b16 v[26:27], v10 offset:1024
    v_mfma_f32_16x16x32_bf16 v[116:119], v[36:39], v[56:59], v[116:119]
    ds_read_b64_tr_b16 v[28:29], v11 offset:0
    s_add_u32 m0, s60, 0x22000
    s_add_u32 s14, s62, 0x240000
    buffer_load_dwordx4 v15, s[32:35], s14 offen lds
    v_cvt_pk_bf16_f32 v243, v246, v247
    v_mfma_f32_16x16x32_bf16 v[120:123], v[40:43], v[56:59], v[120:123]
    ds_read_b64_tr_b16 v[30:31], v11 offset:1024
    v_mfma_f32_16x16x32_bf16 v[124:127], v[44:47], v[56:59], v[124:127]
    ds_read_b128 v[60:63], v6 offset:32768
    s_add_u32 s15, s66, 0xa000
    buffer_store_dwordx4 v[240:243], v2, s[36:39], s15 offen sc1
    ds_read_b128 v[48:51], v6 offset:34816
    s_setprio 2
    s_waitcnt lgkmcnt(1)
    v_mfma_f32_16x16x32_bf16 v[64:67], v[16:19], v[60:63], v[64:67]
    v_mfma_f32_16x16x32_bf16 v[68:71], v[20:23], v[60:63], v[68:71]
    ds_read_b128 v[52:55], v6 offset:36864
    s_add_u32 m0, s60, 0x0
    s_add_u32 s14, s63, 0x200
    buffer_load_dwordx4 v14, s[20:23], s14 offen lds
    v_cvt_pk_bf16_f32 v248, v248, v249
    v_cvt_pk_bf16_f32 v249, v250, v251
    v_mfma_f32_16x16x32_bf16 v[72:75], v[24:27], v[60:63], v[72:75]
    v_mfma_f32_16x16x32_bf16 v[76:79], v[28:31], v[60:63], v[76:79]
    ds_read_b128 v[56:59], v6 offset:38912
    v_cvt_pk_bf16_f32 v250, v252, v253
    ds_read_b64_tr_b16 v[32:33], v0 offset:8192
    s_waitcnt lgkmcnt(3)
    v_mfma_f32_16x16x32_bf16 v[80:83], v[16:19], v[48:51], v[80:83]
    v_mfma_f32_16x16x32_bf16 v[84:87], v[20:23], v[48:51], v[84:87]
    ds_read_b64_tr_b16 v[34:35], v0 offset:9216
    s_add_u32 m0, s60, 0x2000
    s_add_u32 s14, s63, 0x10200
    buffer_load_dwordx4 v14, s[20:23], s14 offen lds
    v_cvt_pk_bf16_f32 v251, v254, v255
    v_mfma_f32_16x16x32_bf16 v[88:91], v[24:27], v[48:51], v[88:91]
    v_mfma_f32_16x16x32_bf16 v[92:95], v[28:31], v[48:51], v[92:95]
    ds_read_b64_tr_b16 v[36:37], v3 offset:8192
    s_add_u32 s15, s66, 0xa400
    buffer_store_dwordx4 v[248:251], v2, s[36:39], s15 offen sc1
    ds_read_b64_tr_b16 v[38:39], v3 offset:9216
    s_setprio 1
    s_waitcnt lgkmcnt(5)
    v_mfma_f32_16x16x32_bf16 v[96:99], v[16:19], v[52:55], v[96:99]
    v_mfma_f32_16x16x32_bf16 v[100:103], v[20:23], v[52:55], v[100:103]
    ds_read_b64_tr_b16 v[40:41], v10 offset:8192
    s_add_u32 m0, s60, 0x4000
    s_add_u32 s14, s64, 0x200
    buffer_load_dwordx4 v14, s[20:23], s14 offen lds
    v_cvt_pk_bf16_f32 v144, v144, v145
    v_cvt_pk_bf16_f32 v145, v146, v147
    v_mfma_f32_16x16x32_bf16 v[104:107], v[24:27], v[52:55], v[104:107]
    v_mfma_f32_16x16x32_bf16 v[108:111], v[28:31], v[52:55], v[108:111]
    ds_read_b64_tr_b16 v[42:43], v10 offset:9216
    v_cvt_pk_bf16_f32 v146, v148, v149
    ds_read_b64_tr_b16 v[44:45], v11 offset:8192
    s_waitcnt lgkmcnt(7)
    v_mfma_f32_16x16x32_bf16 v[112:115], v[16:19], v[56:59], v[112:115]
    v_mfma_f32_16x16x32_bf16 v[116:119], v[20:23], v[56:59], v[116:119]
    ds_read_b64_tr_b16 v[46:47], v11 offset:9216
    s_add_u32 m0, s60, 0x6000
    s_add_u32 s14, s64, 0x10200
    buffer_load_dwordx4 v14, s[20:23], s14 offen lds
    v_cvt_pk_bf16_f32 v147, v150, v151
    v_mfma_f32_16x16x32_bf16 v[120:123], v[24:27], v[56:59], v[120:123]
    v_mfma_f32_16x16x32_bf16 v[124:127], v[28:31], v[56:59], v[124:127]
    ds_read_b128 v[60:63], v7 offset:32768
    s_add_u32 s15, s65, 0x2000
    buffer_store_dwordx4 v[144:147], v2, s[36:39], s15 offen sc1
    ds_read_b128 v[48:51], v7 offset:34816
    s_setprio 0
    s_waitcnt lgkmcnt(1)
    v_mfma_f32_16x16x32_bf16 v[64:67], v[32:35], v[60:63], v[64:67]
    v_mfma_f32_16x16x32_bf16 v[68:71], v[36:39], v[60:63], v[68:71]
    ds_read_b128 v[52:55], v7 offset:36864
    v_cvt_pk_bf16_f32 v152, v152, v153
    v_cvt_pk_bf16_f32 v153, v154, v155
    v_mfma_f32_16x16x32_bf16 v[72:75], v[40:43], v[60:63], v[72:75]
    v_mfma_f32_16x16x32_bf16 v[76:79], v[44:47], v[60:63], v[76:79]
    ds_read_b128 v[56:59], v7 offset:38912
    v_cvt_pk_bf16_f32 v154, v156, v157
    s_waitcnt lgkmcnt(2)
    v_mfma_f32_16x16x32_bf16 v[80:83], v[32:35], v[48:51], v[80:83]
    v_mfma_f32_16x16x32_bf16 v[84:87], v[36:39], v[48:51], v[84:87]
    v_cvt_pk_bf16_f32 v155, v158, v159
    v_mfma_f32_16x16x32_bf16 v[88:91], v[40:43], v[48:51], v[88:91]
    v_mfma_f32_16x16x32_bf16 v[92:95], v[44:47], v[48:51], v[92:95]
    s_add_u32 s15, s65, 0x3000
    buffer_store_dwordx4 v[152:155], v2, s[36:39], s15 offen sc1
    s_and_b32 s14, s2, 1
    s_lshl_b32 s14, s14, 2
    s_lshr_b32 s15, s3, 1
    s_add_u32 s14, s14, s15
    s_lshl_b32 s14, s14, 7
    s_lshr_b32 s15, s2, 1
    s_add_u32 s14, s14, s15
    s_lshl_b32 s14, s14, 1
    s_and_b32 s15, s3, 1
    s_add_u32 s14, s14, s15
    s_lshl_b32 s14, s14, 11
    buffer_store_dwordx4 v[132:135], v2, s[76:79], s14 offen offset:0 sc1
    buffer_store_dwordx4 v[136:139], v2, s[76:79], s14 offen offset:1024 sc1
    s_waitcnt vmcnt(14) lgkmcnt(0)
    s_barrier
    s_setprio 3
    v_mfma_f32_16x16x32_bf16 v[96:99], v[32:35], v[52:55], v[96:99]
    ds_read_b64_tr_b16 v[16:17], v0 offset:16384
    v_mfma_f32_16x16x32_bf16 v[100:103], v[36:39], v[52:55], v[100:103]
    ds_read_b64_tr_b16 v[18:19], v0 offset:17408
    s_add_u32 m0, s60, 0x18000
    s_add_u32 s14, s62, 0x280000
    buffer_load_dwordx4 v15, s[32:35], s14 offen lds
    v_cvt_pk_bf16_f32 v160, v160, v161
    v_cvt_pk_bf16_f32 v161, v162, v163
    v_mfma_f32_16x16x32_bf16 v[104:107], v[40:43], v[52:55], v[104:107]
    ds_read_b64_tr_b16 v[20:21], v3 offset:16384
    v_mfma_f32_16x16x32_bf16 v[108:111], v[44:47], v[52:55], v[108:111]
    ds_read_b64_tr_b16 v[22:23], v3 offset:17408
    v_cvt_pk_bf16_f32 v162, v164, v165
    ds_read_b64_tr_b16 v[24:25], v10 offset:16384
    v_mfma_f32_16x16x32_bf16 v[112:115], v[32:35], v[56:59], v[112:115]
    ds_read_b64_tr_b16 v[26:27], v10 offset:17408
    v_mfma_f32_16x16x32_bf16 v[116:119], v[36:39], v[56:59], v[116:119]
    ds_read_b64_tr_b16 v[28:29], v11 offset:16384
    s_add_u32 m0, s60, 0x1a000
    s_add_u32 s14, s62, 0x2c0000
    buffer_load_dwordx4 v15, s[32:35], s14 offen lds
    v_cvt_pk_bf16_f32 v163, v166, v167
    v_mfma_f32_16x16x32_bf16 v[120:123], v[40:43], v[56:59], v[120:123]
    ds_read_b64_tr_b16 v[30:31], v11 offset:17408
    v_mfma_f32_16x16x32_bf16 v[124:127], v[44:47], v[56:59], v[124:127]
    ds_read_b128 v[60:63], v8 offset:0
    s_add_u32 s15, s65, 0x8000
    buffer_store_dwordx4 v[160:163], v2, s[36:39], s15 offen sc1
    ds_read_b128 v[48:51], v8 offset:2048
    s_setprio 2
    s_waitcnt lgkmcnt(1)
    v_mfma_f32_16x16x32_bf16 v[64:67], v[16:19], v[60:63], v[64:67]
    v_mfma_f32_16x16x32_bf16 v[68:71], v[20:23], v[60:63], v[68:71]
    ds_read_b128 v[52:55], v8 offset:4096
    s_add_u32 m0, s60, 0x8000
    s_add_u32 s14, s63, 0x280
    buffer_load_dwordx4 v14, s[20:23], s14 offen lds
    v_cvt_pk_bf16_f32 v168, v168, v169
    v_cvt_pk_bf16_f32 v169, v170, v171
    v_mfma_f32_16x16x32_bf16 v[72:75], v[24:27], v[60:63], v[72:75]
    v_mfma_f32_16x16x32_bf16 v[76:79], v[28:31], v[60:63], v[76:79]
    ds_read_b128 v[56:59], v8 offset:6144
    v_cvt_pk_bf16_f32 v170, v172, v173
    ds_read_b64_tr_b16 v[32:33], v0 offset:24576
    s_waitcnt lgkmcnt(3)
    v_mfma_f32_16x16x32_bf16 v[80:83], v[16:19], v[48:51], v[80:83]
    v_mfma_f32_16x16x32_bf16 v[84:87], v[20:23], v[48:51], v[84:87]
    ds_read_b64_tr_b16 v[34:35], v0 offset:25600
    s_add_u32 m0, s60, 0xa000
    s_add_u32 s14, s63, 0x10280
    buffer_load_dwordx4 v14, s[20:23], s14 offen lds
    v_cvt_pk_bf16_f32 v171, v174, v175
    v_mfma_f32_16x16x32_bf16 v[88:91], v[24:27], v[48:51], v[88:91]
    v_mfma_f32_16x16x32_bf16 v[92:95], v[28:31], v[48:51], v[92:95]
    ds_read_b64_tr_b16 v[36:37], v3 offset:24576
    s_add_u32 s15, s65, 0x9000
    buffer_store_dwordx4 v[168:171], v2, s[36:39], s15 offen sc1
    ds_read_b64_tr_b16 v[38:39], v3 offset:25600
    s_setprio 1
    s_waitcnt lgkmcnt(5)
    v_mfma_f32_16x16x32_bf16 v[96:99], v[16:19], v[52:55], v[96:99]
    v_mfma_f32_16x16x32_bf16 v[100:103], v[20:23], v[52:55], v[100:103]
    ds_read_b64_tr_b16 v[40:41], v10 offset:24576
    s_add_u32 m0, s60, 0xc000
    s_add_u32 s14, s64, 0x280
    buffer_load_dwordx4 v14, s[20:23], s14 offen lds
    v_cvt_pk_bf16_f32 v176, v176, v177
    v_cvt_pk_bf16_f32 v177, v178, v179
    v_mfma_f32_16x16x32_bf16 v[104:107], v[24:27], v[52:55], v[104:107]
    v_mfma_f32_16x16x32_bf16 v[108:111], v[28:31], v[52:55], v[108:111]
    ds_read_b64_tr_b16 v[42:43], v10 offset:25600
    v_cvt_pk_bf16_f32 v178, v180, v181
    ds_read_b64_tr_b16 v[44:45], v11 offset:24576
    s_waitcnt lgkmcnt(7)
    v_mfma_f32_16x16x32_bf16 v[112:115], v[16:19], v[56:59], v[112:115]
    v_mfma_f32_16x16x32_bf16 v[116:119], v[20:23], v[56:59], v[116:119]
    ds_read_b64_tr_b16 v[46:47], v11 offset:25600
    s_add_u32 m0, s60, 0xe000
    s_add_u32 s14, s64, 0x10280
    buffer_load_dwordx4 v14, s[20:23], s14 offen lds
    v_cvt_pk_bf16_f32 v179, v182, v183
    v_mfma_f32_16x16x32_bf16 v[120:123], v[24:27], v[56:59], v[120:123]
    v_mfma_f32_16x16x32_bf16 v[124:127], v[28:31], v[56:59], v[124:127]
    ds_read_b128 v[60:63], v9 offset:0
    s_add_u32 s15, s65, 0xa000
    buffer_store_dwordx4 v[176:179], v2, s[36:39], s15 offen sc1
    ds_read_b128 v[48:51], v9 offset:2048
    s_setprio 0
    s_waitcnt lgkmcnt(1)
    v_mfma_f32_16x16x32_bf16 v[64:67], v[32:35], v[60:63], v[64:67]
    v_mfma_f32_16x16x32_bf16 v[68:71], v[36:39], v[60:63], v[68:71]
    ds_read_b128 v[52:55], v9 offset:4096
    v_cvt_pk_bf16_f32 v184, v184, v185
    v_cvt_pk_bf16_f32 v185, v186, v187
    v_mfma_f32_16x16x32_bf16 v[72:75], v[40:43], v[60:63], v[72:75]
    v_mfma_f32_16x16x32_bf16 v[76:79], v[44:47], v[60:63], v[76:79]
    ds_read_b128 v[56:59], v9 offset:6144
    v_cvt_pk_bf16_f32 v186, v188, v189
    s_waitcnt lgkmcnt(2)
    v_mfma_f32_16x16x32_bf16 v[80:83], v[32:35], v[48:51], v[80:83]
    v_mfma_f32_16x16x32_bf16 v[84:87], v[36:39], v[48:51], v[84:87]
    v_cvt_pk_bf16_f32 v187, v190, v191
    v_mfma_f32_16x16x32_bf16 v[88:91], v[40:43], v[48:51], v[88:91]
    v_mfma_f32_16x16x32_bf16 v[92:95], v[44:47], v[48:51], v[92:95]
    s_add_u32 s15, s65, 0xb000
    buffer_store_dwordx4 v[184:187], v2, s[36:39], s15 offen sc1
    s_waitcnt vmcnt(14) lgkmcnt(0)
    s_barrier
    s_setprio 3
    v_mfma_f32_16x16x32_bf16 v[96:99], v[32:35], v[52:55], v[96:99]
    ds_read_b64_tr_b16 v[16:17], v0 offset:32768
    v_mfma_f32_16x16x32_bf16 v[100:103], v[36:39], v[52:55], v[100:103]
    ds_read_b64_tr_b16 v[18:19], v0 offset:33792
    s_add_u32 m0, s60, 0x1c000
    s_add_u32 s14, s62, 0x300000
    buffer_load_dwordx4 v15, s[32:35], s14 offen lds
    v_cvt_pk_bf16_f32 v192, v192, v193
    v_cvt_pk_bf16_f32 v193, v194, v195
    v_mfma_f32_16x16x32_bf16 v[104:107], v[40:43], v[52:55], v[104:107]
    ds_read_b64_tr_b16 v[20:21], v3 offset:32768
    v_mfma_f32_16x16x32_bf16 v[108:111], v[44:47], v[52:55], v[108:111]
    ds_read_b64_tr_b16 v[22:23], v3 offset:33792
    v_cvt_pk_bf16_f32 v194, v196, v197
    ds_read_b64_tr_b16 v[24:25], v10 offset:32768
    v_mfma_f32_16x16x32_bf16 v[112:115], v[32:35], v[56:59], v[112:115]
    ds_read_b64_tr_b16 v[26:27], v10 offset:33792
    v_mfma_f32_16x16x32_bf16 v[116:119], v[36:39], v[56:59], v[116:119]
    ds_read_b64_tr_b16 v[28:29], v11 offset:32768
    s_add_u32 m0, s60, 0x1e000
    s_add_u32 s14, s62, 0x340000
    buffer_load_dwordx4 v15, s[32:35], s14 offen lds
    v_cvt_pk_bf16_f32 v195, v198, v199
    v_mfma_f32_16x16x32_bf16 v[120:123], v[40:43], v[56:59], v[120:123]
    ds_read_b64_tr_b16 v[30:31], v11 offset:33792
    v_mfma_f32_16x16x32_bf16 v[124:127], v[44:47], v[56:59], v[124:127]
    ds_read_b128 v[60:63], v6 offset:0
    s_add_u32 s15, s66, 0x0
    buffer_store_dwordx4 v[192:195], v2, s[36:39], s15 offen sc1
    ds_read_b128 v[48:51], v6 offset:2048
    s_setprio 2
    s_waitcnt lgkmcnt(1)
    v_mfma_f32_16x16x32_bf16 v[64:67], v[16:19], v[60:63], v[64:67]
    v_mfma_f32_16x16x32_bf16 v[68:71], v[20:23], v[60:63], v[68:71]
    ds_read_b128 v[52:55], v6 offset:4096
    s_add_u32 m0, s60, 0x10000
    s_add_u32 s14, s63, 0x300
    buffer_load_dwordx4 v14, s[20:23], s14 offen lds
    v_cvt_pk_bf16_f32 v200, v200, v201
    v_cvt_pk_bf16_f32 v201, v202, v203
    v_mfma_f32_16x16x32_bf16 v[72:75], v[24:27], v[60:63], v[72:75]
    v_mfma_f32_16x16x32_bf16 v[76:79], v[28:31], v[60:63], v[76:79]
    ds_read_b128 v[56:59], v6 offset:6144
    v_cvt_pk_bf16_f32 v202, v204, v205
    ds_read_b64_tr_b16 v[32:33], v0 offset:40960
    s_waitcnt lgkmcnt(3)
    v_mfma_f32_16x16x32_bf16 v[80:83], v[16:19], v[48:51], v[80:83]
    v_mfma_f32_16x16x32_bf16 v[84:87], v[20:23], v[48:51], v[84:87]
    ds_read_b64_tr_b16 v[34:35], v0 offset:41984
    s_add_u32 m0, s60, 0x12000
    s_add_u32 s14, s63, 0x10300
    buffer_load_dwordx4 v14, s[20:23], s14 offen lds
    v_cvt_pk_bf16_f32 v203, v206, v207
    v_mfma_f32_16x16x32_bf16 v[88:91], v[24:27], v[48:51], v[88:91]
    v_mfma_f32_16x16x32_bf16 v[92:95], v[28:31], v[48:51], v[92:95]
    ds_read_b64_tr_b16 v[36:37], v3 offset:40960
    s_add_u32 s15, s66, 0x400
    buffer_store_dwordx4 v[200:203], v2, s[36:39], s15 offen sc1
    ds_read_b64_tr_b16 v[38:39], v3 offset:41984
    s_setprio 1
    s_waitcnt lgkmcnt(5)
    v_mfma_f32_16x16x32_bf16 v[96:99], v[16:19], v[52:55], v[96:99]
    v_mfma_f32_16x16x32_bf16 v[100:103], v[20:23], v[52:55], v[100:103]
    ds_read_b64_tr_b16 v[40:41], v10 offset:40960
    s_add_u32 m0, s60, 0x14000
    s_add_u32 s14, s64, 0x300
    buffer_load_dwordx4 v14, s[20:23], s14 offen lds
    v_cvt_pk_bf16_f32 v208, v208, v209
    v_cvt_pk_bf16_f32 v209, v210, v211
    v_mfma_f32_16x16x32_bf16 v[104:107], v[24:27], v[52:55], v[104:107]
    v_mfma_f32_16x16x32_bf16 v[108:111], v[28:31], v[52:55], v[108:111]
    ds_read_b64_tr_b16 v[42:43], v10 offset:41984
    v_cvt_pk_bf16_f32 v210, v212, v213
    ds_read_b64_tr_b16 v[44:45], v11 offset:40960
    s_waitcnt lgkmcnt(7)
    v_mfma_f32_16x16x32_bf16 v[112:115], v[16:19], v[56:59], v[112:115]
    v_mfma_f32_16x16x32_bf16 v[116:119], v[20:23], v[56:59], v[116:119]
    ds_read_b64_tr_b16 v[46:47], v11 offset:41984
    s_add_u32 m0, s60, 0x16000
    s_add_u32 s14, s64, 0x10300
    buffer_load_dwordx4 v14, s[20:23], s14 offen lds
    v_cvt_pk_bf16_f32 v211, v214, v215
    v_mfma_f32_16x16x32_bf16 v[120:123], v[24:27], v[56:59], v[120:123]
    v_mfma_f32_16x16x32_bf16 v[124:127], v[28:31], v[56:59], v[124:127]
    ds_read_b128 v[60:63], v7 offset:0
    s_add_u32 s15, s66, 0x2000
    buffer_store_dwordx4 v[208:211], v2, s[36:39], s15 offen sc1
    ds_read_b128 v[48:51], v7 offset:2048
    s_setprio 0
    s_waitcnt lgkmcnt(1)
    v_mfma_f32_16x16x32_bf16 v[64:67], v[32:35], v[60:63], v[64:67]
    v_mfma_f32_16x16x32_bf16 v[68:71], v[36:39], v[60:63], v[68:71]
    ds_read_b128 v[52:55], v7 offset:4096
    v_cvt_pk_bf16_f32 v216, v216, v217
    v_cvt_pk_bf16_f32 v217, v218, v219
    v_mfma_f32_16x16x32_bf16 v[72:75], v[40:43], v[60:63], v[72:75]
    v_mfma_f32_16x16x32_bf16 v[76:79], v[44:47], v[60:63], v[76:79]
    ds_read_b128 v[56:59], v7 offset:6144
    v_cvt_pk_bf16_f32 v218, v220, v221
    s_waitcnt lgkmcnt(2)
    v_mfma_f32_16x16x32_bf16 v[80:83], v[32:35], v[48:51], v[80:83]
    v_mfma_f32_16x16x32_bf16 v[84:87], v[36:39], v[48:51], v[84:87]
    v_cvt_pk_bf16_f32 v219, v222, v223
    v_mfma_f32_16x16x32_bf16 v[88:91], v[40:43], v[48:51], v[88:91]
    v_mfma_f32_16x16x32_bf16 v[92:95], v[44:47], v[48:51], v[92:95]
    s_add_u32 s15, s66, 0x2400
    buffer_store_dwordx4 v[216:219], v2, s[36:39], s15 offen sc1
    s_waitcnt vmcnt(12) lgkmcnt(0)
    s_barrier
    s_setprio 3
    v_mfma_f32_16x16x32_bf16 v[96:99], v[32:35], v[52:55], v[96:99]
    ds_read_b64_tr_b16 v[16:17], v0 offset:0
    v_mfma_f32_16x16x32_bf16 v[100:103], v[36:39], v[52:55], v[100:103]
    ds_read_b64_tr_b16 v[18:19], v0 offset:1024
    s_add_u32 m0, s60, 0x20000
    s_add_u32 s14, s62, 0x380000
    buffer_load_dwordx4 v15, s[32:35], s14 offen lds
    v_mfma_f32_16x16x32_bf16 v[104:107], v[40:43], v[52:55], v[104:107]
    ds_read_b64_tr_b16 v[20:21], v3 offset:0
    v_mfma_f32_16x16x32_bf16 v[108:111], v[44:47], v[52:55], v[108:111]
    ds_read_b64_tr_b16 v[22:23], v3 offset:1024
    ds_read_b64_tr_b16 v[24:25], v10 offset:0
    v_mfma_f32_16x16x32_bf16 v[112:115], v[32:35], v[56:59], v[112:115]
    ds_read_b64_tr_b16 v[26:27], v10 offset:1024
    v_mfma_f32_16x16x32_bf16 v[116:119], v[36:39], v[56:59], v[116:119]
    ds_read_b64_tr_b16 v[28:29], v11 offset:0
    s_add_u32 m0, s60, 0x22000
    s_add_u32 s14, s62, 0x3c0000
    buffer_load_dwordx4 v15, s[32:35], s14 offen lds
    v_mfma_f32_16x16x32_bf16 v[120:123], v[40:43], v[56:59], v[120:123]
    ds_read_b64_tr_b16 v[30:31], v11 offset:1024
    v_mfma_f32_16x16x32_bf16 v[124:127], v[44:47], v[56:59], v[124:127]
    ds_read_b128 v[60:63], v6 offset:32768
    ds_read_b128 v[48:51], v6 offset:34816
    s_setprio 2
    s_waitcnt lgkmcnt(1)
    v_mfma_f32_16x16x32_bf16 v[64:67], v[16:19], v[60:63], v[64:67]
    v_mfma_f32_16x16x32_bf16 v[68:71], v[20:23], v[60:63], v[68:71]
    ds_read_b128 v[52:55], v6 offset:36864
    s_add_u32 m0, s60, 0x0
    s_add_u32 s14, s63, 0x380
    buffer_load_dwordx4 v14, s[20:23], s14 offen lds
    v_mfma_f32_16x16x32_bf16 v[72:75], v[24:27], v[60:63], v[72:75]
    v_mfma_f32_16x16x32_bf16 v[76:79], v[28:31], v[60:63], v[76:79]
    ds_read_b128 v[56:59], v6 offset:38912
    ds_read_b64_tr_b16 v[32:33], v0 offset:8192
    s_waitcnt lgkmcnt(3)
    v_mfma_f32_16x16x32_bf16 v[80:83], v[16:19], v[48:51], v[80:83]
    v_mfma_f32_16x16x32_bf16 v[84:87], v[20:23], v[48:51], v[84:87]
    ds_read_b64_tr_b16 v[34:35], v0 offset:9216
    s_add_u32 m0, s60, 0x2000
    s_add_u32 s14, s63, 0x10380
    buffer_load_dwordx4 v14, s[20:23], s14 offen lds
    v_mfma_f32_16x16x32_bf16 v[88:91], v[24:27], v[48:51], v[88:91]
    v_mfma_f32_16x16x32_bf16 v[92:95], v[28:31], v[48:51], v[92:95]
    ds_read_b64_tr_b16 v[36:37], v3 offset:8192
    ds_read_b64_tr_b16 v[38:39], v3 offset:9216
    s_setprio 1
    s_waitcnt lgkmcnt(5)
    v_mfma_f32_16x16x32_bf16 v[96:99], v[16:19], v[52:55], v[96:99]
    v_mfma_f32_16x16x32_bf16 v[100:103], v[20:23], v[52:55], v[100:103]
    ds_read_b64_tr_b16 v[40:41], v10 offset:8192
    s_add_u32 m0, s60, 0x4000
    s_add_u32 s14, s64, 0x380
    buffer_load_dwordx4 v14, s[20:23], s14 offen lds
    v_mfma_f32_16x16x32_bf16 v[104:107], v[24:27], v[52:55], v[104:107]
    v_mfma_f32_16x16x32_bf16 v[108:111], v[28:31], v[52:55], v[108:111]
    ds_read_b64_tr_b16 v[42:43], v10 offset:9216
    ds_read_b64_tr_b16 v[44:45], v11 offset:8192
    s_waitcnt lgkmcnt(7)
    v_mfma_f32_16x16x32_bf16 v[112:115], v[16:19], v[56:59], v[112:115]
    v_mfma_f32_16x16x32_bf16 v[116:119], v[20:23], v[56:59], v[116:119]
    ds_read_b64_tr_b16 v[46:47], v11 offset:9216
    s_add_u32 m0, s60, 0x6000
    s_add_u32 s14, s64, 0x10380
    buffer_load_dwordx4 v14, s[20:23], s14 offen lds
    v_mfma_f32_16x16x32_bf16 v[120:123], v[24:27], v[56:59], v[120:123]
    v_mfma_f32_16x16x32_bf16 v[124:127], v[28:31], v[56:59], v[124:127]
    ds_read_b128 v[60:63], v7 offset:32768
    ds_read_b128 v[48:51], v7 offset:34816
    s_setprio 0
    s_waitcnt lgkmcnt(1)
    v_mfma_f32_16x16x32_bf16 v[64:67], v[32:35], v[60:63], v[64:67]
    v_mfma_f32_16x16x32_bf16 v[68:71], v[36:39], v[60:63], v[68:71]
    ds_read_b128 v[52:55], v7 offset:36864
    v_mfma_f32_16x16x32_bf16 v[72:75], v[40:43], v[60:63], v[72:75]
    v_mfma_f32_16x16x32_bf16 v[76:79], v[44:47], v[60:63], v[76:79]
    ds_read_b128 v[56:59], v7 offset:38912
    s_waitcnt lgkmcnt(2)
    v_mfma_f32_16x16x32_bf16 v[80:83], v[32:35], v[48:51], v[80:83]
    v_mfma_f32_16x16x32_bf16 v[84:87], v[36:39], v[48:51], v[84:87]
    v_mfma_f32_16x16x32_bf16 v[88:91], v[40:43], v[48:51], v[88:91]
    v_mfma_f32_16x16x32_bf16 v[92:95], v[44:47], v[48:51], v[92:95]
    s_waitcnt vmcnt(8) lgkmcnt(0)
    s_barrier
    s_setprio 3
    v_mfma_f32_16x16x32_bf16 v[96:99], v[32:35], v[52:55], v[96:99]
    ds_read_b64_tr_b16 v[16:17], v0 offset:16384
    v_mfma_f32_16x16x32_bf16 v[100:103], v[36:39], v[52:55], v[100:103]
    ds_read_b64_tr_b16 v[18:19], v0 offset:17408
    v_mfma_f32_16x16x32_bf16 v[104:107], v[40:43], v[52:55], v[104:107]
    ds_read_b64_tr_b16 v[20:21], v3 offset:16384
    v_mfma_f32_16x16x32_bf16 v[108:111], v[44:47], v[52:55], v[108:111]
    ds_read_b64_tr_b16 v[22:23], v3 offset:17408
    ds_read_b64_tr_b16 v[24:25], v10 offset:16384
    v_mfma_f32_16x16x32_bf16 v[112:115], v[32:35], v[56:59], v[112:115]
    ds_read_b64_tr_b16 v[26:27], v10 offset:17408
    v_mfma_f32_16x16x32_bf16 v[116:119], v[36:39], v[56:59], v[116:119]
    ds_read_b64_tr_b16 v[28:29], v11 offset:16384
    v_mfma_f32_16x16x32_bf16 v[120:123], v[40:43], v[56:59], v[120:123]
    ds_read_b64_tr_b16 v[30:31], v11 offset:17408
    v_mfma_f32_16x16x32_bf16 v[124:127], v[44:47], v[56:59], v[124:127]
    ds_read_b128 v[60:63], v8 offset:0
    ds_read_b128 v[48:51], v8 offset:2048
    s_setprio 2
    s_waitcnt lgkmcnt(1)
    v_mfma_f32_16x16x32_bf16 v[64:67], v[16:19], v[60:63], v[64:67]
    v_mfma_f32_16x16x32_bf16 v[68:71], v[20:23], v[60:63], v[68:71]
    ds_read_b128 v[52:55], v8 offset:4096
    v_mfma_f32_16x16x32_bf16 v[72:75], v[24:27], v[60:63], v[72:75]
    v_mfma_f32_16x16x32_bf16 v[76:79], v[28:31], v[60:63], v[76:79]
    ds_read_b128 v[56:59], v8 offset:6144
    ds_read_b64_tr_b16 v[32:33], v0 offset:24576
    s_waitcnt lgkmcnt(3)
    v_mfma_f32_16x16x32_bf16 v[80:83], v[16:19], v[48:51], v[80:83]
    v_mfma_f32_16x16x32_bf16 v[84:87], v[20:23], v[48:51], v[84:87]
    ds_read_b64_tr_b16 v[34:35], v0 offset:25600
    v_mfma_f32_16x16x32_bf16 v[88:91], v[24:27], v[48:51], v[88:91]
    v_mfma_f32_16x16x32_bf16 v[92:95], v[28:31], v[48:51], v[92:95]
    ds_read_b64_tr_b16 v[36:37], v3 offset:24576
    ds_read_b64_tr_b16 v[38:39], v3 offset:25600
    s_setprio 1
    s_waitcnt lgkmcnt(5)
    v_mfma_f32_16x16x32_bf16 v[96:99], v[16:19], v[52:55], v[96:99]
    v_mfma_f32_16x16x32_bf16 v[100:103], v[20:23], v[52:55], v[100:103]
    ds_read_b64_tr_b16 v[40:41], v10 offset:24576
    v_mfma_f32_16x16x32_bf16 v[104:107], v[24:27], v[52:55], v[104:107]
    v_mfma_f32_16x16x32_bf16 v[108:111], v[28:31], v[52:55], v[108:111]
    ds_read_b64_tr_b16 v[42:43], v10 offset:25600
    ds_read_b64_tr_b16 v[44:45], v11 offset:24576
    s_waitcnt lgkmcnt(7)
    v_mfma_f32_16x16x32_bf16 v[112:115], v[16:19], v[56:59], v[112:115]
    v_mfma_f32_16x16x32_bf16 v[116:119], v[20:23], v[56:59], v[116:119]
    ds_read_b64_tr_b16 v[46:47], v11 offset:25600
    v_mfma_f32_16x16x32_bf16 v[120:123], v[24:27], v[56:59], v[120:123]
    v_mfma_f32_16x16x32_bf16 v[124:127], v[28:31], v[56:59], v[124:127]
    ds_read_b128 v[60:63], v9 offset:0
    ds_read_b128 v[48:51], v9 offset:2048
    s_setprio 0
    s_waitcnt lgkmcnt(1)
    v_mfma_f32_16x16x32_bf16 v[64:67], v[32:35], v[60:63], v[64:67]
    v_mfma_f32_16x16x32_bf16 v[68:71], v[36:39], v[60:63], v[68:71]
    ds_read_b128 v[52:55], v9 offset:4096
    v_mfma_f32_16x16x32_bf16 v[72:75], v[40:43], v[60:63], v[72:75]
    v_mfma_f32_16x16x32_bf16 v[76:79], v[44:47], v[60:63], v[76:79]
    ds_read_b128 v[56:59], v9 offset:6144
    s_waitcnt lgkmcnt(2)
    v_mfma_f32_16x16x32_bf16 v[80:83], v[32:35], v[48:51], v[80:83]
    v_mfma_f32_16x16x32_bf16 v[84:87], v[36:39], v[48:51], v[84:87]
    v_mfma_f32_16x16x32_bf16 v[88:91], v[40:43], v[48:51], v[88:91]
    v_mfma_f32_16x16x32_bf16 v[92:95], v[44:47], v[48:51], v[92:95]
    s_waitcnt vmcnt(0) lgkmcnt(0)
    s_barrier
    s_setprio 3
    v_mfma_f32_16x16x32_bf16 v[96:99], v[32:35], v[52:55], v[96:99]
    ds_read_b64_tr_b16 v[16:17], v0 offset:32768
    v_mfma_f32_16x16x32_bf16 v[100:103], v[36:39], v[52:55], v[100:103]
    ds_read_b64_tr_b16 v[18:19], v0 offset:33792
    v_mfma_f32_16x16x32_bf16 v[104:107], v[40:43], v[52:55], v[104:107]
    ds_read_b64_tr_b16 v[20:21], v3 offset:32768
    v_mfma_f32_16x16x32_bf16 v[108:111], v[44:47], v[52:55], v[108:111]
    ds_read_b64_tr_b16 v[22:23], v3 offset:33792
    ds_read_b64_tr_b16 v[24:25], v10 offset:32768
    v_mfma_f32_16x16x32_bf16 v[112:115], v[32:35], v[56:59], v[112:115]
    ds_read_b64_tr_b16 v[26:27], v10 offset:33792
    v_mfma_f32_16x16x32_bf16 v[116:119], v[36:39], v[56:59], v[116:119]
    ds_read_b64_tr_b16 v[28:29], v11 offset:32768
    v_mfma_f32_16x16x32_bf16 v[120:123], v[40:43], v[56:59], v[120:123]
    ds_read_b64_tr_b16 v[30:31], v11 offset:33792
    v_mfma_f32_16x16x32_bf16 v[124:127], v[44:47], v[56:59], v[124:127]
    ds_read_b128 v[60:63], v6 offset:0
    ds_read_b128 v[48:51], v6 offset:2048
    s_setprio 2
    s_waitcnt lgkmcnt(1)
    v_mfma_f32_16x16x32_bf16 v[64:67], v[16:19], v[60:63], v[64:67]
    v_mfma_f32_16x16x32_bf16 v[68:71], v[20:23], v[60:63], v[68:71]
    ds_read_b128 v[52:55], v6 offset:4096
    v_mfma_f32_16x16x32_bf16 v[72:75], v[24:27], v[60:63], v[72:75]
    v_mfma_f32_16x16x32_bf16 v[76:79], v[28:31], v[60:63], v[76:79]
    ds_read_b128 v[56:59], v6 offset:6144
    ds_read_b64_tr_b16 v[32:33], v0 offset:40960
    s_waitcnt lgkmcnt(3)
    v_mfma_f32_16x16x32_bf16 v[80:83], v[16:19], v[48:51], v[80:83]
    v_mfma_f32_16x16x32_bf16 v[84:87], v[20:23], v[48:51], v[84:87]
    ds_read_b64_tr_b16 v[34:35], v0 offset:41984
    v_mfma_f32_16x16x32_bf16 v[88:91], v[24:27], v[48:51], v[88:91]
    v_mfma_f32_16x16x32_bf16 v[92:95], v[28:31], v[48:51], v[92:95]
    ds_read_b64_tr_b16 v[36:37], v3 offset:40960
    ds_read_b64_tr_b16 v[38:39], v3 offset:41984
    s_setprio 1
    s_waitcnt lgkmcnt(5)
    v_mfma_f32_16x16x32_bf16 v[96:99], v[16:19], v[52:55], v[96:99]
    v_mfma_f32_16x16x32_bf16 v[100:103], v[20:23], v[52:55], v[100:103]
    ds_read_b64_tr_b16 v[40:41], v10 offset:40960
    v_mfma_f32_16x16x32_bf16 v[104:107], v[24:27], v[52:55], v[104:107]
    v_mfma_f32_16x16x32_bf16 v[108:111], v[28:31], v[52:55], v[108:111]
    ds_read_b64_tr_b16 v[42:43], v10 offset:41984
    ds_read_b64_tr_b16 v[44:45], v11 offset:40960
    s_waitcnt lgkmcnt(7)
    v_mfma_f32_16x16x32_bf16 v[112:115], v[16:19], v[56:59], v[112:115]
    v_mfma_f32_16x16x32_bf16 v[116:119], v[20:23], v[56:59], v[116:119]
    ds_read_b64_tr_b16 v[46:47], v11 offset:41984
    v_mfma_f32_16x16x32_bf16 v[120:123], v[24:27], v[56:59], v[120:123]
    v_mfma_f32_16x16x32_bf16 v[124:127], v[28:31], v[56:59], v[124:127]
    ds_read_b128 v[60:63], v7 offset:0
    ds_read_b128 v[48:51], v7 offset:2048
    s_setprio 0
    s_waitcnt lgkmcnt(1)
    v_mfma_f32_16x16x32_bf16 v[64:67], v[32:35], v[60:63], v[64:67]
    v_mfma_f32_16x16x32_bf16 v[68:71], v[36:39], v[60:63], v[68:71]
    ds_read_b128 v[52:55], v7 offset:4096
    v_mfma_f32_16x16x32_bf16 v[72:75], v[40:43], v[60:63], v[72:75]
    v_mfma_f32_16x16x32_bf16 v[76:79], v[44:47], v[60:63], v[76:79]
    ds_read_b128 v[56:59], v7 offset:6144
    s_waitcnt lgkmcnt(2)
    v_mfma_f32_16x16x32_bf16 v[80:83], v[32:35], v[48:51], v[80:83]
    v_mfma_f32_16x16x32_bf16 v[84:87], v[36:39], v[48:51], v[84:87]
    v_mfma_f32_16x16x32_bf16 v[88:91], v[40:43], v[48:51], v[88:91]
    v_mfma_f32_16x16x32_bf16 v[92:95], v[44:47], v[48:51], v[92:95]
    s_waitcnt lgkmcnt(0)
    s_barrier
    s_setprio 3
    v_mfma_f32_16x16x32_bf16 v[96:99], v[32:35], v[52:55], v[96:99]
    v_mfma_f32_16x16x32_bf16 v[100:103], v[36:39], v[52:55], v[100:103]
    s_and_b32 s20, s3, 3
    s_lshr_b32 s21, s3, 2
    s_lshl_b32 s14, s5, 1
    s_add_u32 s23, s14, 2
    s_sub_u32 s24, 15, s14
    s_cmp_eq_u32 s21, 0
    s_cselect_b32 s24, 0, s24
    s_cselect_b32 s23, s23, 30
    s_cselect_b32 s25, s14, 15
    s_lshl_b32 s26, s4, 20
    s_lshl_b32 s14, s20, 12
    s_add_u32 s26, s26, s14
    s_lshl_b32 s27, s21, 16
    v_add_u32 v3, s27, v2
    s_add_u32 s27, s27, s14
    s_lshl_b32 s33, 1, s23
    s_lshr_b32 s32, s33, 1
    s_lshl_b32 s34, 3, s25
    s_lshr_b32 s34, s34, 1
    s_or_b32 s34, s34, s32
    s_or_b32 s34, s34, s33
    s_cmp_eq_u32 s3, 0
    s_cselect_b32 s71, 0x600, 0
    s_or_b32 s34, s34, s71
    s_lshl_b32 s14, s20, 13
    s_add_u32 s14, s14, 0x20000
    s_mov_b32 s75, s14
    v_and_b32 v11, 7, v1
    v_lshlrev_b32 v11, 3, v11
    s_lshl_b32 s74, s4, 7
    s_add_u32 s74, s74, 12288
    v_mfma_f32_16x16x32_bf16 v[104:107], v[40:43], v[52:55], v[104:107]
    v_mfma_f32_16x16x32_bf16 v[108:111], v[44:47], v[52:55], v[108:111]
    v_mfma_f32_16x16x32_bf16 v[112:115], v[32:35], v[56:59], v[112:115]
    v_mfma_f32_16x16x32_bf16 v[116:119], v[36:39], v[56:59], v[116:119]
    v_mfma_f32_16x16x32_bf16 v[120:123], v[40:43], v[56:59], v[120:123]
    v_mfma_f32_16x16x32_bf16 v[124:127], v[44:47], v[56:59], v[124:127]
hand_0:
    s_setprio 0
    v_mul_f32 v64, s73, v64
    v_mul_f32 v65, s73, v65
    v_cvt_pk_bf16_f32 v64, v64, v65
    v_mul_f32 v66, s73, v66
    v_mul_f32 v67, s73, v67
    v_cvt_pk_bf16_f32 v65, v66, v67
    v_mul_f32 v68, s73, v68
    v_mul_f32 v69, s73, v69
    v_cvt_pk_bf16_f32 v66, v68, v69
    v_mul_f32 v70, s73, v70
    v_mul_f32 v71, s73, v71
    v_cvt_pk_bf16_f32 v67, v70, v71
    v_mul_f32 v72, s73, v72
    v_mul_f32 v73, s73, v73
    v_cvt_pk_bf16_f32 v68, v72, v73
    v_mul_f32 v74, s73, v74
    v_mul_f32 v75, s73, v75
    v_cvt_pk_bf16_f32 v69, v74, v75
    v_mul_f32 v76, s73, v76
    v_mul_f32 v77, s73, v77
    v_cvt_pk_bf16_f32 v70, v76, v77
    v_mul_f32 v78, s73, v78
    v_mul_f32 v79, s73, v79
    v_cvt_pk_bf16_f32 v71, v78, v79
    v_mul_f32 v80, s73, v80
    v_mul_f32 v81, s73, v81
    v_cvt_pk_bf16_f32 v72, v80, v81
    v_mul_f32 v82, s73, v82
    v_mul_f32 v83, s73, v83
    v_cvt_pk_bf16_f32 v73, v82, v83
    v_mul_f32 v84, s73, v84
    v_mul_f32 v85, s73, v85
    v_cvt_pk_bf16_f32 v74, v84, v85
    v_mul_f32 v86, s73, v86
    v_mul_f32 v87, s73, v87
    v_cvt_pk_bf16_f32 v75, v86, v87
    v_mul_f32 v88, s73, v88
    v_mul_f32 v89, s73, v89
    v_cvt_pk_bf16_f32 v76, v88, v89
    v_mul_f32 v90, s73, v90
    v_mul_f32 v91, s73, v91
    v_cvt_pk_bf16_f32 v77, v90, v91
    v_mul_f32 v92, s73, v92
    v_mul_f32 v93, s73, v93
    v_cvt_pk_bf16_f32 v78, v92, v93
    v_mul_f32 v94, s73, v94
    v_mul_f32 v95, s73, v95
    v_cvt_pk_bf16_f32 v79, v94, v95
    v_mul_f32 v96, s73, v96
    v_mul_f32 v97, s73, v97
    v_cvt_pk_bf16_f32 v80, v96, v97
    v_mul_f32 v98, s73, v98
    v_mul_f32 v99, s73, v99
    v_cvt_pk_bf16_f32 v81, v98, v99
    v_mul_f32 v100, s73, v100
    v_mul_f32 v101, s73, v101
    v_cvt_pk_bf16_f32 v82, v100, v101
    v_mul_f32 v102, s73, v102
    v_mul_f32 v103, s73, v103
    v_cvt_pk_bf16_f32 v83, v102, v103
    v_mul_f32 v104, s73, v104
    v_mul_f32 v105, s73, v105
    v_cvt_pk_bf16_f32 v84, v104, v105
    v_mul_f32 v106, s73, v106
    v_mul_f32 v107, s73, v107
    v_cvt_pk_bf16_f32 v85, v106, v107
    v_mul_f32 v108, s73, v108
    v_mul_f32 v109, s73, v109
    v_cvt_pk_bf16_f32 v86, v108, v109
    v_mul_f32 v110, s73, v110
    v_mul_f32 v111, s73, v111
    v_cvt_pk_bf16_f32 v87, v110, v111
    v_mul_f32 v112, s73, v112
    v_mul_f32 v113, s73, v113
    v_cvt_pk_bf16_f32 v88, v112, v113
    v_mul_f32 v114, s73, v114
    v_mul_f32 v115, s73, v115
    v_cvt_pk_bf16_f32 v89, v114, v115
    v_mul_f32 v116, s73, v116
    v_mul_f32 v117, s73, v117
    v_cvt_pk_bf16_f32 v90, v116, v117
    v_mul_f32 v118, s73, v118
    v_mul_f32 v119, s73, v119
    v_cvt_pk_bf16_f32 v91, v118, v119
    v_mul_f32 v120, s73, v120
    v_mul_f32 v121, s73, v121
    v_cvt_pk_bf16_f32 v92, v120, v121
    v_mul_f32 v122, s73, v122
    v_mul_f32 v123, s73, v123
    v_cvt_pk_bf16_f32 v93, v122, v123
    v_mul_f32 v124, s73, v124
    v_mul_f32 v125, s73, v125
    v_cvt_pk_bf16_f32 v94, v124, v125
    v_mul_f32 v126, s73, v126
    v_mul_f32 v127, s73, v127
    v_cvt_pk_bf16_f32 v95, v126, v127
    buffer_load_dwordx2 v[6:7], v11, s[8:11], s74 offen offset:0 sc1
    s_lshr_b32 s14, s20, 1
    s_lshl_b32 s15, s14, 14
    s_add_u32 s15, s15, 0x20000
    s_lshl_b32 s14, s14, 16
    s_add_u32 s14, s14, 0x8000
    s_cmp_eq_u32 s21, 0
    s_cselect_b32 s14, s14, s15
    s_and_b32 s15, s20, 1
    s_lshl_b32 s35, s15, 11
    s_add_u32 s35, s35, s14
    v_add_u32 v9, s35, v2
    v_add_u32 v5, s75, v2
    ds_write_b128 v9, v[64:67] offset:0
    ds_write_b128 v9, v[68:71] offset:1024
    ds_write_b128 v9, v[72:75] offset:4096
    ds_write_b128 v9, v[76:79] offset:5120
    ds_write_b128 v9, v[80:83] offset:8192
    ds_write_b128 v9, v[84:87] offset:9216
    ds_write_b128 v9, v[88:91] offset:12288
    ds_write_b128 v9, v[92:95] offset:13312
    s_lshl_b32 s15, s15, 13
    s_add_u32 s14, s14, s15
    v_add_u32 v9, s14, v2
    s_waitcnt vmcnt(0)
    v_xor_b32 v6, s6, v6
    v_xor_b32 v7, s6, v7
    v_or_b32 v6, v6, v7
    v_cmp_ne_u32 vcc, 0, v6
    s_nop 0
    s_cbranch_vccnz concat_pslow_29
concat_pback_30:
    s_mov_b32 s22, 0
    v_add_u32 v8, 3, v1
    v_and_b32 v8, 63, v8
    v_add_u32 v4, s24, v8
    v_subrev_u32 v10, s23, v8
    v_cmp_gt_u32 vcc, s23, v8
    s_nop 1
    v_cndmask_b32 v4, v10, v4, vcc
    v_lshlrev_b32 v4, 15, v4
    v_add_u32 v4, s26, v4
    s_lshl_b32 s72, s5, 3
    s_add_u32 s72, s72, s3
    s_lshl_b32 s72, s72, 16
    s_add_u32 s72, s72, 0x4c00000
    s_add_u32 s14, s72, 20480
    v_writelane_b32 v4, s14, 14
    s_nop 0
    v_readlane_b32 s28, v4, 61
    s_add_u32 m0, s27, 0x0
    s_nop 3
    buffer_load_dwordx4 v2, s[36:39], s28 offen offset:0 sc1 lds
    buffer_load_dwordx4 v2, s[36:39], s28 offen offset:1024 sc1 lds
    buffer_load_dwordx4 v2, s[36:39], s28 offen offset:2048 sc1 lds
    buffer_load_dwordx4 v2, s[36:39], s28 offen offset:3072 sc1 lds
    s_add_u32 s75, s28, 0x4000
    v_readlane_b32 s28, v4, 62
    s_add_u32 m0, s27, 0x4000
    s_nop 3
    buffer_load_dwordx4 v2, s[36:39], s28 offen offset:0 sc1 lds
    buffer_load_dwordx4 v2, s[36:39], s28 offen offset:1024 sc1 lds
    buffer_load_dwordx4 v2, s[36:39], s28 offen offset:2048 sc1 lds
    buffer_load_dwordx4 v2, s[36:39], s28 offen offset:3072 sc1 lds
    s_add_u32 s29, s28, 0x4000
    s_waitcnt lgkmcnt(0)
    s_barrier
    ds_read_b128 v[32:35], v9 offset:0
    ds_read_b128 v[36:39], v9 offset:1024
    ds_read_b128 v[40:43], v9 offset:2048
    ds_read_b128 v[44:47], v9 offset:3072
    ds_read_b128 v[48:51], v9 offset:4096
    ds_read_b128 v[52:55], v9 offset:5120
    ds_read_b128 v[56:59], v9 offset:6144
    ds_read_b128 v[60:63], v9 offset:7168
    s_load_dwordx2 s[66:67], s[0:1], 72
    s_add_u32 s16, s12, 0x3000000
    s_addc_u32 s17, s13, 0
    s_mov_b32 s18, 0x1000000
    s_mov_b32 s19, 0x20000
    s_lshl_b32 s14, s5, 2
    s_add_u32 s30, s14, s20
    s_lshl_b32 s30, s30, 5
    s_add_u32 s30, s30, s4
    s_lshl_b32 s30, s30, 13
    s_sub_u32 s31, 60, s14
    s_add_u32 s31, s31, s20
    s_lshl_b32 s31, s31, 5
    s_add_u32 s31, s31, s4
    s_lshl_b32 s31, s31, 13
    v_and_b32 v0, 15, v1
    v_lshrrev_b32 v9, 4, v1
    v_lshlrev_b32 v9, 2, v9
    v_sub_u32 v0, v0, v9
    v_mov_b32 v28, 0x3f803f80
    v_mov_b32 v29, 0x3f803f80
    v_mov_b32 v30, 0x3f803f80
    v_mov_b32 v31, 0x3f803f80
    v_mov_b32 v24, 0
    v_mov_b32 v25, 0
    v_mov_b32 v16, 0
    v_mov_b32 v17, 0
    v_mov_b32 v18, 0
    v_mov_b32 v19, 0
    v_mov_b32 v20, 0
    v_mov_b32 v21, 0
    v_mov_b32 v22, 0
    v_mov_b32 v23, 0
    v_mov_b32 v64, 0
    v_mov_b32 v65, 0
    v_mov_b32 v66, 0
    v_mov_b32 v67, 0
    v_mov_b32 v68, 0
    v_mov_b32 v69, 0
    v_mov_b32 v70, 0
    v_mov_b32 v71, 0
    v_mov_b32 v72, 0
    v_mov_b32 v73, 0
    v_mov_b32 v74, 0
    v_mov_b32 v75, 0
    v_mov_b32 v76, 0
    v_mov_b32 v77, 0
    v_mov_b32 v78, 0
    v_mov_b32 v79, 0
    v_mov_b32 v80, 0
    v_mov_b32 v81, 0
    v_mov_b32 v82, 0
    v_mov_b32 v83, 0
    v_mov_b32 v84, 0
    v_mov_b32 v85, 0
    v_mov_b32 v86, 0
    v_mov_b32 v87, 0
    v_mov_b32 v88, 0
    v_mov_b32 v89, 0
    v_mov_b32 v90, 0
    v_mov_b32 v91, 0
    v_mov_b32 v92, 0
    v_mov_b32 v93, 0
    v_mov_b32 v94, 0
    v_mov_b32 v95, 0
    v_mov_b32 v96, 0
    v_mov_b32 v97, 0
    v_mov_b32 v98, 0
    v_mov_b32 v99, 0
    v_mov_b32 v100, 0
    v_mov_b32 v101, 0
    v_mov_b32 v102, 0
    v_mov_b32 v103, 0
    v_mov_b32 v104, 0
    v_mov_b32 v105, 0
    v_mov_b32 v106, 0
    v_mov_b32 v107, 0
    v_mov_b32 v108, 0
    v_mov_b32 v109, 0
    v_mov_b32 v110, 0
    v_mov_b32 v111, 0
    v_mov_b32 v112, 0
    v_mov_b32 v113, 0
    v_mov_b32 v114, 0
    v_mov_b32 v115, 0
    v_mov_b32 v116, 0
    v_mov_b32 v117, 0
    v_mov_b32 v118, 0
    v_mov_b32 v119, 0
    v_mov_b32 v120, 0
    v_mov_b32 v121, 0
    v_mov_b32 v122, 0
    v_mov_b32 v123, 0
    v_mov_b32 v124, 0
    v_mov_b32 v125, 0
    v_mov_b32 v126, 0
    v_mov_b32 v127, 0
    s_waitcnt vmcnt(0) lgkmcnt(0)
    s_mov_b32 s52, s66
    s_mov_b32 s53, s67
    s_mov_b32 s54, 0x400000
    s_mov_b32 s55, 0x20000
    s_barrier
    ds_read_b128 v[216:219], v3 offset:0
    ds_read_b128 v[220:223], v3 offset:1024
    ds_read_b128 v[224:227], v3 offset:2048
    ds_read_b128 v[228:231], v3 offset:3072
    ds_read_b128 v[232:235], v3 offset:4096
    ds_read_b128 v[236:239], v3 offset:5120
    s_waitcnt lgkmcnt(4)
    v_mfma_f32_16x16x32_bf16 v[128:131], v[216:219], v[32:35], v[16:19]
    v_mfma_f32_16x16x32_bf16 v[128:131], v[220:223], v[36:39], v[128:131]
    ds_read_b128 v[240:243], v3 offset:6144
    s_add_u32 m0, s27, 0x8000
    s_nop 0
    buffer_load_dwordx4 v2, s[36:39], s75 offen offset:0 sc1 lds
    v_mfma_f32_16x16x32_bf16 v[136:139], v[216:219], v[48:51], v[20:23]
    v_mfma_f32_16x16x32_bf16 v[136:139], v[220:223], v[52:55], v[136:139]
    ds_read_b128 v[244:247], v3 offset:7168
    buffer_load_dwordx4 v2, s[36:39], s75 offen offset:1024 sc1 lds
    s_waitcnt lgkmcnt(4)
    v_mfma_f32_16x16x32_bf16 v[128:131], v[224:227], v[40:43], v[128:131]
    v_mfma_f32_16x16x32_bf16 v[128:131], v[228:231], v[44:47], v[128:131]
    ds_read_b128 v[216:219], v3 offset:8192
    buffer_load_dwordx4 v2, s[36:39], s75 offen offset:2048 sc1 lds
    v_mfma_f32_16x16x32_bf16 v[136:139], v[224:227], v[56:59], v[136:139]
    v_mfma_f32_16x16x32_bf16 v[136:139], v[228:231], v[60:63], v[136:139]
    ds_read_b128 v[220:223], v3 offset:9216
    buffer_load_dwordx4 v2, s[36:39], s75 offen offset:3072 sc1 lds
    s_waitcnt lgkmcnt(4)
    v_mfma_f32_16x16x32_bf16 v[132:135], v[232:235], v[32:35], v[16:19]
    v_mfma_f32_16x16x32_bf16 v[132:135], v[236:239], v[36:39], v[132:135]
    ds_read_b128 v[224:227], v3 offset:10240
    s_add_u32 m0, s27, 0xc000
    s_nop 0
    buffer_load_dwordx4 v2, s[36:39], s29 offen offset:0 sc1 lds
    v_mfma_f32_16x16x32_bf16 v[140:143], v[232:235], v[48:51], v[20:23]
    v_mfma_f32_16x16x32_bf16 v[140:143], v[236:239], v[52:55], v[140:143]
    ds_read_b128 v[228:231], v3 offset:11264
    buffer_load_dwordx4 v2, s[36:39], s29 offen offset:1024 sc1 lds
    s_waitcnt lgkmcnt(4)
    v_mfma_f32_16x16x32_bf16 v[132:135], v[240:243], v[40:43], v[132:135]
    v_mfma_f32_16x16x32_bf16 v[132:135], v[244:247], v[44:47], v[132:135]
    ds_read_b128 v[232:235], v3 offset:12288
    buffer_load_dwordx4 v2, s[36:39], s29 offen offset:2048 sc1 lds
    v_mfma_f32_16x16x32_bf16 v[140:143], v[240:243], v[56:59], v[140:143]
    v_mfma_f32_16x16x32_bf16 v[140:143], v[244:247], v[60:63], v[140:143]
    ds_read_b128 v[236:239], v3 offset:13312
    buffer_load_dwordx4 v2, s[36:39], s29 offen offset:3072 sc1 lds
    s_waitcnt lgkmcnt(4)
    v_mfma_f32_16x16x32_bf16 v[144:147], v[216:219], v[32:35], v[16:19]
    v_mfma_f32_16x16x32_bf16 v[144:147], v[220:223], v[36:39], v[144:147]
    ds_read_b128 v[240:243], v3 offset:14336
    v_mfma_f32_16x16x32_bf16 v[152:155], v[216:219], v[48:51], v[20:23]
    v_mfma_f32_16x16x32_bf16 v[152:155], v[220:223], v[52:55], v[152:155]
    ds_read_b128 v[244:247], v3 offset:15360
    s_waitcnt lgkmcnt(4)
    v_mfma_f32_16x16x32_bf16 v[144:147], v[224:227], v[40:43], v[144:147]
    v_mfma_f32_16x16x32_bf16 v[144:147], v[228:231], v[44:47], v[144:147]
    v_mfma_f32_16x16x32_bf16 v[152:155], v[224:227], v[56:59], v[152:155]
    v_mfma_f32_16x16x32_bf16 v[152:155], v[228:231], v[60:63], v[152:155]
    s_waitcnt lgkmcnt(2)
    v_mfma_f32_16x16x32_bf16 v[148:151], v[232:235], v[32:35], v[16:19]
    v_mfma_f32_16x16x32_bf16 v[148:151], v[236:239], v[36:39], v[148:151]
    v_mfma_f32_16x16x32_bf16 v[156:159], v[232:235], v[48:51], v[20:23]
    v_mfma_f32_16x16x32_bf16 v[156:159], v[236:239], v[52:55], v[156:159]
    s_waitcnt lgkmcnt(0)
    v_mfma_f32_16x16x32_bf16 v[148:151], v[240:243], v[40:43], v[148:151]
    v_mfma_f32_16x16x32_bf16 v[148:151], v[244:247], v[44:47], v[148:151]
    v_mfma_f32_16x16x32_bf16 v[156:159], v[240:243], v[56:59], v[156:159]
    v_mfma_f32_16x16x32_bf16 v[156:159], v[244:247], v[60:63], v[156:159]
    s_nop 7
    s_add_u32 s14, s22, 0
    s_sub_u32 s15, s14, s25
    s_cmp_lt_u32 s15, 2
    s_cbranch_scc0 concat_nomask_31
    s_lshl_b32 s15, s15, 2
    s_lshl_b32 s35, s20, 1
    s_sub_i32 s15, s15, s35
    v_mov_b32 v13, 0xff800000
    v_cmp_gt_i32 s[40:41], 0, v0
    v_cmp_gt_i32 s[42:43], 1, v0
    v_cmp_gt_i32 s[44:45], 2, v0
    v_cmp_gt_i32 s[46:47], 3, v0
    s_cmp_lt_i32 s15, 0
    s_cbranch_scc1 concat_mnext_32
    s_cmp_gt_i32 s15, 0
    s_cbranch_scc1 concat_mfull_33
    v_cndmask_b32 v128, v128, v13, s[40:41]
    v_cndmask_b32 v129, v129, v13, s[42:43]
    v_cndmask_b32 v130, v130, v13, s[44:45]
    v_cndmask_b32 v131, v131, v13, s[46:47]
    s_branch concat_mnext_32
concat_mfull_33:
    v_mov_b32 v128, v13
    v_mov_b32 v129, v13
    v_mov_b32 v130, v13
    v_mov_b32 v131, v13
concat_mnext_32:
    s_cmp_lt_i32 s15, 1
    s_cbranch_scc1 concat_mnext_34
    s_cmp_gt_i32 s15, 1
    s_cbranch_scc1 concat_mfull_35
    v_cndmask_b32 v136, v136, v13, s[40:41]
    v_cndmask_b32 v137, v137, v13, s[42:43]
    v_cndmask_b32 v138, v138, v13, s[44:45]
    v_cndmask_b32 v139, v139, v13, s[46:47]
    s_branch concat_mnext_34
concat_mfull_35:
    v_mov_b32 v136, v13
    v_mov_b32 v137, v13
    v_mov_b32 v138, v13
    v_mov_b32 v139, v13
concat_mnext_34:
    s_cmp_lt_i32 s15, -1
    s_cbranch_scc1 concat_mnext_36
    s_cmp_gt_i32 s15, -1
    s_cbranch_scc1 concat_mfull_37
    v_cndmask_b32 v132, v132, v13, s[40:41]
    v_cndmask_b32 v133, v133, v13, s[42:43]
    v_cndmask_b32 v134, v134, v13, s[44:45]
    v_cndmask_b32 v135, v135, v13, s[46:47]
    s_branch concat_mnext_36
concat_mfull_37:
    v_mov_b32 v132, v13
    v_mov_b32 v133, v13
    v_mov_b32 v134, v13
    v_mov_b32 v135, v13
concat_mnext_36:
    s_cmp_lt_i32 s15, 0
    s_cbranch_scc1 concat_mnext_38
    s_cmp_gt_i32 s15, 0
    s_cbranch_scc1 concat_mfull_39
    v_cndmask_b32 v140, v140, v13, s[40:41]
    v_cndmask_b32 v141, v141, v13, s[42:43]
    v_cndmask_b32 v142, v142, v13, s[44:45]
    v_cndmask_b32 v143, v143, v13, s[46:47]
    s_branch concat_mnext_38
concat_mfull_39:
    v_mov_b32 v140, v13
    v_mov_b32 v141, v13
    v_mov_b32 v142, v13
    v_mov_b32 v143, v13
concat_mnext_38:
    s_cmp_lt_i32 s15, -2
    s_cbranch_scc1 concat_mnext_40
    s_cmp_gt_i32 s15, -2
    s_cbranch_scc1 concat_mfull_41
    v_cndmask_b32 v144, v144, v13, s[40:41]
    v_cndmask_b32 v145, v145, v13, s[42:43]
    v_cndmask_b32 v146, v146, v13, s[44:45]
    v_cndmask_b32 v147, v147, v13, s[46:47]
    s_branch concat_mnext_40
concat_mfull_41:
    v_mov_b32 v144, v13
    v_mov_b32 v145, v13
    v_mov_b32 v146, v13
    v_mov_b32 v147, v13
concat_mnext_40:
    s_cmp_lt_i32 s15, -1
    s_cbranch_scc1 concat_mnext_42
    s_cmp_gt_i32 s15, -1
    s_cbranch_scc1 concat_mfull_43
    v_cndmask_b32 v152, v152, v13, s[40:41]
    v_cndmask_b32 v153, v153, v13, s[42:43]
    v_cndmask_b32 v154, v154, v13, s[44:45]
    v_cndmask_b32 v155, v155, v13, s[46:47]
    s_branch concat_mnext_42
concat_mfull_43:
    v_mov_b32 v152, v13
    v_mov_b32 v153, v13
    v_mov_b32 v154, v13
    v_mov_b32 v155, v13
concat_mnext_42:
    s_cmp_lt_i32 s15, -3
    s_cbranch_scc1 concat_mnext_44
    s_cmp_gt_i32 s15, -3
    s_cbranch_scc1 concat_mfull_45
    v_cndmask_b32 v148, v148, v13, s[40:41]
    v_cndmask_b32 v149, v149, v13, s[42:43]
    v_cndmask_b32 v150, v150, v13, s[44:45]
    v_cndmask_b32 v151, v151, v13, s[46:47]
    s_branch concat_mnext_44
concat_mfull_45:
    v_mov_b32 v148, v13
    v_mov_b32 v149, v13
    v_mov_b32 v150, v13
    v_mov_b32 v151, v13
concat_mnext_44:
    s_cmp_lt_i32 s15, -2
    s_cbranch_scc1 concat_mnext_46
    s_cmp_gt_i32 s15, -2
    s_cbranch_scc1 concat_mfull_47
    v_cndmask_b32 v156, v156, v13, s[40:41]
    v_cndmask_b32 v157, v157, v13, s[42:43]
    v_cndmask_b32 v158, v158, v13, s[44:45]
    v_cndmask_b32 v159, v159, v13, s[46:47]
    s_branch concat_mnext_46
concat_mfull_47:
    v_mov_b32 v156, v13
    v_mov_b32 v157, v13
    v_mov_b32 v158, v13
    v_mov_b32 v159, v13
concat_mnext_46:
concat_nomask_31:
    s_cmp_eq_u32 s14, 0
    s_cbranch_scc1 concat_doinit_49
    s_cmp_lg_u32 s14, s23
    s_cbranch_scc1 concat_noinit_48
concat_doinit_49:
    v_max3_f32 v14, v128, v129, v130
    v_max3_f32 v15, v136, v137, v138
    v_max3_f32 v14, v14, v131, v132
    v_max3_f32 v15, v15, v139, v140
    v_max3_f32 v14, v14, v133, v134
    v_max3_f32 v15, v15, v141, v142
    v_max3_f32 v14, v14, v135, v144
    v_max3_f32 v15, v15, v143, v152
    v_max3_f32 v14, v14, v145, v146
    v_max3_f32 v15, v15, v153, v154
    v_max3_f32 v14, v14, v147, v148
    v_max3_f32 v15, v15, v155, v156
    v_max3_f32 v14, v14, v149, v150
    v_max3_f32 v15, v15, v157, v158
    v_max_f32 v14, v14, v151
    v_max_f32 v15, v15, v159
    v_mov_b32 v10, v14
    v_mov_b32 v11, v15
    s_nop 0
    v_permlane16_swap_b32 v14, v10
    v_permlane16_swap_b32 v15, v11
    v_max_f32 v14, v14, v10
    v_max_f32 v15, v15, v11
    v_mov_b32 v10, v14
    v_mov_b32 v11, v15
    s_nop 0
    v_permlane32_swap_b32 v14, v10
    v_permlane32_swap_b32 v15, v11
    v_max_f32 v14, v14, v10
    v_max_f32 v15, v15, v11
    v_sub_f32 v128, v128, v14
    v_sub_f32 v129, v129, v14
    v_sub_f32 v130, v130, v14
    v_sub_f32 v131, v131, v14
    v_sub_f32 v132, v132, v14
    v_sub_f32 v133, v133, v14
    v_sub_f32 v134, v134, v14
    v_sub_f32 v135, v135, v14
    v_sub_f32 v144, v144, v14
    v_sub_f32 v145, v145, v14
    v_sub_f32 v146, v146, v14
    v_sub_f32 v147, v147, v14
    v_sub_f32 v148, v148, v14
    v_sub_f32 v149, v149, v14
    v_sub_f32 v150, v150, v14
    v_sub_f32 v151, v151, v14
    v_sub_f32 v16, 0, v14
    v_sub_f32 v17, 0, v14
    v_sub_f32 v18, 0, v14
    v_sub_f32 v19, 0, v14
    v_sub_f32 v136, v136, v15
    v_sub_f32 v137, v137, v15
    v_sub_f32 v138, v138, v15
    v_sub_f32 v139, v139, v15
    v_sub_f32 v140, v140, v15
    v_sub_f32 v141, v141, v15
    v_sub_f32 v142, v142, v15
    v_sub_f32 v143, v143, v15
    v_sub_f32 v152, v152, v15
    v_sub_f32 v153, v153, v15
    v_sub_f32 v154, v154, v15
    v_sub_f32 v155, v155, v15
    v_sub_f32 v156, v156, v15
    v_sub_f32 v157, v157, v15
    v_sub_f32 v158, v158, v15
    v_sub_f32 v159, v159, v15
    v_sub_f32 v20, 0, v15
    v_sub_f32 v21, 0, v15
    v_sub_f32 v22, 0, v15
    v_sub_f32 v23, 0, v15
concat_noinit_48:
    v_exp_f32 v10, v128
    v_exp_f32 v11, v129
    v_exp_f32 v12, v130
    v_exp_f32 v13, v131
    v_cvt_pk_bf16_f32 v192, v10, v11
    v_exp_f32 v10, v132
    v_exp_f32 v11, v133
    v_cvt_pk_bf16_f32 v193, v12, v13
    v_exp_f32 v12, v134
    v_exp_f32 v13, v135
    v_cvt_pk_bf16_f32 v194, v10, v11
    v_exp_f32 v10, v136
    v_exp_f32 v11, v137
    v_cvt_pk_bf16_f32 v195, v12, v13
    v_exp_f32 v12, v138
    v_exp_f32 v13, v139
    v_cvt_pk_bf16_f32 v196, v10, v11
    v_exp_f32 v10, v140
    v_exp_f32 v11, v141
    v_cvt_pk_bf16_f32 v197, v12, v13
    v_exp_f32 v12, v142
    v_exp_f32 v13, v143
    v_cvt_pk_bf16_f32 v198, v10, v11
    v_cvt_pk_bf16_f32 v199, v12, v13
    s_waitcnt vmcnt(4) lgkmcnt(0)
    s_barrier
    s_barrier
    s_lshl_b32 s14, s2, 3
    s_add_u32 s14, s14, 8192
    s_add_u32 s14, s14, s7
    v_mov_b32 v12, s6
    v_mov_b32 v13, s6
    buffer_store_dwordx2 v[12:13], off, s[8:11], s14 sc1
    v_readlane_b32 s28, v4, 63
    ds_read_b128 v[216:219], v3 offset:16384
    ds_read_b128 v[220:223], v3 offset:17408
    ds_read_b128 v[224:227], v3 offset:18432
    ds_read_b128 v[228:231], v3 offset:19456
concat_gjoin_5:
loop_code:
concat_loop_50:
    s_waitcnt lgkmcnt(2)
    v_mfma_f32_16x16x32_bf16 v[160:163], v[216:219], v[32:35], v[16:19]
    v_exp_f32 v10, v144
    v_mfma_f32_16x16x32_bf16 v[160:163], v[220:223], v[36:39], v[160:163]
    ds_read_b128 v[232:235], v3 offset:20480
    ds_read_b128 v[236:239], v3 offset:21504
    s_add_u32 m0, s27, 0x0
    s_nop 0
    buffer_load_dwordx4 v2, s[36:39], s28 offen offset:0 sc1 lds
    v_exp_f32 v11, v145
    v_mfma_f32_16x16x32_bf16 v[168:171], v[216:219], v[48:51], v[20:23]
    v_exp_f32 v12, v146
    v_mfma_f32_16x16x32_bf16 v[168:171], v[220:223], v[52:55], v[168:171]
    ds_read_b128 v[240:243], v3 offset:22528
    ds_read_b128 v[244:247], v3 offset:23552
    buffer_load_dwordx4 v2, s[36:39], s28 offen offset:1024 sc1 lds
    v_exp_f32 v13, v147
    s_waitcnt lgkmcnt(4)
    v_mfma_f32_16x16x32_bf16 v[160:163], v[224:227], v[40:43], v[160:163]
    v_cvt_pk_bf16_f32 v208, v10, v11
    v_mfma_f32_16x16x32_bf16 v[160:163], v[228:231], v[44:47], v[160:163]
    ds_read_b128 v[216:219], v3 offset:24576
    buffer_load_dwordx4 v2, s[36:39], s28 offen offset:2048 sc1 lds
    v_exp_f32 v10, v148
    v_mfma_f32_16x16x32_bf16 v[248:251], v[28:31], v[192:195], 0
    v_mfma_f32_16x16x32_bf16 v[252:255], v[28:31], v[196:199], 0
    v_mfma_f32_16x16x32_bf16 v[168:171], v[224:227], v[56:59], v[168:171]
    v_exp_f32 v11, v149
    v_mfma_f32_16x16x32_bf16 v[168:171], v[228:231], v[60:63], v[168:171]
    ds_read_b128 v[220:223], v3 offset:25600
    buffer_load_dwordx4 v2, s[36:39], s28 offen offset:3072 sc1 lds
    v_cvt_pk_bf16_f32 v209, v12, v13
    s_waitcnt lgkmcnt(4)
    v_mfma_f32_16x16x32_bf16 v[164:167], v[232:235], v[32:35], v[16:19]
    v_exp_f32 v12, v150
    v_mfma_f32_16x16x32_bf16 v[164:167], v[236:239], v[36:39], v[164:167]
    ds_read_b128 v[224:227], v3 offset:26624
    v_exp_f32 v13, v151
    v_mfma_f32_16x16x32_bf16 v[172:175], v[232:235], v[48:51], v[20:23]
    v_cvt_pk_bf16_f32 v210, v10, v11
    v_mfma_f32_16x16x32_bf16 v[172:175], v[236:239], v[52:55], v[172:175]
    ds_read_b128 v[228:231], v3 offset:27648
    v_exp_f32 v10, v152
    s_waitcnt lgkmcnt(4)
    v_mfma_f32_16x16x32_bf16 v[164:167], v[240:243], v[40:43], v[164:167]
    v_exp_f32 v11, v153
    v_mfma_f32_16x16x32_bf16 v[164:167], v[244:247], v[44:47], v[164:167]
    ds_read_b128 v[232:235], v3 offset:28672
    v_cvt_pk_bf16_f32 v211, v12, v13
    v_mfma_f32_16x16x32_bf16 v[172:175], v[240:243], v[56:59], v[172:175]
    v_exp_f32 v12, v154
    v_mfma_f32_16x16x32_bf16 v[172:175], v[244:247], v[60:63], v[172:175]
    ds_read_b128 v[236:239], v3 offset:29696
    v_exp_f32 v13, v155
    s_setprio 2
    s_waitcnt lgkmcnt(4)
    v_mfma_f32_16x16x32_bf16 v[176:179], v[216:219], v[32:35], v[16:19]
    v_cvt_pk_bf16_f32 v212, v10, v11
    v_mfma_f32_16x16x32_bf16 v[176:179], v[220:223], v[36:39], v[176:179]
    ds_read_b128 v[240:243], v3 offset:30720
    v_exp_f32 v10, v156
    v_mfma_f32_16x16x32_bf16 v[184:187], v[216:219], v[48:51], v[20:23]
    v_exp_f32 v11, v157
    v_mfma_f32_16x16x32_bf16 v[184:187], v[220:223], v[52:55], v[184:187]
    ds_read_b128 v[244:247], v3 offset:31744
    v_cvt_pk_bf16_f32 v213, v12, v13
    s_waitcnt lgkmcnt(4)
    v_mfma_f32_16x16x32_bf16 v[176:179], v[224:227], v[40:43], v[176:179]
    v_exp_f32 v12, v158
    v_mfma_f32_16x16x32_bf16 v[176:179], v[228:231], v[44:47], v[176:179]
    ds_read_b128 v[216:219], v3 offset:32768
    v_exp_f32 v13, v159
    v_mfma_f32_16x16x32_bf16 v[184:187], v[224:227], v[56:59], v[184:187]
    v_cvt_pk_bf16_f32 v214, v10, v11
    v_mfma_f32_16x16x32_bf16 v[184:187], v[228:231], v[60:63], v[184:187]
    ds_read_b128 v[220:223], v3 offset:40960
    v_cvt_pk_bf16_f32 v215, v12, v13
    s_waitcnt lgkmcnt(4)
    v_mfma_f32_16x16x32_bf16 v[180:183], v[232:235], v[32:35], v[16:19]
    v_mfma_f32_16x16x32_bf16 v[180:183], v[236:239], v[36:39], v[180:183]
    ds_read_b128 v[224:227], v3 offset:33792
    v_mfma_f32_16x16x32_bf16 v[248:251], v[28:31], v[208:211], v[248:251]
    v_mfma_f32_16x16x32_bf16 v[252:255], v[28:31], v[212:215], v[252:255]
    v_mfma_f32_16x16x32_bf16 v[188:191], v[232:235], v[48:51], v[20:23]
    v_mfma_f32_16x16x32_bf16 v[188:191], v[236:239], v[52:55], v[188:191]
    ds_read_b128 v[228:231], v3 offset:41984
    s_waitcnt lgkmcnt(4)
    v_mfma_f32_16x16x32_bf16 v[180:183], v[240:243], v[40:43], v[180:183]
    v_mfma_f32_16x16x32_bf16 v[180:183], v[244:247], v[44:47], v[180:183]
    ds_read_b128 v[232:235], v3 offset:34816
    v_mfma_f32_16x16x32_bf16 v[188:191], v[240:243], v[56:59], v[188:191]
    v_mfma_f32_16x16x32_bf16 v[188:191], v[244:247], v[60:63], v[188:191]
    ds_read_b128 v[236:239], v3 offset:43008
    v_add_f32 v10, v248, v252
    v_cmp_nge_f32 vcc, 0x45800000, v10
    s_nop 0
    s_cbranch_vccnz concat_rare_51
concat_rback_52:
    s_bitcmp1_b32 s34, s22
    s_cbranch_scc1 concat_ev_53
concat_evb_54:
    s_nop 2
    v_add_f32 v24, v24, v248
    v_add_f32 v25, v25, v252
    s_setprio 1
    s_waitcnt lgkmcnt(4)
    v_mfma_f32_16x16x32_bf16 v[64:67], v[216:219], v[192:195], v[64:67]
    v_exp_f32 v10, v160
    v_mfma_f32_16x16x32_bf16 v[64:67], v[220:223], v[208:211], v[64:67]
    ds_read_b128 v[240:243], v3 offset:35840
    v_mfma_f32_16x16x32_bf16 v[96:99], v[216:219], v[196:199], v[96:99]
    v_exp_f32 v11, v161
    v_mfma_f32_16x16x32_bf16 v[96:99], v[220:223], v[212:215], v[96:99]
    ds_read_b128 v[244:247], v3 offset:44032
    v_exp_f32 v12, v162
    s_waitcnt lgkmcnt(4)
    v_mfma_f32_16x16x32_bf16 v[68:71], v[224:227], v[192:195], v[68:71]
    v_exp_f32 v13, v163
    v_mfma_f32_16x16x32_bf16 v[68:71], v[228:231], v[208:211], v[68:71]
    ds_read_b128 v[216:219], v3 offset:36864
    v_mfma_f32_16x16x32_bf16 v[100:103], v[224:227], v[196:199], v[100:103]
    v_cvt_pk_bf16_f32 v200, v10, v11
    v_mfma_f32_16x16x32_bf16 v[100:103], v[228:231], v[212:215], v[100:103]
    ds_read_b128 v[220:223], v3 offset:45056
    v_exp_f32 v10, v164
    s_waitcnt lgkmcnt(4)
    v_mfma_f32_16x16x32_bf16 v[72:75], v[232:235], v[192:195], v[72:75]
    v_exp_f32 v11, v165
    v_mfma_f32_16x16x32_bf16 v[72:75], v[236:239], v[208:211], v[72:75]
    ds_read_b128 v[224:227], v3 offset:37888
    v_mfma_f32_16x16x32_bf16 v[104:107], v[232:235], v[196:199], v[104:107]
    v_cvt_pk_bf16_f32 v201, v12, v13
    v_mfma_f32_16x16x32_bf16 v[104:107], v[236:239], v[212:215], v[104:107]
    ds_read_b128 v[228:231], v3 offset:46080
    v_exp_f32 v12, v166
    s_setprio 0
    s_waitcnt lgkmcnt(4)
    v_mfma_f32_16x16x32_bf16 v[76:79], v[240:243], v[192:195], v[76:79]
    v_exp_f32 v13, v167
    v_mfma_f32_16x16x32_bf16 v[76:79], v[244:247], v[208:211], v[76:79]
    ds_read_b128 v[232:235], v3 offset:38912
    v_mfma_f32_16x16x32_bf16 v[108:111], v[240:243], v[196:199], v[108:111]
    v_cvt_pk_bf16_f32 v202, v10, v11
    v_mfma_f32_16x16x32_bf16 v[108:111], v[244:247], v[212:215], v[108:111]
    ds_read_b128 v[236:239], v3 offset:47104
    v_exp_f32 v10, v168
    s_waitcnt lgkmcnt(4)
    v_mfma_f32_16x16x32_bf16 v[80:83], v[216:219], v[192:195], v[80:83]
    v_exp_f32 v11, v169
    v_mfma_f32_16x16x32_bf16 v[80:83], v[220:223], v[208:211], v[80:83]
    ds_read_b128 v[240:243], v3 offset:39936
    v_mfma_f32_16x16x32_bf16 v[112:115], v[216:219], v[196:199], v[112:115]
    v_cvt_pk_bf16_f32 v203, v12, v13
    v_mfma_f32_16x16x32_bf16 v[112:115], v[220:223], v[212:215], v[112:115]
    ds_read_b128 v[244:247], v3 offset:48128
    s_add_u32 s29, s28, 0x4000
    v_readlane_b32 s28, v4, s22
    v_exp_f32 v12, v170
    s_waitcnt lgkmcnt(4)
    v_mfma_f32_16x16x32_bf16 v[84:87], v[224:227], v[192:195], v[84:87]
    v_exp_f32 v13, v171
    v_mfma_f32_16x16x32_bf16 v[84:87], v[228:231], v[208:211], v[84:87]
    v_mfma_f32_16x16x32_bf16 v[116:119], v[224:227], v[196:199], v[116:119]
    v_cvt_pk_bf16_f32 v204, v10, v11
    v_mfma_f32_16x16x32_bf16 v[116:119], v[228:231], v[212:215], v[116:119]
    s_waitcnt vmcnt(0) lgkmcnt(0)
    s_barrier
    s_setprio 3
    ds_read_b128 v[216:219], v3 offset:0
    v_exp_f32 v10, v172
    v_mfma_f32_16x16x32_bf16 v[88:91], v[232:235], v[192:195], v[88:91]
    v_exp_f32 v11, v173
    v_mfma_f32_16x16x32_bf16 v[88:91], v[236:239], v[208:211], v[88:91]
    ds_read_b128 v[220:223], v3 offset:1024
    s_add_u32 m0, s27, 0x8000
    s_nop 0
    buffer_load_dwordx4 v2, s[36:39], s29 offen offset:0 sc1 lds
    v_mfma_f32_16x16x32_bf16 v[120:123], v[232:235], v[196:199], v[120:123]
    v_cvt_pk_bf16_f32 v205, v12, v13
    v_mfma_f32_16x16x32_bf16 v[120:123], v[236:239], v[212:215], v[120:123]
    ds_read_b128 v[224:227], v3 offset:2048
    buffer_load_dwordx4 v2, s[36:39], s29 offen offset:1024 sc1 lds
    v_exp_f32 v12, v174
    v_mfma_f32_16x16x32_bf16 v[92:95], v[240:243], v[192:195], v[92:95]
    v_exp_f32 v13, v175
    v_mfma_f32_16x16x32_bf16 v[92:95], v[244:247], v[208:211], v[92:95]
    ds_read_b128 v[228:231], v3 offset:3072
    buffer_load_dwordx4 v2, s[36:39], s29 offen offset:2048 sc1 lds
    v_mfma_f32_16x16x32_bf16 v[124:127], v[240:243], v[196:199], v[124:127]
    v_cvt_pk_bf16_f32 v206, v10, v11
    v_mfma_f32_16x16x32_bf16 v[124:127], v[244:247], v[212:215], v[124:127]
    buffer_load_dwordx4 v2, s[36:39], s29 offen offset:3072 sc1 lds
    v_cvt_pk_bf16_f32 v207, v12, v13
    s_add_u32 s22, s22, 1
    s_waitcnt lgkmcnt(2)
    v_mfma_f32_16x16x32_bf16 v[128:131], v[216:219], v[32:35], v[16:19]
    v_exp_f32 v10, v176
    v_mfma_f32_16x16x32_bf16 v[128:131], v[220:223], v[36:39], v[128:131]
    ds_read_b128 v[232:235], v3 offset:4096
    ds_read_b128 v[236:239], v3 offset:5120
    s_add_u32 m0, s27, 0x4000
    s_nop 0
    buffer_load_dwordx4 v2, s[36:39], s28 offen offset:0 sc1 lds
    v_exp_f32 v11, v177
    v_mfma_f32_16x16x32_bf16 v[136:139], v[216:219], v[48:51], v[20:23]
    v_exp_f32 v12, v178
    v_mfma_f32_16x16x32_bf16 v[136:139], v[220:223], v[52:55], v[136:139]
    ds_read_b128 v[240:243], v3 offset:6144
    ds_read_b128 v[244:247], v3 offset:7168
    buffer_load_dwordx4 v2, s[36:39], s28 offen offset:1024 sc1 lds
    v_exp_f32 v13, v179
    s_waitcnt lgkmcnt(4)
    v_mfma_f32_16x16x32_bf16 v[128:131], v[224:227], v[40:43], v[128:131]
    v_cvt_pk_bf16_f32 v208, v10, v11
    v_mfma_f32_16x16x32_bf16 v[128:131], v[228:231], v[44:47], v[128:131]
    ds_read_b128 v[216:219], v3 offset:8192
    buffer_load_dwordx4 v2, s[36:39], s28 offen offset:2048 sc1 lds
    v_exp_f32 v10, v180
    v_mfma_f32_16x16x32_bf16 v[248:251], v[28:31], v[200:203], 0
    v_mfma_f32_16x16x32_bf16 v[252:255], v[28:31], v[204:207], 0
    v_mfma_f32_16x16x32_bf16 v[136:139], v[224:227], v[56:59], v[136:139]
    v_exp_f32 v11, v181
    v_mfma_f32_16x16x32_bf16 v[136:139], v[228:231], v[60:63], v[136:139]
    ds_read_b128 v[220:223], v3 offset:9216
    buffer_load_dwordx4 v2, s[36:39], s28 offen offset:3072 sc1 lds
    v_cvt_pk_bf16_f32 v209, v12, v13
    s_waitcnt lgkmcnt(4)
    v_mfma_f32_16x16x32_bf16 v[132:135], v[232:235], v[32:35], v[16:19]
    v_exp_f32 v12, v182
    v_mfma_f32_16x16x32_bf16 v[132:135], v[236:239], v[36:39], v[132:135]
    ds_read_b128 v[224:227], v3 offset:10240
    v_exp_f32 v13, v183
    v_mfma_f32_16x16x32_bf16 v[140:143], v[232:235], v[48:51], v[20:23]
    v_cvt_pk_bf16_f32 v210, v10, v11
    v_mfma_f32_16x16x32_bf16 v[140:143], v[236:239], v[52:55], v[140:143]
    ds_read_b128 v[228:231], v3 offset:11264
    v_exp_f32 v10, v184
    s_waitcnt lgkmcnt(4)
    v_mfma_f32_16x16x32_bf16 v[132:135], v[240:243], v[40:43], v[132:135]
    v_exp_f32 v11, v185
    v_mfma_f32_16x16x32_bf16 v[132:135], v[244:247], v[44:47], v[132:135]
    ds_read_b128 v[232:235], v3 offset:12288
    v_cvt_pk_bf16_f32 v211, v12, v13
    v_mfma_f32_16x16x32_bf16 v[140:143], v[240:243], v[56:59], v[140:143]
    v_exp_f32 v12, v186
    v_mfma_f32_16x16x32_bf16 v[140:143], v[244:247], v[60:63], v[140:143]
    ds_read_b128 v[236:239], v3 offset:13312
    v_exp_f32 v13, v187
    s_setprio 2
    s_waitcnt lgkmcnt(4)
    v_mfma_f32_16x16x32_bf16 v[144:147], v[216:219], v[32:35], v[16:19]
    v_cvt_pk_bf16_f32 v212, v10, v11
    v_mfma_f32_16x16x32_bf16 v[144:147], v[220:223], v[36:39], v[144:147]
    ds_read_b128 v[240:243], v3 offset:14336
    v_exp_f32 v10, v188
    v_mfma_f32_16x16x32_bf16 v[152:155], v[216:219], v[48:51], v[20:23]
    v_exp_f32 v11, v189
    v_mfma_f32_16x16x32_bf16 v[152:155], v[220:223], v[52:55], v[152:155]
    ds_read_b128 v[244:247], v3 offset:15360
    v_cvt_pk_bf16_f32 v213, v12, v13
    s_waitcnt lgkmcnt(4)
    v_mfma_f32_16x16x32_bf16 v[144:147], v[224:227], v[40:43], v[144:147]
    v_exp_f32 v12, v190
    v_mfma_f32_16x16x32_bf16 v[144:147], v[228:231], v[44:47], v[144:147]
    ds_read_b128 v[216:219], v3 offset:49152
    v_exp_f32 v13, v191
    v_mfma_f32_16x16x32_bf16 v[152:155], v[224:227], v[56:59], v[152:155]
    v_cvt_pk_bf16_f32 v214, v10, v11
    v_mfma_f32_16x16x32_bf16 v[152:155], v[228:231], v[60:63], v[152:155]
    ds_read_b128 v[220:223], v3 offset:57344
    v_cvt_pk_bf16_f32 v215, v12, v13
    s_waitcnt lgkmcnt(4)
    v_mfma_f32_16x16x32_bf16 v[148:151], v[232:235], v[32:35], v[16:19]
    v_mfma_f32_16x16x32_bf16 v[148:151], v[236:239], v[36:39], v[148:151]
    ds_read_b128 v[224:227], v3 offset:50176
    v_mfma_f32_16x16x32_bf16 v[248:251], v[28:31], v[208:211], v[248:251]
    v_mfma_f32_16x16x32_bf16 v[252:255], v[28:31], v[212:215], v[252:255]
    v_mfma_f32_16x16x32_bf16 v[156:159], v[232:235], v[48:51], v[20:23]
    v_mfma_f32_16x16x32_bf16 v[156:159], v[236:239], v[52:55], v[156:159]
    ds_read_b128 v[228:231], v3 offset:58368
    s_waitcnt lgkmcnt(4)
    v_mfma_f32_16x16x32_bf16 v[148:151], v[240:243], v[40:43], v[148:151]
    v_mfma_f32_16x16x32_bf16 v[148:151], v[244:247], v[44:47], v[148:151]
    ds_read_b128 v[232:235], v3 offset:51200
    v_mfma_f32_16x16x32_bf16 v[156:159], v[240:243], v[56:59], v[156:159]
    v_mfma_f32_16x16x32_bf16 v[156:159], v[244:247], v[60:63], v[156:159]
    ds_read_b128 v[236:239], v3 offset:59392
    v_add_f32 v10, v248, v252
    v_cmp_nge_f32 vcc, 0x45800000, v10
    s_nop 0
    s_cbranch_vccnz concat_rare_55
concat_rback_56:
    s_bitcmp1_b32 s34, s22
    s_cbranch_scc1 concat_ev_57
concat_evb_58:
    s_nop 2
    v_add_f32 v24, v24, v248
    v_add_f32 v25, v25, v252
    s_setprio 1
    s_waitcnt lgkmcnt(4)
    v_mfma_f32_16x16x32_bf16 v[64:67], v[216:219], v[200:203], v[64:67]
    v_exp_f32 v10, v128
    v_mfma_f32_16x16x32_bf16 v[64:67], v[220:223], v[208:211], v[64:67]
    ds_read_b128 v[240:243], v3 offset:52224
    v_mfma_f32_16x16x32_bf16 v[96:99], v[216:219], v[204:207], v[96:99]
    v_exp_f32 v11, v129
    v_mfma_f32_16x16x32_bf16 v[96:99], v[220:223], v[212:215], v[96:99]
    ds_read_b128 v[244:247], v3 offset:60416
    v_exp_f32 v12, v130
    s_waitcnt lgkmcnt(4)
    v_mfma_f32_16x16x32_bf16 v[68:71], v[224:227], v[200:203], v[68:71]
    v_exp_f32 v13, v131
    v_mfma_f32_16x16x32_bf16 v[68:71], v[228:231], v[208:211], v[68:71]
    ds_read_b128 v[216:219], v3 offset:53248
    v_mfma_f32_16x16x32_bf16 v[100:103], v[224:227], v[204:207], v[100:103]
    v_cvt_pk_bf16_f32 v192, v10, v11
    v_mfma_f32_16x16x32_bf16 v[100:103], v[228:231], v[212:215], v[100:103]
    ds_read_b128 v[220:223], v3 offset:61440
    v_exp_f32 v10, v132
    s_waitcnt lgkmcnt(4)
    v_mfma_f32_16x16x32_bf16 v[72:75], v[232:235], v[200:203], v[72:75]
    v_exp_f32 v11, v133
    v_mfma_f32_16x16x32_bf16 v[72:75], v[236:239], v[208:211], v[72:75]
    ds_read_b128 v[224:227], v3 offset:54272
    v_mfma_f32_16x16x32_bf16 v[104:107], v[232:235], v[204:207], v[104:107]
    v_cvt_pk_bf16_f32 v193, v12, v13
    v_mfma_f32_16x16x32_bf16 v[104:107], v[236:239], v[212:215], v[104:107]
    ds_read_b128 v[228:231], v3 offset:62464
    v_exp_f32 v12, v134
    s_setprio 0
    s_waitcnt lgkmcnt(4)
    v_mfma_f32_16x16x32_bf16 v[76:79], v[240:243], v[200:203], v[76:79]
    v_exp_f32 v13, v135
    v_mfma_f32_16x16x32_bf16 v[76:79], v[244:247], v[208:211], v[76:79]
    ds_read_b128 v[232:235], v3 offset:55296
    v_mfma_f32_16x16x32_bf16 v[108:111], v[240:243], v[204:207], v[108:111]
    v_cvt_pk_bf16_f32 v194, v10, v11
    v_mfma_f32_16x16x32_bf16 v[108:111], v[244:247], v[212:215], v[108:111]
    ds_read_b128 v[236:239], v3 offset:63488
    v_exp_f32 v10, v136
    s_waitcnt lgkmcnt(4)
    v_mfma_f32_16x16x32_bf16 v[80:83], v[216:219], v[200:203], v[80:83]
    v_exp_f32 v11, v137
    v_mfma_f32_16x16x32_bf16 v[80:83], v[220:223], v[208:211], v[80:83]
    ds_read_b128 v[240:243], v3 offset:56320
    v_mfma_f32_16x16x32_bf16 v[112:115], v[216:219], v[204:207], v[112:115]
    v_cvt_pk_bf16_f32 v195, v12, v13
    v_mfma_f32_16x16x32_bf16 v[112:115], v[220:223], v[212:215], v[112:115]
    ds_read_b128 v[244:247], v3 offset:64512
    s_add_u32 s29, s28, 0x4000
    v_readlane_b32 s28, v4, s22
    v_exp_f32 v12, v138
    s_waitcnt lgkmcnt(4)
    v_mfma_f32_16x16x32_bf16 v[84:87], v[224:227], v[200:203], v[84:87]
    v_exp_f32 v13, v139
    v_mfma_f32_16x16x32_bf16 v[84:87], v[228:231], v[208:211], v[84:87]
    v_mfma_f32_16x16x32_bf16 v[116:119], v[224:227], v[204:207], v[116:119]
    v_cvt_pk_bf16_f32 v196, v10, v11
    v_mfma_f32_16x16x32_bf16 v[116:119], v[228:231], v[212:215], v[116:119]
    s_waitcnt vmcnt(0) lgkmcnt(0)
    s_barrier
    s_setprio 3
    ds_read_b128 v[216:219], v3 offset:16384
    v_exp_f32 v10, v140
    v_mfma_f32_16x16x32_bf16 v[88:91], v[232:235], v[200:203], v[88:91]
    v_exp_f32 v11, v141
    v_mfma_f32_16x16x32_bf16 v[88:91], v[236:239], v[208:211], v[88:91]
    ds_read_b128 v[220:223], v3 offset:17408
    s_add_u32 m0, s27, 0xc000
    s_nop 0
    buffer_load_dwordx4 v2, s[36:39], s29 offen offset:0 sc1 lds
    v_mfma_f32_16x16x32_bf16 v[120:123], v[232:235], v[204:207], v[120:123]
    v_cvt_pk_bf16_f32 v197, v12, v13
    v_mfma_f32_16x16x32_bf16 v[120:123], v[236:239], v[212:215], v[120:123]
    ds_read_b128 v[224:227], v3 offset:18432
    buffer_load_dwordx4 v2, s[36:39], s29 offen offset:1024 sc1 lds
    v_exp_f32 v12, v142
    v_mfma_f32_16x16x32_bf16 v[92:95], v[240:243], v[200:203], v[92:95]
    v_exp_f32 v13, v143
    v_mfma_f32_16x16x32_bf16 v[92:95], v[244:247], v[208:211], v[92:95]
    ds_read_b128 v[228:231], v3 offset:19456
    buffer_load_dwordx4 v2, s[36:39], s29 offen offset:2048 sc1 lds
    v_mfma_f32_16x16x32_bf16 v[124:127], v[240:243], v[204:207], v[124:127]
    v_cvt_pk_bf16_f32 v198, v10, v11
    v_mfma_f32_16x16x32_bf16 v[124:127], v[244:247], v[212:215], v[124:127]
    buffer_load_dwordx4 v2, s[36:39], s29 offen offset:3072 sc1 lds
    v_cvt_pk_bf16_f32 v199, v12, v13
    s_add_u32 s22, s22, 1
    s_cmp_lt_u32 s22, 16
    s_cbranch_scc1 concat_loop_50
tail_code:
    s_setprio 0
    s_waitcnt lgkmcnt(0)
    ds_read_b128 v[216:219], v3 offset:32768
    ds_read_b128 v[220:223], v3 offset:40960
    ds_read_b128 v[224:227], v3 offset:33792
    ds_read_b128 v[228:231], v3 offset:41984
    ds_read_b128 v[232:235], v3 offset:34816
    ds_read_b128 v[236:239], v3 offset:43008
    s_add_u32 s73, s72, 0
    buffer_load_dwordx4 v[160:163], v2, s[36:39], s73 offen offset:0 sc1
    buffer_load_dwordx4 v[164:167], v2, s[36:39], s73 offen offset:1024 sc1
    buffer_load_dwordx4 v[168:171], v2, s[36:39], s73 offen offset:2048 sc1
    buffer_load_dwordx4 v[172:175], v2, s[36:39], s73 offen offset:3072 sc1
    s_add_u32 s73, s72, 4096
    buffer_load_dwordx4 v[176:179], v2, s[36:39], s73 offen offset:0 sc1
    buffer_load_dwordx4 v[180:183], v2, s[36:39], s73 offen offset:1024 sc1
    buffer_load_dwordx4 v[184:187], v2, s[36:39], s73 offen offset:2048 sc1
    buffer_load_dwordx4 v[188:191], v2, s[36:39], s73 offen offset:3072 sc1
    v_mfma_f32_16x16x32_bf16 v[248:251], v[28:31], v[192:195], 0
    v_mfma_f32_16x16x32_bf16 v[252:255], v[28:31], v[196:199], 0
    v_exp_f32 v10, v144
    v_exp_f32 v11, v145
    v_exp_f32 v12, v146
    v_exp_f32 v13, v147
    v_cvt_pk_bf16_f32 v208, v10, v11
    v_exp_f32 v10, v148
    v_exp_f32 v11, v149
    v_cvt_pk_bf16_f32 v209, v12, v13
    v_exp_f32 v12, v150
    v_exp_f32 v13, v151
    v_cvt_pk_bf16_f32 v210, v10, v11
    v_exp_f32 v10, v152
    v_exp_f32 v11, v153
    v_cvt_pk_bf16_f32 v211, v12, v13
    v_exp_f32 v12, v154
    v_exp_f32 v13, v155
    v_cvt_pk_bf16_f32 v212, v10, v11
    v_exp_f32 v10, v156
    v_exp_f32 v11, v157
    v_cvt_pk_bf16_f32 v213, v12, v13
    v_exp_f32 v12, v158
    v_exp_f32 v13, v159
    v_cvt_pk_bf16_f32 v214, v10, v11
    v_cvt_pk_bf16_f32 v215, v12, v13
    v_mfma_f32_16x16x32_bf16 v[248:251], v[28:31], v[208:211], v[248:251]
    s_nop 0
    v_mfma_f32_16x16x32_bf16 v[252:255], v[28:31], v[212:215], v[252:255]
    s_nop 7
    v_add_f32 v10, v248, v252
    v_cmp_nge_f32 vcc, 0x45800000, v10
    s_nop 0
    s_cbranch_vccnz concat_rare_59
concat_rback_60:
    s_bitcmp1_b32 s34, s22
    s_cbranch_scc1 concat_ev_61
concat_evb_62:
    s_nop 2
    v_add_f32 v24, v24, v248
    v_add_f32 v25, v25, v252
    s_waitcnt lgkmcnt(4)
    v_mfma_f32_16x16x32_bf16 v[64:67], v[216:219], v[192:195], v[64:67]
    v_mfma_f32_16x16x32_bf16 v[64:67], v[220:223], v[208:211], v[64:67]
    ds_read_b128 v[240:243], v3 offset:35840
    s_lshl_b32 s61, s3, 13
    s_mov_b32 s63, 0x8000
    s_cmp_ge_u32 s3, 2
    s_cselect_b32 s63, 0x14000, s63
    s_cmp_ge_u32 s3, 4
    s_cselect_b32 s63, 0x18000, s63
    v_mfma_f32_16x16x32_bf16 v[96:99], v[216:219], v[196:199], v[96:99]
    v_mfma_f32_16x16x32_bf16 v[96:99], v[220:223], v[212:215], v[96:99]
    ds_read_b128 v[244:247], v3 offset:44032
    s_add_u32 s61, s61, s63
    s_xor_b32 s14, s3, 4
    s_lshl_b32 s15, s14, 13
    s_mov_b32 s63, 0x8000
    s_cmp_ge_u32 s14, 2
    s_cselect_b32 s63, 0x14000, s63
    s_waitcnt lgkmcnt(4)
    v_mfma_f32_16x16x32_bf16 v[68:71], v[224:227], v[192:195], v[68:71]
    v_mfma_f32_16x16x32_bf16 v[68:71], v[228:231], v[208:211], v[68:71]
    ds_read_b128 v[216:219], v3 offset:36864
    s_cmp_ge_u32 s14, 4
    s_cselect_b32 s63, 0x18000, s63
    s_add_u32 s15, s15, s63
    v_add_u32 v43, s61, v2
    v_add_u32 v44, s15, v2
    v_add_u32 v32, s27, v2
    v_mfma_f32_16x16x32_bf16 v[100:103], v[224:227], v[196:199], v[100:103]
    v_mfma_f32_16x16x32_bf16 v[100:103], v[228:231], v[212:215], v[100:103]
    ds_read_b128 v[220:223], v3 offset:45056
    v_xor_b32 v45, 0x10000, v32
    v_lshrrev_b32 v48, 3, v1
    v_and_b32 v50, 7, v1
    v_bfe_u32 v49, v1, 4, 1
    v_lshlrev_b32 v49, 1, v49
    v_xor_b32 v49, v49, v50
    s_waitcnt lgkmcnt(4)
    v_mfma_f32_16x16x32_bf16 v[72:75], v[232:235], v[192:195], v[72:75]
    v_mfma_f32_16x16x32_bf16 v[72:75], v[236:239], v[208:211], v[72:75]
    ds_read_b128 v[224:227], v3 offset:37888
    v_lshlrev_b32 v49, 4, v49
    v_lshl_add_u32 v34, v48, 12, v49
    v_xor_b32 v35, 64, v34
    v_bfe_u32 v48, v1, 2, 2
    v_bfe_u32 v50, v1, 4, 1
    v_and_b32 v51, 3, v1
    v_mfma_f32_16x16x32_bf16 v[104:107], v[232:235], v[196:199], v[104:107]
    v_mfma_f32_16x16x32_bf16 v[104:107], v[236:239], v[212:215], v[104:107]
    ds_read_b128 v[228:231], v3 offset:46080
    s_add_u32 s44, s12, 0x4200000
    s_addc_u32 s45, s13, 0
    s_mov_b32 s46, 0x200000
    s_mov_b32 s47, 0x20000
    s_lshl_b32 s60, s3, 18
    s_lshl_b32 s14, s4, 7
    s_waitcnt lgkmcnt(4)
    v_mfma_f32_16x16x32_bf16 v[76:79], v[240:243], v[192:195], v[76:79]
    v_mfma_f32_16x16x32_bf16 v[76:79], v[244:247], v[208:211], v[76:79]
    ds_read_b128 v[232:235], v3 offset:38912
    s_add_u32 s60, s60, s14
    s_lshl_b32 s56, s4, 6
    s_lshl_b32 s14, s3, 2
    s_add_u32 s56, s56, s14
    s_lshl_b32 s56, s56, 13
    s_add_u32 s57, s56, 0x1000
    v_mfma_f32_16x16x32_bf16 v[108:111], v[240:243], v[196:199], v[108:111]
    v_mfma_f32_16x16x32_bf16 v[108:111], v[244:247], v[212:215], v[108:111]
    ds_read_b128 v[236:239], v3 offset:47104
    s_add_u32 s58, s56, 0x40000
    s_add_u32 s59, s56, 0x41000
    v_lshrrev_b32 v52, 4, v1
    v_lshl_add_u32 v49, v52, 3, v48
    v_lshlrev_b32 v49, 7, v49
    v_lshl_add_u32 v49, v51, 3, v49
    v_lshrrev_b32 v53, 1, v48
    s_waitcnt lgkmcnt(4)
    v_mfma_f32_16x16x32_bf16 v[80:83], v[216:219], v[192:195], v[80:83]
    v_mfma_f32_16x16x32_bf16 v[80:83], v[220:223], v[208:211], v[80:83]
    ds_read_b128 v[240:243], v3 offset:39936
    v_lshl_add_u32 v53, v50, 1, v53
    s_lshr_b32 s14, s3, 2
    s_lshl_b32 s14, s14, 1
    v_xor_b32 v53, s14, v53
    v_lshl_add_u32 v36, v53, 5, v49
    v_xor_b32 v37, 32, v36
    v_mfma_f32_16x16x32_bf16 v[112:115], v[216:219], v[196:199], v[112:115]
    v_mfma_f32_16x16x32_bf16 v[112:115], v[220:223], v[212:215], v[112:115]
    ds_read_b128 v[244:247], v3 offset:48128
    s_lshl_b32 s14, s5, 6
    s_and_b32 s15, s3, 3
    s_lshl_b32 s15, s15, 4
    s_add_u32 s14, s14, s15
    v_and_b32 v48, 15, v1
    v_add_u32 v48, s14, v48
    s_waitcnt lgkmcnt(4)
    v_mfma_f32_16x16x32_bf16 v[84:87], v[224:227], v[192:195], v[84:87]
    v_mfma_f32_16x16x32_bf16 v[84:87], v[228:231], v[208:211], v[84:87]
    v_cvt_f32_u32 v38, v48
    v_mul_f32 v38, 0x3b000000, v38
    v_lshlrev_b32 v49, 2, v52
    v_cvt_f32_u32 v49, v49
    v_mul_f32 v39, v38, v49
    v_lshlrev_b32 v41, 31, v48
    v_mfma_f32_16x16x32_bf16 v[116:119], v[224:227], v[196:199], v[116:119]
    v_mfma_f32_16x16x32_bf16 v[116:119], v[228:231], v[212:215], v[116:119]
    v_or_b32 v41, 1.0, v41
    s_lshl_b32 s62, s5, 7
    s_add_u32 s62, s62, 1024
    s_and_b32 s14, s4, 1
    s_lshl_b32 s14, s14, 9
    s_lshr_b32 s15, s4, 3
    s_waitcnt lgkmcnt(2)
    v_mfma_f32_16x16x32_bf16 v[88:91], v[232:235], v[192:195], v[88:91]
    v_mfma_f32_16x16x32_bf16 v[88:91], v[236:239], v[208:211], v[88:91]
    s_lshl_b32 s15, s15, 4
    s_add_u32 s14, s14, s15
    s_and_b32 s15, s4, 6
    s_lshl_b32 s15, s15, 1
    s_add_u32 s14, s14, s15
    s_lshl_b32 s14, s14, 11
    v_mfma_f32_16x16x32_bf16 v[120:123], v[232:235], v[196:199], v[120:123]
    v_mfma_f32_16x16x32_bf16 v[120:123], v[236:239], v[212:215], v[120:123]
    s_add_u32 s62, s62, s14
    s_lshr_b32 s14, s3, 2
    s_lshl_b32 s14, s14, 12
    s_and_b32 s15, s3, 3
    s_lshl_b32 s15, s15, 5
    s_add_u32 s14, s14, s15
    s_waitcnt lgkmcnt(0)
    v_mfma_f32_16x16x32_bf16 v[92:95], v[240:243], v[192:195], v[92:95]
    v_mfma_f32_16x16x32_bf16 v[92:95], v[244:247], v[208:211], v[92:95]
    s_add_u32 s14, s14, 0x20000
    v_and_b32 v49, 15, v1
    v_lshlrev_b32 v49, 7, v49
    v_lshl_add_u32 v49, v52, 3, v49
    v_add_u32 v40, s14, v49
    v_and_b32 v42, 3, v1
    v_mfma_f32_16x16x32_bf16 v[124:127], v[240:243], v[196:199], v[124:127]
    v_mfma_f32_16x16x32_bf16 v[124:127], v[244:247], v[212:215], v[124:127]
    v_lshlrev_b32 v42, 3, v42
    s_lshr_b32 s15, s4, 1
    s_lshl_b32 s15, s15, 8
    s_lshl_b32 s14, s3, 5
    s_add_u32 s15, s15, s14
    s_add_u32 s64, s15, 16384
    v_add_u32 v33, s61, v2
    s_cmp_eq_u32 s21, 0
    s_cselect_b64 vcc, -1, 0
    v_cndmask_b32 v6, v20, v16, vcc
    v_cndmask_b32 v7, v25, v24, vcc
    v_cndmask_b32 v28, v16, v20, vcc
    v_cndmask_b32 v29, v24, v25, vcc
    s_waitcnt lgkmcnt(0)
    s_barrier
    ds_write_b64 v32, v[28:29]
    s_cmp_eq_u32 s21, 0
    s_cbranch_scc0 concat_combB_63
    ds_write_b128 v43, v[96:99] offset:0
    ds_write_b128 v43, v[100:103] offset:1024
    ds_write_b128 v43, v[104:107] offset:2048
    ds_write_b128 v43, v[108:111] offset:3072
    ds_write_b128 v43, v[112:115] offset:4096
    ds_write_b128 v43, v[116:119] offset:5120
    ds_write_b128 v43, v[120:123] offset:6144
    ds_write_b128 v43, v[124:127] offset:7168
    s_branch concat_combJ_64
concat_combB_63:
    ds_write_b128 v43, v[64:67] offset:0
    ds_write_b128 v43, v[68:71] offset:1024
    ds_write_b128 v43, v[72:75] offset:2048
    ds_write_b128 v43, v[76:79] offset:3072
    ds_write_b128 v43, v[80:83] offset:4096
    ds_write_b128 v43, v[84:87] offset:5120
    ds_write_b128 v43, v[88:91] offset:6144
    ds_write_b128 v43, v[92:95] offset:7168
    v_mov_b32 v64, v96
    v_mov_b32 v65, v97
    v_mov_b32 v66, v98
    v_mov_b32 v67, v99
    v_mov_b32 v68, v100
    v_mov_b32 v69, v101
    v_mov_b32 v70, v102
    v_mov_b32 v71, v103
    v_mov_b32 v72, v104
    v_mov_b32 v73, v105
    v_mov_b32 v74, v106
    v_mov_b32 v75, v107
    v_mov_b32 v76, v108
    v_mov_b32 v77, v109
    v_mov_b32 v78, v110
    v_mov_b32 v79, v111
    v_mov_b32 v80, v112
    v_mov_b32 v81, v113
    v_mov_b32 v82, v114
    v_mov_b32 v83, v115
    v_mov_b32 v84, v116
    v_mov_b32 v85, v117
    v_mov_b32 v86, v118
    v_mov_b32 v87, v119
    v_mov_b32 v88, v120
    v_mov_b32 v89, v121
    v_mov_b32 v90, v122
    v_mov_b32 v91, v123
    v_mov_b32 v92, v124
    v_mov_b32 v93, v125
    v_mov_b32 v94, v126
    v_mov_b32 v95, v127
    s_add_u32 s31, s31, 4096
concat_combJ_64:
    s_add_u32 s73, s72, 8192
    buffer_load_dwordx4 v[240:243], v2, s[36:39], s73 offen offset:0 sc1
    buffer_load_dwordx4 v[244:247], v2, s[36:39], s73 offen offset:1024 sc1
    buffer_load_dwordx4 v[248:251], v2, s[36:39], s73 offen offset:2048 sc1
    buffer_load_dwordx4 v[252:255], v2, s[36:39], s73 offen offset:3072 sc1
    s_add_u32 s73, s72, 12288
    buffer_load_dwordx4 v[224:227], v2, s[36:39], s73 offen offset:0 sc1
    buffer_load_dwordx4 v[228:231], v2, s[36:39], s73 offen offset:1024 sc1
    buffer_load_dwordx4 v[232:235], v2, s[36:39], s73 offen offset:2048 sc1
    buffer_load_dwordx4 v[236:239], v2, s[36:39], s73 offen offset:3072 sc1
    s_add_u32 s73, s72, 16384
    buffer_load_dwordx4 v[208:211], v2, s[36:39], s73 offen offset:0 sc1
    buffer_load_dwordx4 v[212:215], v2, s[36:39], s73 offen offset:1024 sc1
    buffer_load_dwordx4 v[216:219], v2, s[36:39], s73 offen offset:2048 sc1
    buffer_load_dwordx4 v[220:223], v2, s[36:39], s73 offen offset:3072 sc1
    s_waitcnt lgkmcnt(0)
    s_barrier
    ds_read_b64 v[30:31], v45
    ds_read_b128 v[128:131], v44 offset:0
    ds_read_b128 v[132:135], v44 offset:1024
    ds_read_b128 v[136:139], v44 offset:2048
    ds_read_b128 v[140:143], v44 offset:3072
    ds_read_b128 v[144:147], v44 offset:4096
    ds_read_b128 v[148:151], v44 offset:5120
    ds_read_b128 v[152:155], v44 offset:6144
    ds_read_b128 v[156:159], v44 offset:7168
    s_waitcnt lgkmcnt(8)
    v_min_f32 v14, v6, v30
    v_sub_f32 v15, v14, v6
    v_sub_f32 v9, v14, v30
    v_exp_f32 v15, v15
    v_exp_f32 v9, v9
    v_mul_f32 v14, v7, v15
    v_fmac_f32 v14, v31, v9
    v_rcp_f32 v14, v14
    s_nop 0
    v_mul_f32 v15, v15, v14
    v_mul_f32 v9, v9, v14
    v_mul_f32 v64, v64, v15
    v_mul_f32 v65, v65, v15
    v_mul_f32 v66, v66, v15
    v_mul_f32 v67, v67, v15
    v_mul_f32 v68, v68, v15
    v_mul_f32 v69, v69, v15
    v_mul_f32 v70, v70, v15
    v_mul_f32 v71, v71, v15
    v_mul_f32 v72, v72, v15
    v_mul_f32 v73, v73, v15
    v_mul_f32 v74, v74, v15
    v_mul_f32 v75, v75, v15
    v_mul_f32 v76, v76, v15
    v_mul_f32 v77, v77, v15
    v_mul_f32 v78, v78, v15
    v_mul_f32 v79, v79, v15
    v_mul_f32 v80, v80, v15
    v_mul_f32 v81, v81, v15
    v_mul_f32 v82, v82, v15
    v_mul_f32 v83, v83, v15
    v_mul_f32 v84, v84, v15
    v_mul_f32 v85, v85, v15
    v_mul_f32 v86, v86, v15
    v_mul_f32 v87, v87, v15
    v_mul_f32 v88, v88, v15
    v_mul_f32 v89, v89, v15
    v_mul_f32 v90, v90, v15
    v_mul_f32 v91, v91, v15
    v_mul_f32 v92, v92, v15
    v_mul_f32 v93, v93, v15
    v_mul_f32 v94, v94, v15
    v_mul_f32 v95, v95, v15
    s_waitcnt lgkmcnt(6)
    v_fmac_f32 v64, v128, v9
    v_fmac_f32 v65, v129, v9
    v_fmac_f32 v66, v130, v9
    v_fmac_f32 v67, v131, v9
    v_fmac_f32 v68, v132, v9
    v_fmac_f32 v69, v133, v9
    v_fmac_f32 v70, v134, v9
    v_fmac_f32 v71, v135, v9
    v_cvt_pk_bf16_f32 v64, v64, v65
    v_cvt_pk_bf16_f32 v65, v66, v67
    v_cvt_pk_bf16_f32 v66, v68, v69
    v_cvt_pk_bf16_f32 v67, v70, v71
    s_add_u32 s15, s31, 0
    buffer_store_dwordx4 v[64:67], v2, s[16:19], s15 offen offset:0 sc1
    s_waitcnt lgkmcnt(4)
    v_fmac_f32 v72, v136, v9
    v_fmac_f32 v73, v137, v9
    v_fmac_f32 v74, v138, v9
    v_fmac_f32 v75, v139, v9
    v_fmac_f32 v76, v140, v9
    v_fmac_f32 v77, v141, v9
    v_fmac_f32 v78, v142, v9
    v_fmac_f32 v79, v143, v9
    v_cvt_pk_bf16_f32 v72, v72, v73
    v_cvt_pk_bf16_f32 v73, v74, v75
    v_cvt_pk_bf16_f32 v74, v76, v77
    v_cvt_pk_bf16_f32 v75, v78, v79
    buffer_store_dwordx4 v[72:75], v2, s[16:19], s15 offen offset:1024 sc1
    s_waitcnt lgkmcnt(2)
    v_fmac_f32 v80, v144, v9
    v_fmac_f32 v81, v145, v9
    v_fmac_f32 v82, v146, v9
    v_fmac_f32 v83, v147, v9
    v_fmac_f32 v84, v148, v9
    v_fmac_f32 v85, v149, v9
    v_fmac_f32 v86, v150, v9
    v_fmac_f32 v87, v151, v9
    v_cvt_pk_bf16_f32 v80, v80, v81
    v_cvt_pk_bf16_f32 v81, v82, v83
    v_cvt_pk_bf16_f32 v82, v84, v85
    v_cvt_pk_bf16_f32 v83, v86, v87
    buffer_store_dwordx4 v[80:83], v2, s[16:19], s15 offen offset:2048 sc1
    s_waitcnt lgkmcnt(0)
    v_fmac_f32 v88, v152, v9
    v_fmac_f32 v89, v153, v9
    v_fmac_f32 v90, v154, v9
    v_fmac_f32 v91, v155, v9
    v_fmac_f32 v92, v156, v9
    v_fmac_f32 v93, v157, v9
    v_fmac_f32 v94, v158, v9
    v_fmac_f32 v95, v159, v9
    v_cvt_pk_bf16_f32 v88, v88, v89
    v_cvt_pk_bf16_f32 v89, v90, v91
    v_cvt_pk_bf16_f32 v90, v92, v93
    v_cvt_pk_bf16_f32 v91, v94, v95
    buffer_store_dwordx4 v[88:91], v2, s[16:19], s15 offen offset:3072 sc1
    s_waitcnt vmcnt(0) lgkmcnt(0)
    s_barrier
    s_lshl_b32 s14, s5, 8
    s_lshl_b32 s15, s4, 3
    s_add_u32 s14, s14, s15
    s_add_u32 s14, s14, 16384
    s_add_u32 s14, s14, s7
    v_mov_b32 v46, s6
    v_mov_b32 v47, s6
    buffer_store_dwordx2 v[46:47], off, s[8:11], s14 sc1
    s_lshl_b32 s14, s5, 8
    s_lshl_b32 s15, s4, 3
    s_sub_u32 s14, s15, s14
    s_add_u32 s14, s14, 20224
    s_add_u32 s14, s14, s7
    v_mov_b32 v46, s6
    v_mov_b32 v47, s6
    buffer_store_dwordx2 v[46:47], off, s[8:11], s14 sc1
    v_cmp_gt_u32 vcc, 16, v1
    s_add_u32 m0, s61, 0
    s_add_u32 s14, s60, 0
    buffer_load_dwordx4 v34, s[44:47], s14 offen sc1 lds
    v_fmamk_f32 v128, v38, 0x00000000, v39
    v_fmamk_f32 v130, v38, 0x3f800000, v39
    v_fmamk_f32 v132, v38, 0x40000000, v39
    v_fmamk_f32 v134, v38, 0x40400000, v39
    v_sin_f32 v129, -v128
    v_cos_f32 v128, v128
    v_sin_f32 v131, -v130
    v_cos_f32 v130, v130
    v_sin_f32 v133, -v132
    v_cos_f32 v132, v132
    v_sin_f32 v135, -v134
    v_cos_f32 v134, v134
    v_mul_f32 v144, 0x41800000, v38
    v_cos_f32 v144, v144
    v_cndmask_b32 v41, v129, v41, vcc
    s_add_u32 m0, s61, 1024
    s_add_u32 s14, s60, 32768
    buffer_load_dwordx4 v35, s[44:47], s14 offen sc1 lds
    v_add_f32 v144, v144, v144
    v_cvt_pk_bf16_f32 v64, v128, v41
    v_cvt_pk_bf16_f32 v65, v130, v131
    v_cvt_pk_bf16_f32 v66, v132, v133
    v_cvt_pk_bf16_f32 v67, v134, v135
    v_fmamk_f32 v136, v38, 0x41800000, v39
    v_fmamk_f32 v138, v38, 0x41880000, v39
    v_fmamk_f32 v140, v38, 0x41900000, v39
    v_fmamk_f32 v142, v38, 0x41980000, v39
    v_sin_f32 v137, -v136
    v_cos_f32 v136, v136
    v_sin_f32 v139, -v138
    v_cos_f32 v138, v138
    v_sin_f32 v141, -v140
    v_cos_f32 v140, v140
    v_sin_f32 v143, -v142
    s_add_u32 m0, s61, 2048
    s_add_u32 s14, s60, 65536
    buffer_load_dwordx4 v34, s[44:47], s14 offen sc1 lds
    v_cos_f32 v142, v142
    v_cvt_pk_bf16_f32 v68, v136, v137
    v_cvt_pk_bf16_f32 v69, v138, v139
    v_cvt_pk_bf16_f32 v70, v140, v141
    v_cvt_pk_bf16_f32 v71, v142, v143
    v_fma_f32 v128, v144, v136, -v128
    v_fma_f32 v129, v144, v137, -v129
    v_fma_f32 v130, v144, v138, -v130
    v_fma_f32 v131, v144, v139, -v131
    v_fma_f32 v132, v144, v140, -v132
    v_fma_f32 v133, v144, v141, -v133
    v_fma_f32 v134, v144, v142, -v134
    v_fma_f32 v135, v144, v143, -v135
    v_cvt_pk_bf16_f32 v72, v128, v129
    v_cvt_pk_bf16_f32 v73, v130, v131
    v_cvt_pk_bf16_f32 v74, v132, v133
    s_add_u32 m0, s61, 3072
    s_add_u32 s14, s60, 98304
    buffer_load_dwordx4 v35, s[44:47], s14 offen sc1 lds
    v_cvt_pk_bf16_f32 v75, v134, v135
    v_fma_f32 v136, v144, v128, -v136
    v_fma_f32 v137, v144, v129, -v137
    v_fma_f32 v138, v144, v130, -v138
    v_fma_f32 v139, v144, v131, -v139
    v_fma_f32 v140, v144, v132, -v140
    v_fma_f32 v141, v144, v133, -v141
    v_fma_f32 v142, v144, v134, -v142
    v_fma_f32 v143, v144, v135, -v143
    v_cvt_pk_bf16_f32 v76, v136, v137
    v_cvt_pk_bf16_f32 v77, v138, v139
    v_cvt_pk_bf16_f32 v78, v140, v141
    v_cvt_pk_bf16_f32 v79, v142, v143
    v_fma_f32 v128, v144, v136, -v128
    v_fma_f32 v129, v144, v137, -v129
    s_add_u32 m0, s61, 4096
    s_add_u32 s14, s60, 131072
    buffer_load_dwordx4 v34, s[44:47], s14 offen sc1 lds
    v_fma_f32 v130, v144, v138, -v130
    v_fma_f32 v131, v144, v139, -v131
    v_fma_f32 v132, v144, v140, -v132
    v_fma_f32 v133, v144, v141, -v133
    v_fma_f32 v134, v144, v142, -v134
    v_fma_f32 v135, v144, v143, -v135
    v_cvt_pk_bf16_f32 v80, v128, v129
    v_cvt_pk_bf16_f32 v81, v130, v131
    v_cvt_pk_bf16_f32 v82, v132, v133
    v_cvt_pk_bf16_f32 v83, v134, v135
    v_fma_f32 v136, v144, v128, -v136
    v_fma_f32 v137, v144, v129, -v137
    v_fma_f32 v138, v144, v130, -v138
    v_fma_f32 v139, v144, v131, -v139
    v_fma_f32 v140, v144, v132, -v140
    v_fma_f32 v141, v144, v133, -v141
    s_add_u32 m0, s61, 5120
    s_add_u32 s14, s60, 163840
    buffer_load_dwordx4 v35, s[44:47], s14 offen sc1 lds
    v_fma_f32 v142, v144, v134, -v142
    v_fma_f32 v143, v144, v135, -v143
    v_cvt_pk_bf16_f32 v84, v136, v137
    v_cvt_pk_bf16_f32 v85, v138, v139
    v_cvt_pk_bf16_f32 v86, v140, v141
    v_cvt_pk_bf16_f32 v87, v142, v143
    v_fma_f32 v128, v144, v136, -v128
    v_fma_f32 v129, v144, v137, -v129
    v_fma_f32 v130, v144, v138, -v130
    v_fma_f32 v131, v144, v139, -v131
    v_fma_f32 v132, v144, v140, -v132
    v_fma_f32 v133, v144, v141, -v133
    v_fma_f32 v134, v144, v142, -v134
    v_fma_f32 v135, v144, v143, -v135
    v_cvt_pk_bf16_f32 v88, v128, v129
    v_cvt_pk_bf16_f32 v89, v130, v131
    s_add_u32 m0, s61, 6144
    s_add_u32 s14, s60, 196608
    buffer_load_dwordx4 v34, s[44:47], s14 offen sc1 lds
    v_cvt_pk_bf16_f32 v90, v132, v133
    v_cvt_pk_bf16_f32 v91, v134, v135
    v_fma_f32 v136, v144, v128, -v136
    v_fma_f32 v137, v144, v129, -v137
    v_fma_f32 v138, v144, v130, -v138
    v_fma_f32 v139, v144, v131, -v139
    v_fma_f32 v140, v144, v132, -v140
    v_fma_f32 v141, v144, v133, -v141
    v_fma_f32 v142, v144, v134, -v142
    v_fma_f32 v143, v144, v135, -v143
    v_cvt_pk_bf16_f32 v92, v136, v137
    v_cvt_pk_bf16_f32 v93, v138, v139
    v_cvt_pk_bf16_f32 v94, v140, v141
    v_cvt_pk_bf16_f32 v95, v142, v143
    v_fma_f32 v128, v144, v136, -v128
    s_add_u32 m0, s61, 7168
    s_add_u32 s14, s60, 229376
    buffer_load_dwordx4 v35, s[44:47], s14 offen sc1 lds
    v_fma_f32 v129, v144, v137, -v129
    v_fma_f32 v130, v144, v138, -v130
    v_fma_f32 v131, v144, v139, -v131
    v_fma_f32 v132, v144, v140, -v132
    v_fma_f32 v133, v144, v141, -v133
    v_fma_f32 v134, v144, v142, -v134
    v_fma_f32 v135, v144, v143, -v135
    v_cvt_pk_bf16_f32 v96, v128, v129
    v_cvt_pk_bf16_f32 v97, v130, v131
    v_cvt_pk_bf16_f32 v98, v132, v133
    v_cvt_pk_bf16_f32 v99, v134, v135
    v_fma_f32 v136, v144, v128, -v136
    v_fma_f32 v137, v144, v129, -v137
    v_fma_f32 v138, v144, v130, -v138
    v_fma_f32 v139, v144, v131, -v139
    v_fma_f32 v140, v144, v132, -v140
    buffer_load_dwordx2 v[30:31], v42, s[8:11], s64 offen offset:0 sc1
    v_fma_f32 v141, v144, v133, -v141
    v_fma_f32 v142, v144, v134, -v142
    v_fma_f32 v143, v144, v135, -v143
    v_cvt_pk_bf16_f32 v100, v136, v137
    v_cvt_pk_bf16_f32 v101, v138, v139
    v_cvt_pk_bf16_f32 v102, v140, v141
    v_cvt_pk_bf16_f32 v103, v142, v143
    v_fma_f32 v128, v144, v136, -v128
    v_fma_f32 v129, v144, v137, -v129
    v_fma_f32 v130, v144, v138, -v130
    v_fma_f32 v131, v144, v139, -v131
    v_fma_f32 v132, v144, v140, -v132
    v_fma_f32 v133, v144, v141, -v133
    v_fma_f32 v134, v144, v142, -v134
    v_fma_f32 v135, v144, v143, -v135
    v_cvt_pk_bf16_f32 v104, v128, v129
    s_add_u32 m0, s27, 0
    s_add_u32 s73, s72, 24576
    buffer_load_dwordx4 v2, s[36:39], s73 offen offset:0 sc1 lds
    v_cvt_pk_bf16_f32 v105, v130, v131
    v_cvt_pk_bf16_f32 v106, v132, v133
    v_cvt_pk_bf16_f32 v107, v134, v135
    v_fma_f32 v136, v144, v128, -v136
    v_fma_f32 v137, v144, v129, -v137
    v_fma_f32 v138, v144, v130, -v138
    v_fma_f32 v139, v144, v131, -v139
    v_fma_f32 v140, v144, v132, -v140
    v_fma_f32 v141, v144, v133, -v141
    v_fma_f32 v142, v144, v134, -v142
    v_fma_f32 v143, v144, v135, -v143
    v_cvt_pk_bf16_f32 v108, v136, v137
    v_cvt_pk_bf16_f32 v109, v138, v139
    v_cvt_pk_bf16_f32 v110, v140, v141
    v_cvt_pk_bf16_f32 v111, v142, v143
    buffer_load_dwordx4 v2, s[36:39], s73 offen offset:1024 sc1 lds
    v_fma_f32 v128, v144, v136, -v128
    v_fma_f32 v129, v144, v137, -v129
    v_fma_f32 v130, v144, v138, -v130
    v_fma_f32 v131, v144, v139, -v131
    v_fma_f32 v132, v144, v140, -v132
    v_fma_f32 v133, v144, v141, -v133
    v_fma_f32 v134, v144, v142, -v134
    v_fma_f32 v135, v144, v143, -v135
    v_cvt_pk_bf16_f32 v112, v128, v129
    v_cvt_pk_bf16_f32 v113, v130, v131
    v_cvt_pk_bf16_f32 v114, v132, v133
    v_cvt_pk_bf16_f32 v115, v134, v135
    v_fma_f32 v136, v144, v128, -v136
    v_fma_f32 v137, v144, v129, -v137
    v_fma_f32 v138, v144, v130, -v138
    v_fma_f32 v139, v144, v131, -v139
    buffer_load_dwordx4 v2, s[36:39], s73 offen offset:2048 sc1 lds
    v_fma_f32 v140, v144, v132, -v140
    v_fma_f32 v141, v144, v133, -v141
    v_fma_f32 v142, v144, v134, -v142
    v_fma_f32 v143, v144, v135, -v143
    v_cvt_pk_bf16_f32 v116, v136, v137
    v_cvt_pk_bf16_f32 v117, v138, v139
    v_cvt_pk_bf16_f32 v118, v140, v141
    v_cvt_pk_bf16_f32 v119, v142, v143
    v_fma_f32 v128, v144, v136, -v128
    v_fma_f32 v129, v144, v137, -v129
    v_fma_f32 v130, v144, v138, -v130
    v_fma_f32 v131, v144, v139, -v131
    v_fma_f32 v132, v144, v140, -v132
    v_fma_f32 v133, v144, v141, -v133
    v_fma_f32 v134, v144, v142, -v134
    v_fma_f32 v135, v144, v143, -v135
    buffer_load_dwordx4 v2, s[36:39], s73 offen offset:3072 sc1 lds
    v_cvt_pk_bf16_f32 v120, v128, v129
    v_cvt_pk_bf16_f32 v121, v130, v131
    v_cvt_pk_bf16_f32 v122, v132, v133
    v_cvt_pk_bf16_f32 v123, v134, v135
    v_fma_f32 v136, v144, v128, -v136
    v_fma_f32 v137, v144, v129, -v137
    v_fma_f32 v138, v144, v130, -v138
    v_fma_f32 v139, v144, v131, -v139
    v_fma_f32 v140, v144, v132, -v140
    v_fma_f32 v141, v144, v133, -v141
    v_fma_f32 v142, v144, v134, -v142
    v_fma_f32 v143, v144, v135, -v143
    v_cvt_pk_bf16_f32 v124, v136, v137
    v_cvt_pk_bf16_f32 v125, v138, v139
    v_cvt_pk_bf16_f32 v126, v140, v141
    v_cvt_pk_bf16_f32 v127, v142, v143
    s_waitcnt vmcnt(5)
    s_barrier
    v_add_u32 v36, 0x8000, v36
    v_add_u32 v37, 0x8000, v37
    ds_read_b64_tr_b16 v[48:49], v36 offset:0
    ds_read_b64_tr_b16 v[50:51], v36 offset:512
    ds_read_b64_tr_b16 v[52:53], v37 offset:0
    ds_read_b64_tr_b16 v[54:55], v37 offset:512
    ds_read_b64_tr_b16 v[56:57], v36 offset:4096
    ds_read_b64_tr_b16 v[58:59], v36 offset:4608
    ds_read_b64_tr_b16 v[60:61], v37 offset:4096
    ds_read_b64_tr_b16 v[62:63], v37 offset:4608
    s_waitcnt lgkmcnt(4)
    v_mfma_f32_16x16x32_bf16 v[16:19], v[64:67], v[48:51], 0
    v_mfma_f32_16x16x32_bf16 v[20:23], v[64:67], v[52:55], 0
    s_waitcnt vmcnt(4)
    v_xor_b32 v30, s6, v30
    v_xor_b32 v31, s6, v31
    v_or_b32 v30, v30, v31
    v_cmp_ne_u32 vcc, 0, v30
    s_mov_b32 s73, 0
    s_cbranch_vccnz concat_notyet_65
    buffer_load_dwordx4 v[192:195], v2, s[16:19], s56 offen offset:0 sc1
    buffer_load_dwordx4 v[196:199], v2, s[16:19], s57 offen offset:0 sc1
    buffer_load_dwordx4 v[200:203], v2, s[16:19], s58 offen offset:0 sc1
    buffer_load_dwordx4 v[204:207], v2, s[16:19], s59 offen offset:0 sc1
    buffer_load_dwordx4 v[144:147], v2, s[16:19], s56 offen offset:1024 sc1
    buffer_load_dwordx4 v[148:151], v2, s[16:19], s57 offen offset:1024 sc1
    buffer_load_dwordx4 v[152:155], v2, s[16:19], s58 offen offset:1024 sc1
    buffer_load_dwordx4 v[156:159], v2, s[16:19], s59 offen offset:1024 sc1
    buffer_load_dwordx4 v[128:131], v2, s[16:19], s56 offen offset:2048 sc1
    buffer_load_dwordx4 v[132:135], v2, s[16:19], s57 offen offset:2048 sc1
    buffer_load_dwordx4 v[136:139], v2, s[16:19], s58 offen offset:2048 sc1
    buffer_load_dwordx4 v[140:143], v2, s[16:19], s59 offen offset:2048 sc1
    s_mov_b32 s73, 1
concat_notyet_65:
    s_mov_b32 s60, s73
    ds_read_b64_tr_b16 v[48:49], v36 offset:8192
    ds_read_b64_tr_b16 v[50:51], v36 offset:8704
    ds_read_b64_tr_b16 v[52:53], v37 offset:8192
    ds_read_b64_tr_b16 v[54:55], v37 offset:8704
    s_waitcnt lgkmcnt(4)
    v_mfma_f32_16x16x32_bf16 v[16:19], v[68:71], v[56:59], v[16:19]
    v_mfma_f32_16x16x32_bf16 v[20:23], v[68:71], v[60:63], v[20:23]
    ds_read_b64_tr_b16 v[56:57], v36 offset:12288
    ds_read_b64_tr_b16 v[58:59], v36 offset:12800
    ds_read_b64_tr_b16 v[60:61], v37 offset:12288
    ds_read_b64_tr_b16 v[62:63], v37 offset:12800
    s_waitcnt lgkmcnt(4)
    v_mfma_f32_16x16x32_bf16 v[16:19], v[72:75], v[48:51], v[16:19]
    v_mfma_f32_16x16x32_bf16 v[20:23], v[72:75], v[52:55], v[20:23]
    v_add_u32 v36, 0x10000, v36
    v_add_u32 v37, 0x10000, v37
    ds_read_b64_tr_b16 v[48:49], v36 offset:0
    ds_read_b64_tr_b16 v[50:51], v36 offset:512
    ds_read_b64_tr_b16 v[52:53], v37 offset:0
    ds_read_b64_tr_b16 v[54:55], v37 offset:512
    s_waitcnt lgkmcnt(4)
    v_mfma_f32_16x16x32_bf16 v[16:19], v[76:79], v[56:59], v[16:19]
    v_mfma_f32_16x16x32_bf16 v[20:23], v[76:79], v[60:63], v[20:23]
    ds_read_b64_tr_b16 v[56:57], v36 offset:4096
    ds_read_b64_tr_b16 v[58:59], v36 offset:4608
    ds_read_b64_tr_b16 v[60:61], v37 offset:4096
    ds_read_b64_tr_b16 v[62:63], v37 offset:4608
    s_waitcnt lgkmcnt(4)
    v_mfma_f32_16x16x32_bf16 v[16:19], v[80:83], v[48:51], v[16:19]
    v_mfma_f32_16x16x32_bf16 v[20:23], v[80:83], v[52:55], v[20:23]
    ds_read_b64_tr_b16 v[48:49], v36 offset:8192
    ds_read_b64_tr_b16 v[50:51], v36 offset:8704
    ds_read_b64_tr_b16 v[52:53], v37 offset:8192
    ds_read_b64_tr_b16 v[54:55], v37 offset:8704
    s_waitcnt lgkmcnt(4)
    v_mfma_f32_16x16x32_bf16 v[16:19], v[84:87], v[56:59], v[16:19]
    v_mfma_f32_16x16x32_bf16 v[20:23], v[84:87], v[60:63], v[20:23]
    ds_read_b64_tr_b16 v[56:57], v36 offset:12288
    ds_read_b64_tr_b16 v[58:59], v36 offset:12800
    ds_read_b64_tr_b16 v[60:61], v37 offset:12288
    ds_read_b64_tr_b16 v[62:63], v37 offset:12800
    s_waitcnt lgkmcnt(4)
    v_mfma_f32_16x16x32_bf16 v[16:19], v[88:91], v[48:51], v[16:19]
    v_mfma_f32_16x16x32_bf16 v[20:23], v[88:91], v[52:55], v[20:23]
    v_add_u32 v36, 0x8000, v36
    v_add_u32 v37, 0x8000, v37
    ds_read_b64_tr_b16 v[48:49], v36 offset:0
    ds_read_b64_tr_b16 v[50:51], v36 offset:512
    ds_read_b64_tr_b16 v[52:53], v37 offset:0
    ds_read_b64_tr_b16 v[54:55], v37 offset:512
    s_waitcnt lgkmcnt(4)
    v_mfma_f32_16x16x32_bf16 v[16:19], v[92:95], v[56:59], v[16:19]
    v_mfma_f32_16x16x32_bf16 v[20:23], v[92:95], v[60:63], v[20:23]
    ds_read_b64_tr_b16 v[56:57], v36 offset:4096
    ds_read_b64_tr_b16 v[58:59], v36 offset:4608
    ds_read_b64_tr_b16 v[60:61], v37 offset:4096
    ds_read_b64_tr_b16 v[62:63], v37 offset:4608
    s_waitcnt lgkmcnt(4)
    v_mfma_f32_16x16x32_bf16 v[16:19], v[96:99], v[48:51], v[16:19]
    v_mfma_f32_16x16x32_bf16 v[20:23], v[96:99], v[52:55], v[20:23]
    ds_read_b64_tr_b16 v[48:49], v36 offset:8192
    ds_read_b64_tr_b16 v[50:51], v36 offset:8704
    ds_read_b64_tr_b16 v[52:53], v37 offset:8192
    ds_read_b64_tr_b16 v[54:55], v37 offset:8704
    s_waitcnt lgkmcnt(4)
    v_mfma_f32_16x16x32_bf16 v[16:19], v[100:103], v[56:59], v[16:19]
    v_mfma_f32_16x16x32_bf16 v[20:23], v[100:103], v[60:63], v[20:23]
    ds_read_b64_tr_b16 v[56:57], v36 offset:12288
    ds_read_b64_tr_b16 v[58:59], v36 offset:12800
    ds_read_b64_tr_b16 v[60:61], v37 offset:12288
    ds_read_b64_tr_b16 v[62:63], v37 offset:12800
    s_waitcnt lgkmcnt(4)
    v_mfma_f32_16x16x32_bf16 v[16:19], v[104:107], v[48:51], v[16:19]
    v_mfma_f32_16x16x32_bf16 v[20:23], v[104:107], v[52:55], v[20:23]
    ds_read_b64_tr_b16 v[48:49], v36 offset:16384
    ds_read_b64_tr_b16 v[50:51], v36 offset:16896
    ds_read_b64_tr_b16 v[52:53], v37 offset:16384
    ds_read_b64_tr_b16 v[54:55], v37 offset:16896
    s_waitcnt lgkmcnt(4)
    v_mfma_f32_16x16x32_bf16 v[16:19], v[108:111], v[56:59], v[16:19]
    v_mfma_f32_16x16x32_bf16 v[20:23], v[108:111], v[60:63], v[20:23]
    ds_read_b64_tr_b16 v[56:57], v36 offset:20480
    ds_read_b64_tr_b16 v[58:59], v36 offset:20992
    ds_read_b64_tr_b16 v[60:61], v37 offset:20480
    ds_read_b64_tr_b16 v[62:63], v37 offset:20992
    s_waitcnt lgkmcnt(4)
    v_mfma_f32_16x16x32_bf16 v[16:19], v[112:115], v[48:51], v[16:19]
    v_mfma_f32_16x16x32_bf16 v[20:23], v[112:115], v[52:55], v[20:23]
    ds_read_b64_tr_b16 v[48:49], v36 offset:24576
    ds_read_b64_tr_b16 v[50:51], v36 offset:25088
    ds_read_b64_tr_b16 v[52:53], v37 offset:24576
    ds_read_b64_tr_b16 v[54:55], v37 offset:25088
    s_waitcnt lgkmcnt(4)
    v_mfma_f32_16x16x32_bf16 v[16:19], v[116:119], v[56:59], v[16:19]
    v_mfma_f32_16x16x32_bf16 v[20:23], v[116:119], v[60:63], v[20:23]
    ds_read_b64_tr_b16 v[56:57], v36 offset:28672
    ds_read_b64_tr_b16 v[58:59], v36 offset:29184
    ds_read_b64_tr_b16 v[60:61], v37 offset:28672
    ds_read_b64_tr_b16 v[62:63], v37 offset:29184
    s_waitcnt lgkmcnt(4)
    v_mfma_f32_16x16x32_bf16 v[16:19], v[120:123], v[48:51], v[16:19]
    v_mfma_f32_16x16x32_bf16 v[20:23], v[120:123], v[52:55], v[20:23]
    s_waitcnt lgkmcnt(0)
    v_mfma_f32_16x16x32_bf16 v[16:19], v[124:127], v[56:59], v[16:19]
    v_mfma_f32_16x16x32_bf16 v[20:23], v[124:127], v[60:63], v[20:23]
    s_barrier
    s_add_u32 m0, s61, 0
    s_add_u32 s73, s72, 28672
    buffer_load_dwordx4 v2, s[36:39], s73 offen offset:0 sc1 lds
    buffer_load_dwordx4 v2, s[36:39], s73 offen offset:1024 sc1 lds
    buffer_load_dwordx4 v2, s[36:39], s73 offen offset:2048 sc1 lds
    buffer_load_dwordx4 v2, s[36:39], s73 offen offset:3072 sc1 lds
    s_add_u32 m0, s61, 4096
    s_add_u32 s73, s72, 32768
    buffer_load_dwordx4 v2, s[36:39], s73 offen offset:0 sc1 lds
    buffer_load_dwordx4 v2, s[36:39], s73 offen offset:1024 sc1 lds
    buffer_load_dwordx4 v2, s[36:39], s73 offen offset:2048 sc1 lds
    buffer_load_dwordx4 v2, s[36:39], s73 offen offset:3072 sc1 lds
    s_cmp_eq_u32 s60, 1
    s_cbranch_scc1 concat_have_66
    s_mov_b32 s63, 0x100000
concat_poll_67:
    buffer_load_dwordx2 v[30:31], v42, s[8:11], s64 offen offset:0 sc1
    s_waitcnt vmcnt(0)
    v_xor_b32 v30, s6, v30
    v_xor_b32 v31, s6, v31
    v_or_b32 v30, v30, v31
    v_cmp_ne_u32 vcc, 0, v30
    s_nop 0
    s_cbranch_vccz concat_pdone_68
    s_sleep 1
    s_sub_u32 s63, s63, 1
    s_cbranch_scc0 concat_poll_67
concat_pdone_68:
    buffer_load_dwordx4 v[192:195], v2, s[16:19], s56 offen offset:0 sc1
    buffer_load_dwordx4 v[196:199], v2, s[16:19], s57 offen offset:0 sc1
    buffer_load_dwordx4 v[200:203], v2, s[16:19], s58 offen offset:0 sc1
    buffer_load_dwordx4 v[204:207], v2, s[16:19], s59 offen offset:0 sc1
    buffer_load_dwordx4 v[144:147], v2, s[16:19], s56 offen offset:1024 sc1
    buffer_load_dwordx4 v[148:151], v2, s[16:19], s57 offen offset:1024 sc1
    buffer_load_dwordx4 v[152:155], v2, s[16:19], s58 offen offset:1024 sc1
    buffer_load_dwordx4 v[156:159], v2, s[16:19], s59 offen offset:1024 sc1
    buffer_load_dwordx4 v[128:131], v2, s[16:19], s56 offen offset:2048 sc1
    buffer_load_dwordx4 v[132:135], v2, s[16:19], s57 offen offset:2048 sc1
    buffer_load_dwordx4 v[136:139], v2, s[16:19], s58 offen offset:2048 sc1
    buffer_load_dwordx4 v[140:143], v2, s[16:19], s59 offen offset:2048 sc1
concat_have_66:
    v_cvt_pk_bf16_f32 v16, v16, v17
    v_cvt_pk_bf16_f32 v17, v18, v19
    v_cvt_pk_bf16_f32 v20, v20, v21
    v_cvt_pk_bf16_f32 v21, v22, v23
    s_waitcnt vmcnt(8)
    v_mfma_f32_16x16x32_bf16 v[64:67], v[160:163], v[192:195], 0
    v_mfma_f32_16x16x32_bf16 v[68:71], v[164:167], v[192:195], 0
    v_mfma_f32_16x16x32_bf16 v[72:75], v[168:171], v[192:195], 0
    v_mfma_f32_16x16x32_bf16 v[76:79], v[172:175], v[192:195], 0
    v_mfma_f32_16x16x32_bf16 v[80:83], v[160:163], v[196:199], 0
    v_mfma_f32_16x16x32_bf16 v[84:87], v[164:167], v[196:199], 0
    v_mfma_f32_16x16x32_bf16 v[88:91], v[168:171], v[196:199], 0
    v_mfma_f32_16x16x32_bf16 v[92:95], v[172:175], v[196:199], 0
    v_mfma_f32_16x16x32_bf16 v[96:99], v[160:163], v[200:203], 0
    v_mfma_f32_16x16x32_bf16 v[100:103], v[164:167], v[200:203], 0
    v_mfma_f32_16x16x32_bf16 v[104:107], v[168:171], v[200:203], 0
    v_mfma_f32_16x16x32_bf16 v[108:111], v[172:175], v[200:203], 0
    v_mfma_f32_16x16x32_bf16 v[112:115], v[160:163], v[204:207], 0
    v_mfma_f32_16x16x32_bf16 v[116:119], v[164:167], v[204:207], 0
    v_mfma_f32_16x16x32_bf16 v[120:123], v[168:171], v[204:207], 0
    v_mfma_f32_16x16x32_bf16 v[124:127], v[172:175], v[204:207], 0
    buffer_load_dwordx4 v[192:195], v2, s[16:19], s56 offen offset:3072 sc1
    buffer_load_dwordx4 v[196:199], v2, s[16:19], s57 offen offset:3072 sc1
    buffer_load_dwordx4 v[200:203], v2, s[16:19], s58 offen offset:3072 sc1
    buffer_load_dwordx4 v[204:207], v2, s[16:19], s59 offen offset:3072 sc1
    s_add_u32 s56, s56, 8192
    s_add_u32 s57, s57, 8192
    s_add_u32 s58, s58, 8192
    s_add_u32 s59, s59, 8192
    buffer_load_dwordx4 v[160:163], v2, s[16:19], s56 offen offset:0 sc1
    buffer_load_dwordx4 v[164:167], v2, s[16:19], s57 offen offset:0 sc1
    buffer_load_dwordx4 v[168:171], v2, s[16:19], s58 offen offset:0 sc1
    buffer_load_dwordx4 v[172:175], v2, s[16:19], s59 offen offset:0 sc1
    s_waitcnt vmcnt(12)
    v_mfma_f32_16x16x32_bf16 v[64:67], v[176:179], v[144:147], v[64:67]
    v_mfma_f32_16x16x32_bf16 v[68:71], v[180:183], v[144:147], v[68:71]
    v_mfma_f32_16x16x32_bf16 v[72:75], v[184:187], v[144:147], v[72:75]
    v_mfma_f32_16x16x32_bf16 v[76:79], v[188:191], v[144:147], v[76:79]
    v_mfma_f32_16x16x32_bf16 v[80:83], v[176:179], v[148:151], v[80:83]
    v_mfma_f32_16x16x32_bf16 v[84:87], v[180:183], v[148:151], v[84:87]
    v_mfma_f32_16x16x32_bf16 v[88:91], v[184:187], v[148:151], v[88:91]
    v_mfma_f32_16x16x32_bf16 v[92:95], v[188:191], v[148:151], v[92:95]
    v_mfma_f32_16x16x32_bf16 v[96:99], v[176:179], v[152:155], v[96:99]
    v_mfma_f32_16x16x32_bf16 v[100:103], v[180:183], v[152:155], v[100:103]
    v_mfma_f32_16x16x32_bf16 v[104:107], v[184:187], v[152:155], v[104:107]
    v_mfma_f32_16x16x32_bf16 v[108:111], v[188:191], v[152:155], v[108:111]
    v_mfma_f32_16x16x32_bf16 v[112:115], v[176:179], v[156:159], v[112:115]
    v_mfma_f32_16x16x32_bf16 v[116:119], v[180:183], v[156:159], v[116:119]
    v_mfma_f32_16x16x32_bf16 v[120:123], v[184:187], v[156:159], v[120:123]
    v_mfma_f32_16x16x32_bf16 v[124:127], v[188:191], v[156:159], v[124:127]
    buffer_load_dwordx4 v[144:147], v2, s[16:19], s56 offen offset:1024 sc1
    buffer_load_dwordx4 v[148:151], v2, s[16:19], s57 offen offset:1024 sc1
    buffer_load_dwordx4 v[152:155], v2, s[16:19], s58 offen offset:1024 sc1
    buffer_load_dwordx4 v[156:159], v2, s[16:19], s59 offen offset:1024 sc1
    buffer_load_dwordx4 v[176:179], v2, s[16:19], s56 offen offset:2048 sc1
    buffer_load_dwordx4 v[180:183], v2, s[16:19], s57 offen offset:2048 sc1
    buffer_load_dwordx4 v[184:187], v2, s[16:19], s58 offen offset:2048 sc1
    buffer_load_dwordx4 v[188:191], v2, s[16:19], s59 offen offset:2048 sc1
    s_waitcnt vmcnt(16)
    v_mfma_f32_16x16x32_bf16 v[64:67], v[240:243], v[128:131], v[64:67]
    v_mfma_f32_16x16x32_bf16 v[68:71], v[244:247], v[128:131], v[68:71]
    v_mfma_f32_16x16x32_bf16 v[72:75], v[248:251], v[128:131], v[72:75]
    v_mfma_f32_16x16x32_bf16 v[76:79], v[252:255], v[128:131], v[76:79]
    v_mfma_f32_16x16x32_bf16 v[80:83], v[240:243], v[132:135], v[80:83]
    v_mfma_f32_16x16x32_bf16 v[84:87], v[244:247], v[132:135], v[84:87]
    v_mfma_f32_16x16x32_bf16 v[88:91], v[248:251], v[132:135], v[88:91]
    v_mfma_f32_16x16x32_bf16 v[92:95], v[252:255], v[132:135], v[92:95]
    v_mfma_f32_16x16x32_bf16 v[96:99], v[240:243], v[136:139], v[96:99]
    v_mfma_f32_16x16x32_bf16 v[100:103], v[244:247], v[136:139], v[100:103]
    v_mfma_f32_16x16x32_bf16 v[104:107], v[248:251], v[136:139], v[104:107]
    v_mfma_f32_16x16x32_bf16 v[108:111], v[252:255], v[136:139], v[108:111]
    v_mfma_f32_16x16x32_bf16 v[112:115], v[240:243], v[140:143], v[112:115]
    v_mfma_f32_16x16x32_bf16 v[116:119], v[244:247], v[140:143], v[116:119]
    v_mfma_f32_16x16x32_bf16 v[120:123], v[248:251], v[140:143], v[120:123]
    v_mfma_f32_16x16x32_bf16 v[124:127], v[252:255], v[140:143], v[124:127]
    ds_read_b128 v[128:131], v32 offset:16384
    ds_read_b128 v[132:135], v32 offset:17408
    ds_read_b128 v[136:139], v32 offset:18432
    ds_read_b128 v[140:143], v32 offset:19456
    buffer_load_dwordx4 v[240:243], v2, s[16:19], s56 offen offset:3072 sc1
    buffer_load_dwordx4 v[244:247], v2, s[16:19], s57 offen offset:3072 sc1
    buffer_load_dwordx4 v[248:251], v2, s[16:19], s58 offen offset:3072 sc1
    buffer_load_dwordx4 v[252:255], v2, s[16:19], s59 offen offset:3072 sc1
    s_waitcnt vmcnt(16)
    v_mfma_f32_16x16x32_bf16 v[64:67], v[224:227], v[192:195], v[64:67]
    v_mfma_f32_16x16x32_bf16 v[68:71], v[228:231], v[192:195], v[68:71]
    v_mfma_f32_16x16x32_bf16 v[72:75], v[232:235], v[192:195], v[72:75]
    v_mfma_f32_16x16x32_bf16 v[76:79], v[236:239], v[192:195], v[76:79]
    v_mfma_f32_16x16x32_bf16 v[80:83], v[224:227], v[196:199], v[80:83]
    v_mfma_f32_16x16x32_bf16 v[84:87], v[228:231], v[196:199], v[84:87]
    v_mfma_f32_16x16x32_bf16 v[88:91], v[232:235], v[196:199], v[88:91]
    v_mfma_f32_16x16x32_bf16 v[92:95], v[236:239], v[196:199], v[92:95]
    v_mfma_f32_16x16x32_bf16 v[96:99], v[224:227], v[200:203], v[96:99]
    v_mfma_f32_16x16x32_bf16 v[100:103], v[228:231], v[200:203], v[100:103]
    v_mfma_f32_16x16x32_bf16 v[104:107], v[232:235], v[200:203], v[104:107]
    v_mfma_f32_16x16x32_bf16 v[108:111], v[236:239], v[200:203], v[108:111]
    v_mfma_f32_16x16x32_bf16 v[112:115], v[224:227], v[204:207], v[112:115]
    v_mfma_f32_16x16x32_bf16 v[116:119], v[228:231], v[204:207], v[116:119]
    v_mfma_f32_16x16x32_bf16 v[120:123], v[232:235], v[204:207], v[120:123]
    v_mfma_f32_16x16x32_bf16 v[124:127], v[236:239], v[204:207], v[124:127]
    ds_read_b128 v[192:195], v32 offset:0
    ds_read_b128 v[196:199], v32 offset:1024
    ds_read_b128 v[200:203], v32 offset:2048
    ds_read_b128 v[204:207], v32 offset:3072
    s_add_u32 s56, s56, 8192
    s_add_u32 s57, s57, 8192
    s_add_u32 s58, s58, 8192
    s_add_u32 s59, s59, 8192
    buffer_load_dwordx4 v[224:227], v2, s[16:19], s56 offen offset:0 sc1
    buffer_load_dwordx4 v[228:231], v2, s[16:19], s57 offen offset:0 sc1
    buffer_load_dwordx4 v[232:235], v2, s[16:19], s58 offen offset:0 sc1
    buffer_load_dwordx4 v[236:239], v2, s[16:19], s59 offen offset:0 sc1
    s_waitcnt vmcnt(16)
    v_mfma_f32_16x16x32_bf16 v[64:67], v[208:211], v[160:163], v[64:67]
    v_mfma_f32_16x16x32_bf16 v[68:71], v[212:215], v[160:163], v[68:71]
    v_mfma_f32_16x16x32_bf16 v[72:75], v[216:219], v[160:163], v[72:75]
    v_mfma_f32_16x16x32_bf16 v[76:79], v[220:223], v[160:163], v[76:79]
    v_mfma_f32_16x16x32_bf16 v[80:83], v[208:211], v[164:167], v[80:83]
    v_mfma_f32_16x16x32_bf16 v[84:87], v[212:215], v[164:167], v[84:87]
    v_mfma_f32_16x16x32_bf16 v[88:91], v[216:219], v[164:167], v[88:91]
    v_mfma_f32_16x16x32_bf16 v[92:95], v[220:223], v[164:167], v[92:95]
    v_mfma_f32_16x16x32_bf16 v[96:99], v[208:211], v[168:171], v[96:99]
    v_mfma_f32_16x16x32_bf16 v[100:103], v[212:215], v[168:171], v[100:103]
    v_mfma_f32_16x16x32_bf16 v[104:107], v[216:219], v[168:171], v[104:107]
    v_mfma_f32_16x16x32_bf16 v[108:111], v[220:223], v[168:171], v[108:111]
    v_mfma_f32_16x16x32_bf16 v[112:115], v[208:211], v[172:175], v[112:115]
    v_mfma_f32_16x16x32_bf16 v[116:119], v[212:215], v[172:175], v[116:119]
    v_mfma_f32_16x16x32_bf16 v[120:123], v[216:219], v[172:175], v[120:123]
    v_mfma_f32_16x16x32_bf16 v[124:127], v[220:223], v[172:175], v[124:127]
    ds_read_b128 v[160:163], v33 offset:0
    ds_read_b128 v[164:167], v33 offset:1024
    ds_read_b128 v[168:171], v33 offset:2048
    ds_read_b128 v[172:175], v33 offset:3072
    buffer_load_dwordx4 v[208:211], v2, s[16:19], s56 offen offset:1024 sc1
    buffer_load_dwordx4 v[212:215], v2, s[16:19], s57 offen offset:1024 sc1
    buffer_load_dwordx4 v[216:219], v2, s[16:19], s58 offen offset:1024 sc1
    buffer_load_dwordx4 v[220:223], v2, s[16:19], s59 offen offset:1024 sc1
    s_waitcnt vmcnt(16) lgkmcnt(8)
    v_mfma_f32_16x16x32_bf16 v[64:67], v[128:131], v[144:147], v[64:67]
    v_mfma_f32_16x16x32_bf16 v[68:71], v[132:135], v[144:147], v[68:71]
    v_mfma_f32_16x16x32_bf16 v[72:75], v[136:139], v[144:147], v[72:75]
    v_mfma_f32_16x16x32_bf16 v[76:79], v[140:143], v[144:147], v[76:79]
    v_mfma_f32_16x16x32_bf16 v[80:83], v[128:131], v[148:151], v[80:83]
    v_mfma_f32_16x16x32_bf16 v[84:87], v[132:135], v[148:151], v[84:87]
    v_mfma_f32_16x16x32_bf16 v[88:91], v[136:139], v[148:151], v[88:91]
    v_mfma_f32_16x16x32_bf16 v[92:95], v[140:143], v[148:151], v[92:95]
    v_mfma_f32_16x16x32_bf16 v[96:99], v[128:131], v[152:155], v[96:99]
    v_mfma_f32_16x16x32_bf16 v[100:103], v[132:135], v[152:155], v[100:103]
    v_mfma_f32_16x16x32_bf16 v[104:107], v[136:139], v[152:155], v[104:107]
    v_mfma_f32_16x16x32_bf16 v[108:111], v[140:143], v[152:155], v[108:111]
    v_mfma_f32_16x16x32_bf16 v[112:115], v[128:131], v[156:159], v[112:115]
    v_mfma_f32_16x16x32_bf16 v[116:119], v[132:135], v[156:159], v[116:119]
    v_mfma_f32_16x16x32_bf16 v[120:123], v[136:139], v[156:159], v[120:123]
    v_mfma_f32_16x16x32_bf16 v[124:127], v[140:143], v[156:159], v[124:127]
    ds_read_b128 v[144:147], v33 offset:4096
    ds_read_b128 v[148:151], v33 offset:5120
    ds_read_b128 v[152:155], v33 offset:6144
    ds_read_b128 v[156:159], v33 offset:7168
    buffer_load_dwordx4 v[128:131], v2, s[16:19], s56 offen offset:2048 sc1
    buffer_load_dwordx4 v[132:135], v2, s[16:19], s57 offen offset:2048 sc1
    buffer_load_dwordx4 v[136:139], v2, s[16:19], s58 offen offset:2048 sc1
    buffer_load_dwordx4 v[140:143], v2, s[16:19], s59 offen offset:2048 sc1
    s_waitcnt vmcnt(16) lgkmcnt(8)
    v_mfma_f32_16x16x32_bf16 v[64:67], v[192:195], v[176:179], v[64:67]
    v_mfma_f32_16x16x32_bf16 v[68:71], v[196:199], v[176:179], v[68:71]
    v_mfma_f32_16x16x32_bf16 v[72:75], v[200:203], v[176:179], v[72:75]
    v_mfma_f32_16x16x32_bf16 v[76:79], v[204:207], v[176:179], v[76:79]
    v_mfma_f32_16x16x32_bf16 v[80:83], v[192:195], v[180:183], v[80:83]
    v_mfma_f32_16x16x32_bf16 v[84:87], v[196:199], v[180:183], v[84:87]
    v_mfma_f32_16x16x32_bf16 v[88:91], v[200:203], v[180:183], v[88:91]
    v_mfma_f32_16x16x32_bf16 v[92:95], v[204:207], v[180:183], v[92:95]
    v_mfma_f32_16x16x32_bf16 v[96:99], v[192:195], v[184:187], v[96:99]
    v_mfma_f32_16x16x32_bf16 v[100:103], v[196:199], v[184:187], v[100:103]
    v_mfma_f32_16x16x32_bf16 v[104:107], v[200:203], v[184:187], v[104:107]
    v_mfma_f32_16x16x32_bf16 v[108:111], v[204:207], v[184:187], v[108:111]
    v_mfma_f32_16x16x32_bf16 v[112:115], v[192:195], v[188:191], v[112:115]
    v_mfma_f32_16x16x32_bf16 v[116:119], v[196:199], v[188:191], v[116:119]
    v_mfma_f32_16x16x32_bf16 v[120:123], v[200:203], v[188:191], v[120:123]
    v_mfma_f32_16x16x32_bf16 v[124:127], v[204:207], v[188:191], v[124:127]
    ds_read_b128 v[176:179], v32 offset:49152
    ds_read_b128 v[180:183], v32 offset:50176
    ds_read_b128 v[184:187], v32 offset:51200
    ds_read_b128 v[188:191], v32 offset:52224
    buffer_load_dwordx4 v[192:195], v2, s[16:19], s56 offen offset:3072 sc1
    buffer_load_dwordx4 v[196:199], v2, s[16:19], s57 offen offset:3072 sc1
    buffer_load_dwordx4 v[200:203], v2, s[16:19], s58 offen offset:3072 sc1
    buffer_load_dwordx4 v[204:207], v2, s[16:19], s59 offen offset:3072 sc1
    s_waitcnt vmcnt(16) lgkmcnt(8)
    v_mfma_f32_16x16x32_bf16 v[64:67], v[160:163], v[240:243], v[64:67]
    v_mfma_f32_16x16x32_bf16 v[68:71], v[164:167], v[240:243], v[68:71]
    v_mfma_f32_16x16x32_bf16 v[72:75], v[168:171], v[240:243], v[72:75]
    v_mfma_f32_16x16x32_bf16 v[76:79], v[172:175], v[240:243], v[76:79]
    v_mfma_f32_16x16x32_bf16 v[80:83], v[160:163], v[244:247], v[80:83]
    v_mfma_f32_16x16x32_bf16 v[84:87], v[164:167], v[244:247], v[84:87]
    v_mfma_f32_16x16x32_bf16 v[88:91], v[168:171], v[244:247], v[88:91]
    v_mfma_f32_16x16x32_bf16 v[92:95], v[172:175], v[244:247], v[92:95]
    v_mfma_f32_16x16x32_bf16 v[96:99], v[160:163], v[248:251], v[96:99]
    v_mfma_f32_16x16x32_bf16 v[100:103], v[164:167], v[248:251], v[100:103]
    v_mfma_f32_16x16x32_bf16 v[104:107], v[168:171], v[248:251], v[104:107]
    v_mfma_f32_16x16x32_bf16 v[108:111], v[172:175], v[248:251], v[108:111]
    v_mfma_f32_16x16x32_bf16 v[112:115], v[160:163], v[252:255], v[112:115]
    v_mfma_f32_16x16x32_bf16 v[116:119], v[164:167], v[252:255], v[116:119]
    v_mfma_f32_16x16x32_bf16 v[120:123], v[168:171], v[252:255], v[120:123]
    v_mfma_f32_16x16x32_bf16 v[124:127], v[172:175], v[252:255], v[124:127]
    s_add_u32 s73, s72, 40960
    buffer_load_dwordx4 v[240:243], v2, s[36:39], s73 offen offset:0 sc1
    buffer_load_dwordx4 v[244:247], v2, s[36:39], s73 offen offset:1024 sc1
    buffer_load_dwordx4 v[248:251], v2, s[36:39], s73 offen offset:2048 sc1
    buffer_load_dwordx4 v[252:255], v2, s[36:39], s73 offen offset:3072 sc1
    s_add_u32 s56, s56, 8192
    s_add_u32 s57, s57, 8192
    s_add_u32 s58, s58, 8192
    s_add_u32 s59, s59, 8192
    buffer_load_dwordx4 v[160:163], v2, s[16:19], s56 offen offset:0 sc1
    buffer_load_dwordx4 v[164:167], v2, s[16:19], s57 offen offset:0 sc1
    buffer_load_dwordx4 v[168:171], v2, s[16:19], s58 offen offset:0 sc1
    buffer_load_dwordx4 v[172:175], v2, s[16:19], s59 offen offset:0 sc1
    s_waitcnt vmcnt(20) lgkmcnt(4)
    v_mfma_f32_16x16x32_bf16 v[64:67], v[144:147], v[224:227], v[64:67]
    v_mfma_f32_16x16x32_bf16 v[68:71], v[148:151], v[224:227], v[68:71]
    v_mfma_f32_16x16x32_bf16 v[72:75], v[152:155], v[224:227], v[72:75]
    v_mfma_f32_16x16x32_bf16 v[76:79], v[156:159], v[224:227], v[76:79]
    v_mfma_f32_16x16x32_bf16 v[80:83], v[144:147], v[228:231], v[80:83]
    v_mfma_f32_16x16x32_bf16 v[84:87], v[148:151], v[228:231], v[84:87]
    v_mfma_f32_16x16x32_bf16 v[88:91], v[152:155], v[228:231], v[88:91]
    v_mfma_f32_16x16x32_bf16 v[92:95], v[156:159], v[228:231], v[92:95]
    v_mfma_f32_16x16x32_bf16 v[96:99], v[144:147], v[232:235], v[96:99]
    v_mfma_f32_16x16x32_bf16 v[100:103], v[148:151], v[232:235], v[100:103]
    v_mfma_f32_16x16x32_bf16 v[104:107], v[152:155], v[232:235], v[104:107]
    v_mfma_f32_16x16x32_bf16 v[108:111], v[156:159], v[232:235], v[108:111]
    v_mfma_f32_16x16x32_bf16 v[112:115], v[144:147], v[236:239], v[112:115]
    v_mfma_f32_16x16x32_bf16 v[116:119], v[148:151], v[236:239], v[116:119]
    v_mfma_f32_16x16x32_bf16 v[120:123], v[152:155], v[236:239], v[120:123]
    v_mfma_f32_16x16x32_bf16 v[124:127], v[156:159], v[236:239], v[124:127]
    s_add_u32 s73, s72, 45056
    buffer_load_dwordx4 v[224:227], v2, s[36:39], s73 offen offset:0 sc1
    buffer_load_dwordx4 v[228:231], v2, s[36:39], s73 offen offset:1024 sc1
    buffer_load_dwordx4 v[232:235], v2, s[36:39], s73 offen offset:2048 sc1
    buffer_load_dwordx4 v[236:239], v2, s[36:39], s73 offen offset:3072 sc1
    buffer_load_dwordx4 v[144:147], v2, s[16:19], s56 offen offset:1024 sc1
    buffer_load_dwordx4 v[148:151], v2, s[16:19], s57 offen offset:1024 sc1
    buffer_load_dwordx4 v[152:155], v2, s[16:19], s58 offen offset:1024 sc1
    buffer_load_dwordx4 v[156:159], v2, s[16:19], s59 offen offset:1024 sc1
    s_waitcnt vmcnt(24) lgkmcnt(0)
    v_mfma_f32_16x16x32_bf16 v[64:67], v[176:179], v[208:211], v[64:67]
    v_mfma_f32_16x16x32_bf16 v[68:71], v[180:183], v[208:211], v[68:71]
    v_mfma_f32_16x16x32_bf16 v[72:75], v[184:187], v[208:211], v[72:75]
    v_mfma_f32_16x16x32_bf16 v[76:79], v[188:191], v[208:211], v[76:79]
    v_mfma_f32_16x16x32_bf16 v[80:83], v[176:179], v[212:215], v[80:83]
    v_mfma_f32_16x16x32_bf16 v[84:87], v[180:183], v[212:215], v[84:87]
    v_mfma_f32_16x16x32_bf16 v[88:91], v[184:187], v[212:215], v[88:91]
    v_mfma_f32_16x16x32_bf16 v[92:95], v[188:191], v[212:215], v[92:95]
    v_mfma_f32_16x16x32_bf16 v[96:99], v[176:179], v[216:219], v[96:99]
    v_mfma_f32_16x16x32_bf16 v[100:103], v[180:183], v[216:219], v[100:103]
    v_mfma_f32_16x16x32_bf16 v[104:107], v[184:187], v[216:219], v[104:107]
    v_mfma_f32_16x16x32_bf16 v[108:111], v[188:191], v[216:219], v[108:111]
    v_mfma_f32_16x16x32_bf16 v[112:115], v[176:179], v[220:223], v[112:115]
    v_mfma_f32_16x16x32_bf16 v[116:119], v[180:183], v[220:223], v[116:119]
    v_mfma_f32_16x16x32_bf16 v[120:123], v[184:187], v[220:223], v[120:123]
    v_mfma_f32_16x16x32_bf16 v[124:127], v[188:191], v[220:223], v[124:127]
    s_add_u32 s73, s72, 49152
    buffer_load_dwordx4 v[208:211], v2, s[36:39], s73 offen offset:0 sc1
    buffer_load_dwordx4 v[212:215], v2, s[36:39], s73 offen offset:1024 sc1
    buffer_load_dwordx4 v[216:219], v2, s[36:39], s73 offen offset:2048 sc1
    buffer_load_dwordx4 v[220:223], v2, s[36:39], s73 offen offset:3072 sc1
    buffer_load_dwordx4 v[176:179], v2, s[16:19], s56 offen offset:2048 sc1
    buffer_load_dwordx4 v[180:183], v2, s[16:19], s57 offen offset:2048 sc1
    buffer_load_dwordx4 v[184:187], v2, s[16:19], s58 offen offset:2048 sc1
    buffer_load_dwordx4 v[188:191], v2, s[16:19], s59 offen offset:2048 sc1
    s_waitcnt vmcnt(20)
    v_mfma_f32_16x16x32_bf16 v[64:67], v[240:243], v[128:131], v[64:67]
    v_mfma_f32_16x16x32_bf16 v[68:71], v[244:247], v[128:131], v[68:71]
    v_mfma_f32_16x16x32_bf16 v[72:75], v[248:251], v[128:131], v[72:75]
    v_mfma_f32_16x16x32_bf16 v[76:79], v[252:255], v[128:131], v[76:79]
    v_mfma_f32_16x16x32_bf16 v[80:83], v[240:243], v[132:135], v[80:83]
    v_mfma_f32_16x16x32_bf16 v[84:87], v[244:247], v[132:135], v[84:87]
    v_mfma_f32_16x16x32_bf16 v[88:91], v[248:251], v[132:135], v[88:91]
    v_mfma_f32_16x16x32_bf16 v[92:95], v[252:255], v[132:135], v[92:95]
    v_mfma_f32_16x16x32_bf16 v[96:99], v[240:243], v[136:139], v[96:99]
    v_mfma_f32_16x16x32_bf16 v[100:103], v[244:247], v[136:139], v[100:103]
    v_mfma_f32_16x16x32_bf16 v[104:107], v[248:251], v[136:139], v[104:107]
    v_mfma_f32_16x16x32_bf16 v[108:111], v[252:255], v[136:139], v[108:111]
    v_mfma_f32_16x16x32_bf16 v[112:115], v[240:243], v[140:143], v[112:115]
    v_mfma_f32_16x16x32_bf16 v[116:119], v[244:247], v[140:143], v[116:119]
    v_mfma_f32_16x16x32_bf16 v[120:123], v[248:251], v[140:143], v[120:123]
    v_mfma_f32_16x16x32_bf16 v[124:127], v[252:255], v[140:143], v[124:127]
    s_add_u32 s73, s72, 53248
    buffer_load_dwordx4 v[128:131], v2, s[36:39], s73 offen offset:0 sc1
    buffer_load_dwordx4 v[132:135], v2, s[36:39], s73 offen offset:1024 sc1
    buffer_load_dwordx4 v[136:139], v2, s[36:39], s73 offen offset:2048 sc1
    buffer_load_dwordx4 v[140:143], v2, s[36:39], s73 offen offset:3072 sc1
    buffer_load_dwordx4 v[240:243], v2, s[16:19], s56 offen offset:3072 sc1
    buffer_load_dwordx4 v[244:247], v2, s[16:19], s57 offen offset:3072 sc1
    buffer_load_dwordx4 v[248:251], v2, s[16:19], s58 offen offset:3072 sc1
    buffer_load_dwordx4 v[252:255], v2, s[16:19], s59 offen offset:3072 sc1
    s_waitcnt lgkmcnt(0)
    s_barrier
    ds_write_b64 v40, v[16:17] offset:0
    ds_write_b64 v40, v[20:21] offset:2048
    s_waitcnt vmcnt(20)
    v_mfma_f32_16x16x32_bf16 v[64:67], v[224:227], v[192:195], v[64:67]
    v_mfma_f32_16x16x32_bf16 v[68:71], v[228:231], v[192:195], v[68:71]
    v_mfma_f32_16x16x32_bf16 v[72:75], v[232:235], v[192:195], v[72:75]
    v_mfma_f32_16x16x32_bf16 v[76:79], v[236:239], v[192:195], v[76:79]
    v_mfma_f32_16x16x32_bf16 v[80:83], v[224:227], v[196:199], v[80:83]
    v_mfma_f32_16x16x32_bf16 v[84:87], v[228:231], v[196:199], v[84:87]
    v_mfma_f32_16x16x32_bf16 v[88:91], v[232:235], v[196:199], v[88:91]
    v_mfma_f32_16x16x32_bf16 v[92:95], v[236:239], v[196:199], v[92:95]
    v_mfma_f32_16x16x32_bf16 v[96:99], v[224:227], v[200:203], v[96:99]
    v_mfma_f32_16x16x32_bf16 v[100:103], v[228:231], v[200:203], v[100:103]
    v_mfma_f32_16x16x32_bf16 v[104:107], v[232:235], v[200:203], v[104:107]
    v_mfma_f32_16x16x32_bf16 v[108:111], v[236:239], v[200:203], v[108:111]
    v_mfma_f32_16x16x32_bf16 v[112:115], v[224:227], v[204:207], v[112:115]
    v_mfma_f32_16x16x32_bf16 v[116:119], v[228:231], v[204:207], v[116:119]
    v_mfma_f32_16x16x32_bf16 v[120:123], v[232:235], v[204:207], v[120:123]
    v_mfma_f32_16x16x32_bf16 v[124:127], v[236:239], v[204:207], v[124:127]
    s_add_u32 s73, s72, 57344
    buffer_load_dwordx4 v[192:195], v2, s[36:39], s73 offen offset:0 sc1
    buffer_load_dwordx4 v[196:199], v2, s[36:39], s73 offen offset:1024 sc1
    buffer_load_dwordx4 v[200:203], v2, s[36:39], s73 offen offset:2048 sc1
    buffer_load_dwordx4 v[204:207], v2, s[36:39], s73 offen offset:3072 sc1
    s_waitcnt vmcnt(16)
    v_mfma_f32_16x16x32_bf16 v[64:67], v[208:211], v[160:163], v[64:67]
    v_mfma_f32_16x16x32_bf16 v[68:71], v[212:215], v[160:163], v[68:71]
    v_mfma_f32_16x16x32_bf16 v[72:75], v[216:219], v[160:163], v[72:75]
    v_mfma_f32_16x16x32_bf16 v[76:79], v[220:223], v[160:163], v[76:79]
    v_mfma_f32_16x16x32_bf16 v[80:83], v[208:211], v[164:167], v[80:83]
    v_mfma_f32_16x16x32_bf16 v[84:87], v[212:215], v[164:167], v[84:87]
    v_mfma_f32_16x16x32_bf16 v[88:91], v[216:219], v[164:167], v[88:91]
    v_mfma_f32_16x16x32_bf16 v[92:95], v[220:223], v[164:167], v[92:95]
    v_mfma_f32_16x16x32_bf16 v[96:99], v[208:211], v[168:171], v[96:99]
    v_mfma_f32_16x16x32_bf16 v[100:103], v[212:215], v[168:171], v[100:103]
    v_mfma_f32_16x16x32_bf16 v[104:107], v[216:219], v[168:171], v[104:107]
    v_mfma_f32_16x16x32_bf16 v[108:111], v[220:223], v[168:171], v[108:111]
    v_mfma_f32_16x16x32_bf16 v[112:115], v[208:211], v[172:175], v[112:115]
    v_mfma_f32_16x16x32_bf16 v[116:119], v[212:215], v[172:175], v[116:119]
    v_mfma_f32_16x16x32_bf16 v[120:123], v[216:219], v[172:175], v[120:123]
    v_mfma_f32_16x16x32_bf16 v[124:127], v[220:223], v[172:175], v[124:127]
    s_add_u32 s73, s72, 61440
    buffer_load_dwordx4 v[160:163], v2, s[36:39], s73 offen offset:0 sc1
    buffer_load_dwordx4 v[164:167], v2, s[36:39], s73 offen offset:1024 sc1
    buffer_load_dwordx4 v[168:171], v2, s[36:39], s73 offen offset:2048 sc1
    buffer_load_dwordx4 v[172:175], v2, s[36:39], s73 offen offset:3072 sc1
    s_waitcnt vmcnt(12)
    v_mfma_f32_16x16x32_bf16 v[64:67], v[128:131], v[144:147], v[64:67]
    v_mfma_f32_16x16x32_bf16 v[68:71], v[132:135], v[144:147], v[68:71]
    v_mfma_f32_16x16x32_bf16 v[72:75], v[136:139], v[144:147], v[72:75]
    v_mfma_f32_16x16x32_bf16 v[76:79], v[140:143], v[144:147], v[76:79]
    v_mfma_f32_16x16x32_bf16 v[80:83], v[128:131], v[148:151], v[80:83]
    v_mfma_f32_16x16x32_bf16 v[84:87], v[132:135], v[148:151], v[84:87]
    v_mfma_f32_16x16x32_bf16 v[88:91], v[136:139], v[148:151], v[88:91]
    v_mfma_f32_16x16x32_bf16 v[92:95], v[140:143], v[148:151], v[92:95]
    v_mfma_f32_16x16x32_bf16 v[96:99], v[128:131], v[152:155], v[96:99]
    v_mfma_f32_16x16x32_bf16 v[100:103], v[132:135], v[152:155], v[100:103]
    v_mfma_f32_16x16x32_bf16 v[104:107], v[136:139], v[152:155], v[104:107]
    v_mfma_f32_16x16x32_bf16 v[108:111], v[140:143], v[152:155], v[108:111]
    v_mfma_f32_16x16x32_bf16 v[112:115], v[128:131], v[156:159], v[112:115]
    v_mfma_f32_16x16x32_bf16 v[116:119], v[132:135], v[156:159], v[116:119]
    v_mfma_f32_16x16x32_bf16 v[120:123], v[136:139], v[156:159], v[120:123]
    v_mfma_f32_16x16x32_bf16 v[124:127], v[140:143], v[156:159], v[124:127]
    s_waitcnt vmcnt(4)
    v_mfma_f32_16x16x32_bf16 v[64:67], v[192:195], v[176:179], v[64:67]
    v_mfma_f32_16x16x32_bf16 v[68:71], v[196:199], v[176:179], v[68:71]
    v_mfma_f32_16x16x32_bf16 v[72:75], v[200:203], v[176:179], v[72:75]
    v_mfma_f32_16x16x32_bf16 v[76:79], v[204:207], v[176:179], v[76:79]
    v_mfma_f32_16x16x32_bf16 v[80:83], v[192:195], v[180:183], v[80:83]
    v_mfma_f32_16x16x32_bf16 v[84:87], v[196:199], v[180:183], v[84:87]
    v_mfma_f32_16x16x32_bf16 v[88:91], v[200:203], v[180:183], v[88:91]
    v_mfma_f32_16x16x32_bf16 v[92:95], v[204:207], v[180:183], v[92:95]
    v_mfma_f32_16x16x32_bf16 v[96:99], v[192:195], v[184:187], v[96:99]
    v_mfma_f32_16x16x32_bf16 v[100:103], v[196:199], v[184:187], v[100:103]
    v_mfma_f32_16x16x32_bf16 v[104:107], v[200:203], v[184:187], v[104:107]
    v_mfma_f32_16x16x32_bf16 v[108:111], v[204:207], v[184:187], v[108:111]
    v_mfma_f32_16x16x32_bf16 v[112:115], v[192:195], v[188:191], v[112:115]
    v_mfma_f32_16x16x32_bf16 v[116:119], v[196:199], v[188:191], v[116:119]
    v_mfma_f32_16x16x32_bf16 v[120:123], v[200:203], v[188:191], v[120:123]
    v_mfma_f32_16x16x32_bf16 v[124:127], v[204:207], v[188:191], v[124:127]
    s_waitcnt vmcnt(0)
    v_mfma_f32_16x16x32_bf16 v[64:67], v[160:163], v[240:243], v[64:67]
    v_mfma_f32_16x16x32_bf16 v[68:71], v[164:167], v[240:243], v[68:71]
    v_mfma_f32_16x16x32_bf16 v[72:75], v[168:171], v[240:243], v[72:75]
    v_mfma_f32_16x16x32_bf16 v[76:79], v[172:175], v[240:243], v[76:79]
    v_mfma_f32_16x16x32_bf16 v[80:83], v[160:163], v[244:247], v[80:83]
    v_mfma_f32_16x16x32_bf16 v[84:87], v[164:167], v[244:247], v[84:87]
    v_mfma_f32_16x16x32_bf16 v[88:91], v[168:171], v[244:247], v[88:91]
    v_mfma_f32_16x16x32_bf16 v[92:95], v[172:175], v[244:247], v[92:95]
    v_mfma_f32_16x16x32_bf16 v[96:99], v[160:163], v[248:251], v[96:99]
    v_mfma_f32_16x16x32_bf16 v[100:103], v[164:167], v[248:251], v[100:103]
    v_mfma_f32_16x16x32_bf16 v[104:107], v[168:171], v[248:251], v[104:107]
    v_mfma_f32_16x16x32_bf16 v[108:111], v[172:175], v[248:251], v[108:111]
    v_mfma_f32_16x16x32_bf16 v[112:115], v[160:163], v[252:255], v[112:115]
    v_mfma_f32_16x16x32_bf16 v[116:119], v[164:167], v[252:255], v[116:119]
    v_mfma_f32_16x16x32_bf16 v[120:123], v[168:171], v[252:255], v[120:123]
    v_mfma_f32_16x16x32_bf16 v[124:127], v[172:175], v[252:255], v[124:127]
    v_and_b32 v4, 15, v1
    v_lshrrev_b32 v3, 4, v1
    v_and_b32 v5, 7, v1
    v_xor_b32 v3, v3, v5
    s_lshl_b32 s14, s3, 14
    v_lshlrev_b32 v4, 8, v4
    v_add_u32 v8, s14, v4
    v_lshl_add_u32 v4, v3, 4, v8
    v_xor_b32 v5, 64, v4
    ds_write_b128 v4, v[64:67] offset:0
    ds_write_b128 v5, v[68:71] offset:0
    ds_write_b128 v4, v[72:75] offset:128
    ds_write_b128 v5, v[76:79] offset:128
    ds_write_b128 v4, v[80:83] offset:4096
    ds_write_b128 v5, v[84:87] offset:4096
    ds_write_b128 v4, v[88:91] offset:4224
    ds_write_b128 v5, v[92:95] offset:4224
    ds_write_b128 v4, v[96:99] offset:8192
    ds_write_b128 v5, v[100:103] offset:8192
    ds_write_b128 v4, v[104:107] offset:8320
    ds_write_b128 v5, v[108:111] offset:8320
    ds_write_b128 v4, v[112:115] offset:12288
    s_waitcnt lgkmcnt(9)
    ds_write_b128 v5, v[116:119] offset:12288
    ds_write_b128 v4, v[120:123] offset:12416
    ds_write_b128 v5, v[124:127] offset:12416
    s_lshl_b32 s14, s3, 6
    v_add_u32 v0, s14, v1
    s_waitcnt lgkmcnt(0)
    s_barrier
    v_lshrrev_b32 v8, 3, v0
    v_and_b32 v3, 7, v0
    v_lshlrev_b32 v4, 1, v3
    v_and_b32 v5, 7, v8
    v_xor_b32 v4, v4, v5
    v_lshlrev_b32 v4, 4, v4
    v_lshl_add_u32 v4, v8, 8, v4
    v_xor_b32 v5, 16, v4
    v_add_u32 v6, 0x10000, v4
    v_add_u32 v7, 0x10000, v5
    v_lshlrev_b32 v10, 4, v0
    v_add_u32 v10, 0x20000, v10
    ds_read_b128 v[12:15], v10
    ds_read_b128 v[128:131], v4 offset:0
    ds_read_b128 v[132:135], v5 offset:0
    ds_read_b128 v[136:139], v4 offset:16384
    ds_read_b128 v[140:143], v5 offset:16384
    ds_read_b128 v[144:147], v4 offset:32768
    ds_read_b128 v[148:151], v5 offset:32768
    ds_read_b128 v[152:155], v4 offset:49152
    ds_read_b128 v[156:159], v5 offset:49152
    ds_read_b128 v[160:163], v6 offset:0
    ds_read_b128 v[164:167], v7 offset:0
    ds_read_b128 v[168:171], v6 offset:16384
    ds_read_b128 v[172:175], v7 offset:16384
    ds_read_b128 v[176:179], v6 offset:32768
    ds_read_b128 v[180:183], v7 offset:32768
    s_waitcnt lgkmcnt(9)
    ds_read_b128 v[184:187], v6 offset:49152
    ds_read_b128 v[188:191], v7 offset:49152
    v_lshlrev_b32 v8, 11, v8
    v_lshl_add_u32 v8, v3, 4, v8
    s_lshl_b32 s14, s4, 17
    s_lshl_b32 s15, s5, 7
    s_add_u32 s14, s14, s15
    v_bfe_u32 v10, v0, 5, 1
    v_lshrrev_b32 v11, 6, v0
    v_lshl_add_u32 v10, v10, 4, v11
    v_lshlrev_b32 v10, 6, v10
    v_bfe_u32 v11, v0, 3, 2
    v_add_u32 v10, v10, v11
    v_lshlrev_b32 v10, 11, v10
    v_lshl_add_u32 v10, v3, 4, v10
    s_waitcnt lgkmcnt(8)
    buffer_store_dwordx4 v[12:15], v10, s[52:55], s62 offen sc1
    v_add_f32 v128, v128, v136
    v_add_f32 v129, v129, v137
    v_add_f32 v130, v130, v138
    v_add_f32 v131, v131, v139
    v_add_f32 v132, v132, v140
    v_add_f32 v133, v133, v141
    v_add_f32 v134, v134, v142
    v_add_f32 v135, v135, v143
    v_add_f32 v128, v128, v144
    v_add_f32 v129, v129, v145
    v_add_f32 v130, v130, v146
    v_add_f32 v131, v131, v147
    v_add_f32 v132, v132, v148
    v_add_f32 v133, v133, v149
    v_add_f32 v134, v134, v150
    v_add_f32 v135, v135, v151
    v_add_f32 v128, v128, v152
    v_add_f32 v129, v129, v153
    v_add_f32 v130, v130, v154
    v_add_f32 v131, v131, v155
    v_add_f32 v132, v132, v156
    v_add_f32 v133, v133, v157
    v_add_f32 v134, v134, v158
    v_add_f32 v135, v135, v159
    s_waitcnt lgkmcnt(0)
    v_add_f32 v128, v128, v160
    v_add_f32 v129, v129, v161
    v_add_f32 v130, v130, v162
    v_add_f32 v131, v131, v163
    v_add_f32 v132, v132, v164
    v_add_f32 v133, v133, v165
    v_add_f32 v134, v134, v166
    v_add_f32 v135, v135, v167
    v_add_f32 v128, v128, v168
    v_add_f32 v129, v129, v169
    v_add_f32 v130, v130, v170
    v_add_f32 v131, v131, v171
    v_add_f32 v132, v132, v172
    v_add_f32 v133, v133, v173
    v_add_f32 v134, v134, v174
    v_add_f32 v135, v135, v175
    v_add_f32 v128, v128, v176
    v_add_f32 v129, v129, v177
    v_add_f32 v130, v130, v178
    v_add_f32 v131, v131, v179
    v_add_f32 v132, v132, v180
    v_add_f32 v133, v133, v181
    v_add_f32 v134, v134, v182
    v_add_f32 v135, v135, v183
    v_add_f32 v128, v128, v184
    v_add_f32 v129, v129, v185
    v_add_f32 v130, v130, v186
    v_add_f32 v131, v131, v187
    v_add_f32 v132, v132, v188
    v_add_f32 v133, v133, v189
    v_add_f32 v134, v134, v190
    v_add_f32 v135, v135, v191
    v_cvt_pk_bf16_f32 v128, v128, v129
    v_cvt_pk_bf16_f32 v129, v130, v131
    v_cvt_pk_bf16_f32 v130, v132, v133
    v_cvt_pk_bf16_f32 v131, v134, v135
    buffer_store_dwordx4 v[128:131], v8, s[52:55], s14 offen sc1
    s_cmp_eq_u32 s2, 0
    s_cselect_b32 s14, s7, 0x40000000
    v_mov_b32 v9, s6
    buffer_store_dword v9, off, s[8:11], s14 sc1
concat_end:
    s_endpgm
concat_pslow_6:
    s_mov_b32 s15, 4096
    s_mov_b32 s35, 0x100000
concat_poll_69:
    buffer_load_dwordx2 v[252:253], v248, s[8:11], s15 offen offset:0 sc1
    buffer_load_dwordx2 v[254:255], v248, s[8:11], s15 offen offset:512 sc1
    buffer_load_dwordx2 v[14:15], v248, s[8:11], s15 offen offset:1024 sc1
    buffer_load_dwordx2 v[12:13], v248, s[8:11], s15 offen offset:1536 sc1
    s_waitcnt vmcnt(0)
    v_xor_b32 v252, s6, v252
    v_xor_b32 v253, s6, v253
    v_xor_b32 v254, s6, v254
    v_xor_b32 v255, s6, v255
    v_xor_b32 v14, s6, v14
    v_xor_b32 v15, s6, v15
    v_xor_b32 v12, s6, v12
    v_xor_b32 v13, s6, v13
    v_or_b32 v252, v252, v253
    v_or_b32 v252, v252, v255
    v_or_b32 v252, v252, v254
    v_or_b32 v252, v252, v15
    v_or_b32 v252, v252, v14
    v_or_b32 v252, v252, v13
    v_or_b32 v252, v252, v12
    v_cmp_ne_u32 vcc, 0, v252
    s_nop 0
    s_cbranch_vccz concat_pdone_70
    s_sleep 1
    s_sub_u32 s35, s35, 1
    s_cbranch_scc0 concat_poll_69
concat_pdone_70:
    s_branch concat_pback_7
concat_pslow_8:
    s_mov_b32 s35, 0x100000
concat_poll_71:
    buffer_load_dwordx2 v[6:7], v11, s[8:11], s74 offen offset:0 sc1
    s_waitcnt vmcnt(0)
    v_xor_b32 v6, s6, v6
    v_xor_b32 v7, s6, v7
    v_or_b32 v6, v6, v7
    v_cmp_ne_u32 vcc, 0, v6
    s_nop 0
    s_cbranch_vccz concat_pdone_72
    s_sleep 1
    s_sub_u32 s35, s35, 1
    s_cbranch_scc0 concat_poll_71
concat_pdone_72:
    s_branch concat_pback_9
concat_pslow_29:
    s_mov_b32 s35, 0x100000
concat_poll_73:
    buffer_load_dwordx2 v[6:7], v11, s[8:11], s74 offen offset:0 sc1
    s_waitcnt vmcnt(0)
    v_xor_b32 v6, s6, v6
    v_xor_b32 v7, s6, v7
    v_or_b32 v6, v6, v7
    v_cmp_ne_u32 vcc, 0, v6
    s_nop 0
    s_cbranch_vccz concat_pdone_74
    s_sleep 1
    s_sub_u32 s35, s35, 1
    s_cbranch_scc0 concat_poll_73
concat_pdone_74:
    s_branch concat_pback_30
concat_rare_51:
    s_nop 15
    v_max3_f32 v14, v128, v129, v130
    v_max3_f32 v15, v136, v137, v138
    v_max3_f32 v14, v14, v131, v132
    v_max3_f32 v15, v15, v139, v140
    v_max3_f32 v14, v14, v133, v134
    v_max3_f32 v15, v15, v141, v142
    v_max3_f32 v14, v14, v135, v144
    v_max3_f32 v15, v15, v143, v152
    v_max3_f32 v14, v14, v145, v146
    v_max3_f32 v15, v15, v153, v154
    v_max3_f32 v14, v14, v147, v148
    v_max3_f32 v15, v15, v155, v156
    v_max3_f32 v14, v14, v149, v150
    v_max3_f32 v15, v15, v157, v158
    v_max_f32 v14, v14, v151
    v_max_f32 v15, v15, v159
    v_mov_b32 v10, v14
    v_mov_b32 v11, v15
    s_nop 0
    v_permlane16_swap_b32 v14, v10
    v_permlane16_swap_b32 v15, v11
    v_max_f32 v14, v14, v10
    v_max_f32 v15, v15, v11
    v_mov_b32 v10, v14
    v_mov_b32 v11, v15
    s_nop 0
    v_permlane32_swap_b32 v14, v10
    v_permlane32_swap_b32 v15, v11
    v_max_f32 v14, v14, v10
    v_max_f32 v15, v15, v11
    v_max_f32 v6, 0, v14
    v_max_f32 v7, 0, v15
    v_exp_f32 v8, -v6
    v_exp_f32 v9, -v7
    v_mul_f32 v64, v64, v8
    v_mul_f32 v65, v65, v8
    v_mul_f32 v66, v66, v8
    v_mul_f32 v67, v67, v8
    v_mul_f32 v68, v68, v8
    v_mul_f32 v69, v69, v8
    v_mul_f32 v70, v70, v8
    v_mul_f32 v71, v71, v8
    v_mul_f32 v72, v72, v8
    v_mul_f32 v73, v73, v8
    v_mul_f32 v74, v74, v8
    v_mul_f32 v75, v75, v8
    v_mul_f32 v76, v76, v8
    v_mul_f32 v77, v77, v8
    v_mul_f32 v78, v78, v8
    v_mul_f32 v79, v79, v8
    v_mul_f32 v80, v80, v8
    v_mul_f32 v81, v81, v8
    v_mul_f32 v82, v82, v8
    v_mul_f32 v83, v83, v8
    v_mul_f32 v84, v84, v8
    v_mul_f32 v85, v85, v8
    v_mul_f32 v86, v86, v8
    v_mul_f32 v87, v87, v8
    v_mul_f32 v88, v88, v8
    v_mul_f32 v89, v89, v8
    v_mul_f32 v90, v90, v8
    v_mul_f32 v91, v91, v8
    v_mul_f32 v92, v92, v8
    v_mul_f32 v93, v93, v8
    v_mul_f32 v94, v94, v8
    v_mul_f32 v95, v95, v8
    v_mul_f32 v24, v24, v8
    v_sub_f32 v128, v128, v6
    v_sub_f32 v129, v129, v6
    v_sub_f32 v130, v130, v6
    v_sub_f32 v131, v131, v6
    v_sub_f32 v132, v132, v6
    v_sub_f32 v133, v133, v6
    v_sub_f32 v134, v134, v6
    v_sub_f32 v135, v135, v6
    v_sub_f32 v144, v144, v6
    v_sub_f32 v145, v145, v6
    v_sub_f32 v146, v146, v6
    v_sub_f32 v147, v147, v6
    v_sub_f32 v148, v148, v6
    v_sub_f32 v149, v149, v6
    v_sub_f32 v150, v150, v6
    v_sub_f32 v151, v151, v6
    v_mul_f32 v96, v96, v9
    v_mul_f32 v97, v97, v9
    v_mul_f32 v98, v98, v9
    v_mul_f32 v99, v99, v9
    v_mul_f32 v100, v100, v9
    v_mul_f32 v101, v101, v9
    v_mul_f32 v102, v102, v9
    v_mul_f32 v103, v103, v9
    v_mul_f32 v104, v104, v9
    v_mul_f32 v105, v105, v9
    v_mul_f32 v106, v106, v9
    v_mul_f32 v107, v107, v9
    v_mul_f32 v108, v108, v9
    v_mul_f32 v109, v109, v9
    v_mul_f32 v110, v110, v9
    v_mul_f32 v111, v111, v9
    v_mul_f32 v112, v112, v9
    v_mul_f32 v113, v113, v9
    v_mul_f32 v114, v114, v9
    v_mul_f32 v115, v115, v9
    v_mul_f32 v116, v116, v9
    v_mul_f32 v117, v117, v9
    v_mul_f32 v118, v118, v9
    v_mul_f32 v119, v119, v9
    v_mul_f32 v120, v120, v9
    v_mul_f32 v121, v121, v9
    v_mul_f32 v122, v122, v9
    v_mul_f32 v123, v123, v9
    v_mul_f32 v124, v124, v9
    v_mul_f32 v125, v125, v9
    v_mul_f32 v126, v126, v9
    v_mul_f32 v127, v127, v9
    v_mul_f32 v25, v25, v9
    v_sub_f32 v136, v136, v7
    v_sub_f32 v137, v137, v7
    v_sub_f32 v138, v138, v7
    v_sub_f32 v139, v139, v7
    v_sub_f32 v140, v140, v7
    v_sub_f32 v141, v141, v7
    v_sub_f32 v142, v142, v7
    v_sub_f32 v143, v143, v7
    v_sub_f32 v152, v152, v7
    v_sub_f32 v153, v153, v7
    v_sub_f32 v154, v154, v7
    v_sub_f32 v155, v155, v7
    v_sub_f32 v156, v156, v7
    v_sub_f32 v157, v157, v7
    v_sub_f32 v158, v158, v7
    v_sub_f32 v159, v159, v7
    v_exp_f32 v10, v128
    v_exp_f32 v11, v129
    v_exp_f32 v12, v130
    v_exp_f32 v13, v131
    v_cvt_pk_bf16_f32 v192, v10, v11
    v_exp_f32 v10, v132
    v_exp_f32 v11, v133
    v_cvt_pk_bf16_f32 v193, v12, v13
    v_exp_f32 v12, v134
    v_exp_f32 v13, v135
    v_cvt_pk_bf16_f32 v194, v10, v11
    v_exp_f32 v10, v136
    v_exp_f32 v11, v137
    v_cvt_pk_bf16_f32 v195, v12, v13
    v_exp_f32 v12, v138
    v_exp_f32 v13, v139
    v_cvt_pk_bf16_f32 v196, v10, v11
    v_exp_f32 v10, v140
    v_exp_f32 v11, v141
    v_cvt_pk_bf16_f32 v197, v12, v13
    v_exp_f32 v12, v142
    v_exp_f32 v13, v143
    v_cvt_pk_bf16_f32 v198, v10, v11
    v_cvt_pk_bf16_f32 v199, v12, v13
    v_exp_f32 v10, v144
    v_exp_f32 v11, v145
    v_exp_f32 v12, v146
    v_exp_f32 v13, v147
    v_cvt_pk_bf16_f32 v208, v10, v11
    v_exp_f32 v10, v148
    v_exp_f32 v11, v149
    v_cvt_pk_bf16_f32 v209, v12, v13
    v_exp_f32 v12, v150
    v_exp_f32 v13, v151
    v_cvt_pk_bf16_f32 v210, v10, v11
    v_exp_f32 v10, v152
    v_exp_f32 v11, v153
    v_cvt_pk_bf16_f32 v211, v12, v13
    v_exp_f32 v12, v154
    v_exp_f32 v13, v155
    v_cvt_pk_bf16_f32 v212, v10, v11
    v_exp_f32 v10, v156
    v_exp_f32 v11, v157
    v_cvt_pk_bf16_f32 v213, v12, v13
    v_exp_f32 v12, v158
    v_exp_f32 v13, v159
    v_cvt_pk_bf16_f32 v214, v10, v11
    v_cvt_pk_bf16_f32 v215, v12, v13
    v_mfma_f32_16x16x32_bf16 v[248:251], v[28:31], v[192:195], 0
    v_mfma_f32_16x16x32_bf16 v[252:255], v[28:31], v[196:199], 0
    v_mfma_f32_16x16x32_bf16 v[248:251], v[28:31], v[208:211], v[248:251]
    v_mfma_f32_16x16x32_bf16 v[252:255], v[28:31], v[212:215], v[252:255]
    s_bitcmp1_b32 s32, s22
    s_cbranch_scc1 concat_rback_52
    v_sub_f32 v160, v160, v6
    v_sub_f32 v161, v161, v6
    v_sub_f32 v162, v162, v6
    v_sub_f32 v163, v163, v6
    v_sub_f32 v164, v164, v6
    v_sub_f32 v165, v165, v6
    v_sub_f32 v166, v166, v6
    v_sub_f32 v167, v167, v6
    v_sub_f32 v176, v176, v6
    v_sub_f32 v177, v177, v6
    v_sub_f32 v178, v178, v6
    v_sub_f32 v179, v179, v6
    v_sub_f32 v180, v180, v6
    v_sub_f32 v181, v181, v6
    v_sub_f32 v182, v182, v6
    v_sub_f32 v183, v183, v6
    v_sub_f32 v16, v16, v6
    v_sub_f32 v17, v17, v6
    v_sub_f32 v18, v18, v6
    v_sub_f32 v19, v19, v6
    v_sub_f32 v168, v168, v7
    v_sub_f32 v169, v169, v7
    v_sub_f32 v170, v170, v7
    v_sub_f32 v171, v171, v7
    v_sub_f32 v172, v172, v7
    v_sub_f32 v173, v173, v7
    v_sub_f32 v174, v174, v7
    v_sub_f32 v175, v175, v7
    v_sub_f32 v184, v184, v7
    v_sub_f32 v185, v185, v7
    v_sub_f32 v186, v186, v7
    v_sub_f32 v187, v187, v7
    v_sub_f32 v188, v188, v7
    v_sub_f32 v189, v189, v7
    v_sub_f32 v190, v190, v7
    v_sub_f32 v191, v191, v7
    v_sub_f32 v20, v20, v7
    v_sub_f32 v21, v21, v7
    v_sub_f32 v22, v22, v7
    v_sub_f32 v23, v23, v7
    s_branch concat_rback_52
concat_ev_53:
    s_bitcmp1_b32 s33, s22
    s_cbranch_scc0 concat_skip_75
    s_nop 7
    v_rcp_f32 v14, v24
    v_rcp_f32 v15, v25
    v_mul_f32 v64, v64, v14
    v_mul_f32 v65, v65, v14
    v_mul_f32 v66, v66, v14
    v_mul_f32 v67, v67, v14
    v_mul_f32 v68, v68, v14
    v_mul_f32 v69, v69, v14
    v_mul_f32 v70, v70, v14
    v_mul_f32 v71, v71, v14
    v_cvt_pk_bf16_f32 v64, v64, v65
    v_cvt_pk_bf16_f32 v65, v66, v67
    v_cvt_pk_bf16_f32 v66, v68, v69
    v_cvt_pk_bf16_f32 v67, v70, v71
    s_add_u32 s15, s30, 0
    buffer_store_dwordx4 v[64:67], v2, s[16:19], s15 offen offset:0 sc1
    v_mul_f32 v72, v72, v14
    v_mul_f32 v73, v73, v14
    v_mul_f32 v74, v74, v14
    v_mul_f32 v75, v75, v14
    v_mul_f32 v76, v76, v14
    v_mul_f32 v77, v77, v14
    v_mul_f32 v78, v78, v14
    v_mul_f32 v79, v79, v14
    v_cvt_pk_bf16_f32 v72, v72, v73
    v_cvt_pk_bf16_f32 v73, v74, v75
    v_cvt_pk_bf16_f32 v74, v76, v77
    v_cvt_pk_bf16_f32 v75, v78, v79
    buffer_store_dwordx4 v[72:75], v2, s[16:19], s15 offen offset:1024 sc1
    v_mul_f32 v80, v80, v14
    v_mul_f32 v81, v81, v14
    v_mul_f32 v82, v82, v14
    v_mul_f32 v83, v83, v14
    v_mul_f32 v84, v84, v14
    v_mul_f32 v85, v85, v14
    v_mul_f32 v86, v86, v14
    v_mul_f32 v87, v87, v14
    v_cvt_pk_bf16_f32 v80, v80, v81
    v_cvt_pk_bf16_f32 v81, v82, v83
    v_cvt_pk_bf16_f32 v82, v84, v85
    v_cvt_pk_bf16_f32 v83, v86, v87
    buffer_store_dwordx4 v[80:83], v2, s[16:19], s15 offen offset:2048 sc1
    v_mul_f32 v88, v88, v14
    v_mul_f32 v89, v89, v14
    v_mul_f32 v90, v90, v14
    v_mul_f32 v91, v91, v14
    v_mul_f32 v92, v92, v14
    v_mul_f32 v93, v93, v14
    v_mul_f32 v94, v94, v14
    v_mul_f32 v95, v95, v14
    v_cvt_pk_bf16_f32 v88, v88, v89
    v_cvt_pk_bf16_f32 v89, v90, v91
    v_cvt_pk_bf16_f32 v90, v92, v93
    v_cvt_pk_bf16_f32 v91, v94, v95
    buffer_store_dwordx4 v[88:91], v2, s[16:19], s15 offen offset:3072 sc1
    v_mul_f32 v96, v96, v15
    v_mul_f32 v97, v97, v15
    v_mul_f32 v98, v98, v15
    v_mul_f32 v99, v99, v15
    v_mul_f32 v100, v100, v15
    v_mul_f32 v101, v101, v15
    v_mul_f32 v102, v102, v15
    v_mul_f32 v103, v103, v15
    v_cvt_pk_bf16_f32 v96, v96, v97
    v_cvt_pk_bf16_f32 v97, v98, v99
    v_cvt_pk_bf16_f32 v98, v100, v101
    v_cvt_pk_bf16_f32 v99, v102, v103
    s_add_u32 s15, s30, 4096
    buffer_store_dwordx4 v[96:99], v2, s[16:19], s15 offen offset:0 sc1
    v_mul_f32 v104, v104, v15
    v_mul_f32 v105, v105, v15
    v_mul_f32 v106, v106, v15
    v_mul_f32 v107, v107, v15
    v_mul_f32 v108, v108, v15
    v_mul_f32 v109, v109, v15
    v_mul_f32 v110, v110, v15
    v_mul_f32 v111, v111, v15
    v_cvt_pk_bf16_f32 v104, v104, v105
    v_cvt_pk_bf16_f32 v105, v106, v107
    v_cvt_pk_bf16_f32 v106, v108, v109
    v_cvt_pk_bf16_f32 v107, v110, v111
    buffer_store_dwordx4 v[104:107], v2, s[16:19], s15 offen offset:1024 sc1
    v_mul_f32 v112, v112, v15
    v_mul_f32 v113, v113, v15
    v_mul_f32 v114, v114, v15
    v_mul_f32 v115, v115, v15
    v_mul_f32 v116, v116, v15
    v_mul_f32 v117, v117, v15
    v_mul_f32 v118, v118, v15
    v_mul_f32 v119, v119, v15
    v_cvt_pk_bf16_f32 v112, v112, v113
    v_cvt_pk_bf16_f32 v113, v114, v115
    v_cvt_pk_bf16_f32 v114, v116, v117
    v_cvt_pk_bf16_f32 v115, v118, v119
    buffer_store_dwordx4 v[112:115], v2, s[16:19], s15 offen offset:2048 sc1
    v_mul_f32 v120, v120, v15
    v_mul_f32 v121, v121, v15
    v_mul_f32 v122, v122, v15
    v_mul_f32 v123, v123, v15
    v_mul_f32 v124, v124, v15
    v_mul_f32 v125, v125, v15
    v_mul_f32 v126, v126, v15
    v_mul_f32 v127, v127, v15
    v_cvt_pk_bf16_f32 v120, v120, v121
    v_cvt_pk_bf16_f32 v121, v122, v123
    v_cvt_pk_bf16_f32 v122, v124, v125
    v_cvt_pk_bf16_f32 v123, v126, v127
    buffer_store_dwordx4 v[120:123], v2, s[16:19], s15 offen offset:3072 sc1
    v_mov_b32 v64, 0
    v_mov_b32 v65, 0
    v_mov_b32 v66, 0
    v_mov_b32 v67, 0
    v_mov_b32 v68, 0
    v_mov_b32 v69, 0
    v_mov_b32 v70, 0
    v_mov_b32 v71, 0
    v_mov_b32 v72, 0
    v_mov_b32 v73, 0
    v_mov_b32 v74, 0
    v_mov_b32 v75, 0
    v_mov_b32 v76, 0
    v_mov_b32 v77, 0
    v_mov_b32 v78, 0
    v_mov_b32 v79, 0
    v_mov_b32 v80, 0
    v_mov_b32 v81, 0
    v_mov_b32 v82, 0
    v_mov_b32 v83, 0
    v_mov_b32 v84, 0
    v_mov_b32 v85, 0
    v_mov_b32 v86, 0
    v_mov_b32 v87, 0
    v_mov_b32 v88, 0
    v_mov_b32 v89, 0
    v_mov_b32 v90, 0
    v_mov_b32 v91, 0
    v_mov_b32 v92, 0
    v_mov_b32 v93, 0
    v_mov_b32 v94, 0
    v_mov_b32 v95, 0
    v_mov_b32 v96, 0
    v_mov_b32 v97, 0
    v_mov_b32 v98, 0
    v_mov_b32 v99, 0
    v_mov_b32 v100, 0
    v_mov_b32 v101, 0
    v_mov_b32 v102, 0
    v_mov_b32 v103, 0
    v_mov_b32 v104, 0
    v_mov_b32 v105, 0
    v_mov_b32 v106, 0
    v_mov_b32 v107, 0
    v_mov_b32 v108, 0
    v_mov_b32 v109, 0
    v_mov_b32 v110, 0
    v_mov_b32 v111, 0
    v_mov_b32 v112, 0
    v_mov_b32 v113, 0
    v_mov_b32 v114, 0
    v_mov_b32 v115, 0
    v_mov_b32 v116, 0
    v_mov_b32 v117, 0
    v_mov_b32 v118, 0
    v_mov_b32 v119, 0
    v_mov_b32 v120, 0
    v_mov_b32 v121, 0
    v_mov_b32 v122, 0
    v_mov_b32 v123, 0
    v_mov_b32 v124, 0
    v_mov_b32 v125, 0
    v_mov_b32 v126, 0
    v_mov_b32 v127, 0
    v_mov_b32 v24, 0
    v_mov_b32 v25, 0
concat_skip_75:
    s_nop 7
    s_add_u32 s14, s22, 1
    s_sub_u32 s15, s14, s25
    s_cmp_lt_u32 s15, 2
    s_cbranch_scc0 concat_nomask_76
    s_lshl_b32 s15, s15, 2
    s_lshl_b32 s35, s20, 1
    s_sub_i32 s15, s15, s35
    v_mov_b32 v13, 0xff800000
    v_cmp_gt_i32 s[40:41], 0, v0
    v_cmp_gt_i32 s[42:43], 1, v0
    v_cmp_gt_i32 s[44:45], 2, v0
    v_cmp_gt_i32 s[46:47], 3, v0
    s_cmp_lt_i32 s15, 0
    s_cbranch_scc1 concat_mnext_77
    s_cmp_gt_i32 s15, 0
    s_cbranch_scc1 concat_mfull_78
    v_cndmask_b32 v160, v160, v13, s[40:41]
    v_cndmask_b32 v161, v161, v13, s[42:43]
    v_cndmask_b32 v162, v162, v13, s[44:45]
    v_cndmask_b32 v163, v163, v13, s[46:47]
    s_branch concat_mnext_77
concat_mfull_78:
    v_mov_b32 v160, v13
    v_mov_b32 v161, v13
    v_mov_b32 v162, v13
    v_mov_b32 v163, v13
concat_mnext_77:
    s_cmp_lt_i32 s15, 1
    s_cbranch_scc1 concat_mnext_79
    s_cmp_gt_i32 s15, 1
    s_cbranch_scc1 concat_mfull_80
    v_cndmask_b32 v168, v168, v13, s[40:41]
    v_cndmask_b32 v169, v169, v13, s[42:43]
    v_cndmask_b32 v170, v170, v13, s[44:45]
    v_cndmask_b32 v171, v171, v13, s[46:47]
    s_branch concat_mnext_79
concat_mfull_80:
    v_mov_b32 v168, v13
    v_mov_b32 v169, v13
    v_mov_b32 v170, v13
    v_mov_b32 v171, v13
concat_mnext_79:
    s_cmp_lt_i32 s15, -1
    s_cbranch_scc1 concat_mnext_81
    s_cmp_gt_i32 s15, -1
    s_cbranch_scc1 concat_mfull_82
    v_cndmask_b32 v164, v164, v13, s[40:41]
    v_cndmask_b32 v165, v165, v13, s[42:43]
    v_cndmask_b32 v166, v166, v13, s[44:45]
    v_cndmask_b32 v167, v167, v13, s[46:47]
    s_branch concat_mnext_81
concat_mfull_82:
    v_mov_b32 v164, v13
    v_mov_b32 v165, v13
    v_mov_b32 v166, v13
    v_mov_b32 v167, v13
concat_mnext_81:
    s_cmp_lt_i32 s15, 0
    s_cbranch_scc1 concat_mnext_83
    s_cmp_gt_i32 s15, 0
    s_cbranch_scc1 concat_mfull_84
    v_cndmask_b32 v172, v172, v13, s[40:41]
    v_cndmask_b32 v173, v173, v13, s[42:43]
    v_cndmask_b32 v174, v174, v13, s[44:45]
    v_cndmask_b32 v175, v175, v13, s[46:47]
    s_branch concat_mnext_83
concat_mfull_84:
    v_mov_b32 v172, v13
    v_mov_b32 v173, v13
    v_mov_b32 v174, v13
    v_mov_b32 v175, v13
concat_mnext_83:
    s_cmp_lt_i32 s15, -2
    s_cbranch_scc1 concat_mnext_85
    s_cmp_gt_i32 s15, -2
    s_cbranch_scc1 concat_mfull_86
    v_cndmask_b32 v176, v176, v13, s[40:41]
    v_cndmask_b32 v177, v177, v13, s[42:43]
    v_cndmask_b32 v178, v178, v13, s[44:45]
    v_cndmask_b32 v179, v179, v13, s[46:47]
    s_branch concat_mnext_85
concat_mfull_86:
    v_mov_b32 v176, v13
    v_mov_b32 v177, v13
    v_mov_b32 v178, v13
    v_mov_b32 v179, v13
concat_mnext_85:
    s_cmp_lt_i32 s15, -1
    s_cbranch_scc1 concat_mnext_87
    s_cmp_gt_i32 s15, -1
    s_cbranch_scc1 concat_mfull_88
    v_cndmask_b32 v184, v184, v13, s[40:41]
    v_cndmask_b32 v185, v185, v13, s[42:43]
    v_cndmask_b32 v186, v186, v13, s[44:45]
    v_cndmask_b32 v187, v187, v13, s[46:47]
    s_branch concat_mnext_87
concat_mfull_88:
    v_mov_b32 v184, v13
    v_mov_b32 v185, v13
    v_mov_b32 v186, v13
    v_mov_b32 v187, v13
concat_mnext_87:
    s_cmp_lt_i32 s15, -3
    s_cbranch_scc1 concat_mnext_89
    s_cmp_gt_i32 s15, -3
    s_cbranch_scc1 concat_mfull_90
    v_cndmask_b32 v180, v180, v13, s[40:41]
    v_cndmask_b32 v181, v181, v13, s[42:43]
    v_cndmask_b32 v182, v182, v13, s[44:45]
    v_cndmask_b32 v183, v183, v13, s[46:47]
    s_branch concat_mnext_89
concat_mfull_90:
    v_mov_b32 v180, v13
    v_mov_b32 v181, v13
    v_mov_b32 v182, v13
    v_mov_b32 v183, v13
concat_mnext_89:
    s_cmp_lt_i32 s15, -2
    s_cbranch_scc1 concat_mnext_91
    s_cmp_gt_i32 s15, -2
    s_cbranch_scc1 concat_mfull_92
    v_cndmask_b32 v188, v188, v13, s[40:41]
    v_cndmask_b32 v189, v189, v13, s[42:43]
    v_cndmask_b32 v190, v190, v13, s[44:45]
    v_cndmask_b32 v191, v191, v13, s[46:47]
    s_branch concat_mnext_91
concat_mfull_92:
    v_mov_b32 v188, v13
    v_mov_b32 v189, v13
    v_mov_b32 v190, v13
    v_mov_b32 v191, v13
concat_mnext_91:
concat_nomask_76:
    s_cmp_eq_u32 s14, 0
    s_cbranch_scc1 concat_doinit_94
    s_cmp_lg_u32 s14, s23
    s_cbranch_scc1 concat_noinit_93
concat_doinit_94:
    v_max3_f32 v14, v160, v161, v162
    v_max3_f32 v15, v168, v169, v170
    v_max3_f32 v14, v14, v163, v164
    v_max3_f32 v15, v15, v171, v172
    v_max3_f32 v14, v14, v165, v166
    v_max3_f32 v15, v15, v173, v174
    v_max3_f32 v14, v14, v167, v176
    v_max3_f32 v15, v15, v175, v184
    v_max3_f32 v14, v14, v177, v178
    v_max3_f32 v15, v15, v185, v186
    v_max3_f32 v14, v14, v179, v180
    v_max3_f32 v15, v15, v187, v188
    v_max3_f32 v14, v14, v181, v182
    v_max3_f32 v15, v15, v189, v190
    v_max_f32 v14, v14, v183
    v_max_f32 v15, v15, v191
    v_mov_b32 v10, v14
    v_mov_b32 v11, v15
    s_nop 0
    v_permlane16_swap_b32 v14, v10
    v_permlane16_swap_b32 v15, v11
    v_max_f32 v14, v14, v10
    v_max_f32 v15, v15, v11
    v_mov_b32 v10, v14
    v_mov_b32 v11, v15
    s_nop 0
    v_permlane32_swap_b32 v14, v10
    v_permlane32_swap_b32 v15, v11
    v_max_f32 v14, v14, v10
    v_max_f32 v15, v15, v11
    v_sub_f32 v160, v160, v14
    v_sub_f32 v161, v161, v14
    v_sub_f32 v162, v162, v14
    v_sub_f32 v163, v163, v14
    v_sub_f32 v164, v164, v14
    v_sub_f32 v165, v165, v14
    v_sub_f32 v166, v166, v14
    v_sub_f32 v167, v167, v14
    v_sub_f32 v176, v176, v14
    v_sub_f32 v177, v177, v14
    v_sub_f32 v178, v178, v14
    v_sub_f32 v179, v179, v14
    v_sub_f32 v180, v180, v14
    v_sub_f32 v181, v181, v14
    v_sub_f32 v182, v182, v14
    v_sub_f32 v183, v183, v14
    v_sub_f32 v16, 0, v14
    v_sub_f32 v17, 0, v14
    v_sub_f32 v18, 0, v14
    v_sub_f32 v19, 0, v14
    v_sub_f32 v168, v168, v15
    v_sub_f32 v169, v169, v15
    v_sub_f32 v170, v170, v15
    v_sub_f32 v171, v171, v15
    v_sub_f32 v172, v172, v15
    v_sub_f32 v173, v173, v15
    v_sub_f32 v174, v174, v15
    v_sub_f32 v175, v175, v15
    v_sub_f32 v184, v184, v15
    v_sub_f32 v185, v185, v15
    v_sub_f32 v186, v186, v15
    v_sub_f32 v187, v187, v15
    v_sub_f32 v188, v188, v15
    v_sub_f32 v189, v189, v15
    v_sub_f32 v190, v190, v15
    v_sub_f32 v191, v191, v15
    v_sub_f32 v20, 0, v15
    v_sub_f32 v21, 0, v15
    v_sub_f32 v22, 0, v15
    v_sub_f32 v23, 0, v15
concat_noinit_93:
    s_add_u32 s14, s22, 2
    s_cmp_eq_u32 s14, s23
    s_cbranch_scc0 concat_skip_95
    s_waitcnt lgkmcnt(0)
    ds_read_b128 v[32:35], v5 offset:0
    ds_read_b128 v[36:39], v5 offset:1024
    ds_read_b128 v[40:43], v5 offset:2048
    ds_read_b128 v[44:47], v5 offset:3072
    ds_read_b128 v[48:51], v5 offset:4096
    ds_read_b128 v[52:55], v5 offset:5120
    ds_read_b128 v[56:59], v5 offset:6144
    ds_read_b128 v[60:63], v5 offset:7168
    v_mov_b32 v16, 0
    v_mov_b32 v17, 0
    v_mov_b32 v18, 0
    v_mov_b32 v19, 0
    v_mov_b32 v20, 0
    v_mov_b32 v21, 0
    v_mov_b32 v22, 0
    v_mov_b32 v23, 0
    s_waitcnt lgkmcnt(0)
concat_skip_95:
    s_lshr_b32 s14, s71, s22
    s_cmp_eq_u32 s14, 3
    s_cbranch_scc0 concat_skip_96
    v_lshlrev_b32 v12, 3, v1
    s_mov_b32 s15, 8192
    buffer_load_dwordx2 v[6:7], v12, s[8:11], s15 offen offset:0 sc1
    buffer_load_dwordx2 v[8:9], v12, s[8:11], s15 offen offset:512 sc1
    buffer_load_dwordx2 v[26:27], v12, s[8:11], s15 offen offset:1024 sc1
    buffer_load_dwordx2 v[14:15], v12, s[8:11], s15 offen offset:1536 sc1
concat_skip_96:
    s_lshr_b32 s14, s71, s22
    s_cmp_eq_u32 s14, 1
    s_cbranch_scc0 concat_skip_97
    v_xor_b32 v6, s6, v6
    v_xor_b32 v7, s6, v7
    v_xor_b32 v8, s6, v8
    v_xor_b32 v9, s6, v9
    v_xor_b32 v26, s6, v26
    v_xor_b32 v27, s6, v27
    v_xor_b32 v14, s6, v14
    v_xor_b32 v15, s6, v15
    v_or_b32 v6, v6, v7
    v_or_b32 v6, v6, v9
    v_or_b32 v6, v6, v8
    v_or_b32 v6, v6, v27
    v_or_b32 v6, v6, v26
    v_or_b32 v6, v6, v15
    v_or_b32 v6, v6, v14
    v_cmp_ne_u32 vcc, 0, v6
    s_nop 0
    s_cbranch_vccz concat_yok_98
    v_lshlrev_b32 v12, 3, v1
    s_mov_b32 s15, 8192
    s_mov_b32 s35, 0x100000
concat_poll_99:
    buffer_load_dwordx2 v[6:7], v12, s[8:11], s15 offen offset:0 sc1
    buffer_load_dwordx2 v[8:9], v12, s[8:11], s15 offen offset:512 sc1
    buffer_load_dwordx2 v[26:27], v12, s[8:11], s15 offen offset:1024 sc1
    buffer_load_dwordx2 v[14:15], v12, s[8:11], s15 offen offset:1536 sc1
    s_waitcnt vmcnt(0)
    v_xor_b32 v6, s6, v6
    v_xor_b32 v7, s6, v7
    v_xor_b32 v8, s6, v8
    v_xor_b32 v9, s6, v9
    v_xor_b32 v26, s6, v26
    v_xor_b32 v27, s6, v27
    v_xor_b32 v14, s6, v14
    v_xor_b32 v15, s6, v15
    v_or_b32 v6, v6, v7
    v_or_b32 v6, v6, v9
    v_or_b32 v6, v6, v8
    v_or_b32 v6, v6, v27
    v_or_b32 v6, v6, v26
    v_or_b32 v6, v6, v15
    v_or_b32 v6, v6, v14
    v_cmp_ne_u32 vcc, 0, v6
    s_nop 0
    s_cbranch_vccz concat_pdone_100
    s_sleep 1
    s_sub_u32 s35, s35, 1
    s_cbranch_scc0 concat_poll_99
concat_pdone_100:
concat_yok_98:
concat_skip_97:
    s_branch concat_evb_54
concat_rare_55:
    s_nop 15
    v_max3_f32 v14, v160, v161, v162
    v_max3_f32 v15, v168, v169, v170
    v_max3_f32 v14, v14, v163, v164
    v_max3_f32 v15, v15, v171, v172
    v_max3_f32 v14, v14, v165, v166
    v_max3_f32 v15, v15, v173, v174
    v_max3_f32 v14, v14, v167, v176
    v_max3_f32 v15, v15, v175, v184
    v_max3_f32 v14, v14, v177, v178
    v_max3_f32 v15, v15, v185, v186
    v_max3_f32 v14, v14, v179, v180
    v_max3_f32 v15, v15, v187, v188
    v_max3_f32 v14, v14, v181, v182
    v_max3_f32 v15, v15, v189, v190
    v_max_f32 v14, v14, v183
    v_max_f32 v15, v15, v191
    v_mov_b32 v10, v14
    v_mov_b32 v11, v15
    s_nop 0
    v_permlane16_swap_b32 v14, v10
    v_permlane16_swap_b32 v15, v11
    v_max_f32 v14, v14, v10
    v_max_f32 v15, v15, v11
    v_mov_b32 v10, v14
    v_mov_b32 v11, v15
    s_nop 0
    v_permlane32_swap_b32 v14, v10
    v_permlane32_swap_b32 v15, v11
    v_max_f32 v14, v14, v10
    v_max_f32 v15, v15, v11
    v_max_f32 v6, 0, v14
    v_max_f32 v7, 0, v15
    v_exp_f32 v8, -v6
    v_exp_f32 v9, -v7
    v_mul_f32 v64, v64, v8
    v_mul_f32 v65, v65, v8
    v_mul_f32 v66, v66, v8
    v_mul_f32 v67, v67, v8
    v_mul_f32 v68, v68, v8
    v_mul_f32 v69, v69, v8
    v_mul_f32 v70, v70, v8
    v_mul_f32 v71, v71, v8
    v_mul_f32 v72, v72, v8
    v_mul_f32 v73, v73, v8
    v_mul_f32 v74, v74, v8
    v_mul_f32 v75, v75, v8
    v_mul_f32 v76, v76, v8
    v_mul_f32 v77, v77, v8
    v_mul_f32 v78, v78, v8
    v_mul_f32 v79, v79, v8
    v_mul_f32 v80, v80, v8
    v_mul_f32 v81, v81, v8
    v_mul_f32 v82, v82, v8
    v_mul_f32 v83, v83, v8
    v_mul_f32 v84, v84, v8
    v_mul_f32 v85, v85, v8
    v_mul_f32 v86, v86, v8
    v_mul_f32 v87, v87, v8
    v_mul_f32 v88, v88, v8
    v_mul_f32 v89, v89, v8
    v_mul_f32 v90, v90, v8
    v_mul_f32 v91, v91, v8
    v_mul_f32 v92, v92, v8
    v_mul_f32 v93, v93, v8
    v_mul_f32 v94, v94, v8
    v_mul_f32 v95, v95, v8
    v_mul_f32 v24, v24, v8
    v_sub_f32 v160, v160, v6
    v_sub_f32 v161, v161, v6
    v_sub_f32 v162, v162, v6
    v_sub_f32 v163, v163, v6
    v_sub_f32 v164, v164, v6
    v_sub_f32 v165, v165, v6
    v_sub_f32 v166, v166, v6
    v_sub_f32 v167, v167, v6
    v_sub_f32 v176, v176, v6
    v_sub_f32 v177, v177, v6
    v_sub_f32 v178, v178, v6
    v_sub_f32 v179, v179, v6
    v_sub_f32 v180, v180, v6
    v_sub_f32 v181, v181, v6
    v_sub_f32 v182, v182, v6
    v_sub_f32 v183, v183, v6
    v_mul_f32 v96, v96, v9
    v_mul_f32 v97, v97, v9
    v_mul_f32 v98, v98, v9
    v_mul_f32 v99, v99, v9
    v_mul_f32 v100, v100, v9
    v_mul_f32 v101, v101, v9
    v_mul_f32 v102, v102, v9
    v_mul_f32 v103, v103, v9
    v_mul_f32 v104, v104, v9
    v_mul_f32 v105, v105, v9
    v_mul_f32 v106, v106, v9
    v_mul_f32 v107, v107, v9
    v_mul_f32 v108, v108, v9
    v_mul_f32 v109, v109, v9
    v_mul_f32 v110, v110, v9
    v_mul_f32 v111, v111, v9
    v_mul_f32 v112, v112, v9
    v_mul_f32 v113, v113, v9
    v_mul_f32 v114, v114, v9
    v_mul_f32 v115, v115, v9
    v_mul_f32 v116, v116, v9
    v_mul_f32 v117, v117, v9
    v_mul_f32 v118, v118, v9
    v_mul_f32 v119, v119, v9
    v_mul_f32 v120, v120, v9
    v_mul_f32 v121, v121, v9
    v_mul_f32 v122, v122, v9
    v_mul_f32 v123, v123, v9
    v_mul_f32 v124, v124, v9
    v_mul_f32 v125, v125, v9
    v_mul_f32 v126, v126, v9
    v_mul_f32 v127, v127, v9
    v_mul_f32 v25, v25, v9
    v_sub_f32 v168, v168, v7
    v_sub_f32 v169, v169, v7
    v_sub_f32 v170, v170, v7
    v_sub_f32 v171, v171, v7
    v_sub_f32 v172, v172, v7
    v_sub_f32 v173, v173, v7
    v_sub_f32 v174, v174, v7
    v_sub_f32 v175, v175, v7
    v_sub_f32 v184, v184, v7
    v_sub_f32 v185, v185, v7
    v_sub_f32 v186, v186, v7
    v_sub_f32 v187, v187, v7
    v_sub_f32 v188, v188, v7
    v_sub_f32 v189, v189, v7
    v_sub_f32 v190, v190, v7
    v_sub_f32 v191, v191, v7
    v_exp_f32 v10, v160
    v_exp_f32 v11, v161
    v_exp_f32 v12, v162
    v_exp_f32 v13, v163
    v_cvt_pk_bf16_f32 v200, v10, v11
    v_exp_f32 v10, v164
    v_exp_f32 v11, v165
    v_cvt_pk_bf16_f32 v201, v12, v13
    v_exp_f32 v12, v166
    v_exp_f32 v13, v167
    v_cvt_pk_bf16_f32 v202, v10, v11
    v_exp_f32 v10, v168
    v_exp_f32 v11, v169
    v_cvt_pk_bf16_f32 v203, v12, v13
    v_exp_f32 v12, v170
    v_exp_f32 v13, v171
    v_cvt_pk_bf16_f32 v204, v10, v11
    v_exp_f32 v10, v172
    v_exp_f32 v11, v173
    v_cvt_pk_bf16_f32 v205, v12, v13
    v_exp_f32 v12, v174
    v_exp_f32 v13, v175
    v_cvt_pk_bf16_f32 v206, v10, v11
    v_cvt_pk_bf16_f32 v207, v12, v13
    v_exp_f32 v10, v176
    v_exp_f32 v11, v177
    v_exp_f32 v12, v178
    v_exp_f32 v13, v179
    v_cvt_pk_bf16_f32 v208, v10, v11
    v_exp_f32 v10, v180
    v_exp_f32 v11, v181
    v_cvt_pk_bf16_f32 v209, v12, v13
    v_exp_f32 v12, v182
    v_exp_f32 v13, v183
    v_cvt_pk_bf16_f32 v210, v10, v11
    v_exp_f32 v10, v184
    v_exp_f32 v11, v185
    v_cvt_pk_bf16_f32 v211, v12, v13
    v_exp_f32 v12, v186
    v_exp_f32 v13, v187
    v_cvt_pk_bf16_f32 v212, v10, v11
    v_exp_f32 v10, v188
    v_exp_f32 v11, v189
    v_cvt_pk_bf16_f32 v213, v12, v13
    v_exp_f32 v12, v190
    v_exp_f32 v13, v191
    v_cvt_pk_bf16_f32 v214, v10, v11
    v_cvt_pk_bf16_f32 v215, v12, v13
    v_mfma_f32_16x16x32_bf16 v[248:251], v[28:31], v[200:203], 0
    v_mfma_f32_16x16x32_bf16 v[252:255], v[28:31], v[204:207], 0
    v_mfma_f32_16x16x32_bf16 v[248:251], v[28:31], v[208:211], v[248:251]
    v_mfma_f32_16x16x32_bf16 v[252:255], v[28:31], v[212:215], v[252:255]
    s_bitcmp1_b32 s32, s22
    s_cbranch_scc1 concat_rback_56
    v_sub_f32 v128, v128, v6
    v_sub_f32 v129, v129, v6
    v_sub_f32 v130, v130, v6
    v_sub_f32 v131, v131, v6
    v_sub_f32 v132, v132, v6
    v_sub_f32 v133, v133, v6
    v_sub_f32 v134, v134, v6
    v_sub_f32 v135, v135, v6
    v_sub_f32 v144, v144, v6
    v_sub_f32 v145, v145, v6
    v_sub_f32 v146, v146, v6
    v_sub_f32 v147, v147, v6
    v_sub_f32 v148, v148, v6
    v_sub_f32 v149, v149, v6
    v_sub_f32 v150, v150, v6
    v_sub_f32 v151, v151, v6
    v_sub_f32 v16, v16, v6
    v_sub_f32 v17, v17, v6
    v_sub_f32 v18, v18, v6
    v_sub_f32 v19, v19, v6
    v_sub_f32 v136, v136, v7
    v_sub_f32 v137, v137, v7
    v_sub_f32 v138, v138, v7
    v_sub_f32 v139, v139, v7
    v_sub_f32 v140, v140, v7
    v_sub_f32 v141, v141, v7
    v_sub_f32 v142, v142, v7
    v_sub_f32 v143, v143, v7
    v_sub_f32 v152, v152, v7
    v_sub_f32 v153, v153, v7
    v_sub_f32 v154, v154, v7
    v_sub_f32 v155, v155, v7
    v_sub_f32 v156, v156, v7
    v_sub_f32 v157, v157, v7
    v_sub_f32 v158, v158, v7
    v_sub_f32 v159, v159, v7
    v_sub_f32 v20, v20, v7
    v_sub_f32 v21, v21, v7
    v_sub_f32 v22, v22, v7
    v_sub_f32 v23, v23, v7
    s_branch concat_rback_56
concat_ev_57:
    s_bitcmp1_b32 s33, s22
    s_cbranch_scc0 concat_skip_101
    s_nop 7
    v_rcp_f32 v14, v24
    v_rcp_f32 v15, v25
    v_mul_f32 v64, v64, v14
    v_mul_f32 v65, v65, v14
    v_mul_f32 v66, v66, v14
    v_mul_f32 v67, v67, v14
    v_mul_f32 v68, v68, v14
    v_mul_f32 v69, v69, v14
    v_mul_f32 v70, v70, v14
    v_mul_f32 v71, v71, v14
    v_cvt_pk_bf16_f32 v64, v64, v65
    v_cvt_pk_bf16_f32 v65, v66, v67
    v_cvt_pk_bf16_f32 v66, v68, v69
    v_cvt_pk_bf16_f32 v67, v70, v71
    s_add_u32 s15, s30, 0
    buffer_store_dwordx4 v[64:67], v2, s[16:19], s15 offen offset:0 sc1
    v_mul_f32 v72, v72, v14
    v_mul_f32 v73, v73, v14
    v_mul_f32 v74, v74, v14
    v_mul_f32 v75, v75, v14
    v_mul_f32 v76, v76, v14
    v_mul_f32 v77, v77, v14
    v_mul_f32 v78, v78, v14
    v_mul_f32 v79, v79, v14
    v_cvt_pk_bf16_f32 v72, v72, v73
    v_cvt_pk_bf16_f32 v73, v74, v75
    v_cvt_pk_bf16_f32 v74, v76, v77
    v_cvt_pk_bf16_f32 v75, v78, v79
    buffer_store_dwordx4 v[72:75], v2, s[16:19], s15 offen offset:1024 sc1
    v_mul_f32 v80, v80, v14
    v_mul_f32 v81, v81, v14
    v_mul_f32 v82, v82, v14
    v_mul_f32 v83, v83, v14
    v_mul_f32 v84, v84, v14
    v_mul_f32 v85, v85, v14
    v_mul_f32 v86, v86, v14
    v_mul_f32 v87, v87, v14
    v_cvt_pk_bf16_f32 v80, v80, v81
    v_cvt_pk_bf16_f32 v81, v82, v83
    v_cvt_pk_bf16_f32 v82, v84, v85
    v_cvt_pk_bf16_f32 v83, v86, v87
    buffer_store_dwordx4 v[80:83], v2, s[16:19], s15 offen offset:2048 sc1
    v_mul_f32 v88, v88, v14
    v_mul_f32 v89, v89, v14
    v_mul_f32 v90, v90, v14
    v_mul_f32 v91, v91, v14
    v_mul_f32 v92, v92, v14
    v_mul_f32 v93, v93, v14
    v_mul_f32 v94, v94, v14
    v_mul_f32 v95, v95, v14
    v_cvt_pk_bf16_f32 v88, v88, v89
    v_cvt_pk_bf16_f32 v89, v90, v91
    v_cvt_pk_bf16_f32 v90, v92, v93
    v_cvt_pk_bf16_f32 v91, v94, v95
    buffer_store_dwordx4 v[88:91], v2, s[16:19], s15 offen offset:3072 sc1
    v_mul_f32 v96, v96, v15
    v_mul_f32 v97, v97, v15
    v_mul_f32 v98, v98, v15
    v_mul_f32 v99, v99, v15
    v_mul_f32 v100, v100, v15
    v_mul_f32 v101, v101, v15
    v_mul_f32 v102, v102, v15
    v_mul_f32 v103, v103, v15
    v_cvt_pk_bf16_f32 v96, v96, v97
    v_cvt_pk_bf16_f32 v97, v98, v99
    v_cvt_pk_bf16_f32 v98, v100, v101
    v_cvt_pk_bf16_f32 v99, v102, v103
    s_add_u32 s15, s30, 4096
    buffer_store_dwordx4 v[96:99], v2, s[16:19], s15 offen offset:0 sc1
    v_mul_f32 v104, v104, v15
    v_mul_f32 v105, v105, v15
    v_mul_f32 v106, v106, v15
    v_mul_f32 v107, v107, v15
    v_mul_f32 v108, v108, v15
    v_mul_f32 v109, v109, v15
    v_mul_f32 v110, v110, v15
    v_mul_f32 v111, v111, v15
    v_cvt_pk_bf16_f32 v104, v104, v105
    v_cvt_pk_bf16_f32 v105, v106, v107
    v_cvt_pk_bf16_f32 v106, v108, v109
    v_cvt_pk_bf16_f32 v107, v110, v111
    buffer_store_dwordx4 v[104:107], v2, s[16:19], s15 offen offset:1024 sc1
    v_mul_f32 v112, v112, v15
    v_mul_f32 v113, v113, v15
    v_mul_f32 v114, v114, v15
    v_mul_f32 v115, v115, v15
    v_mul_f32 v116, v116, v15
    v_mul_f32 v117, v117, v15
    v_mul_f32 v118, v118, v15
    v_mul_f32 v119, v119, v15
    v_cvt_pk_bf16_f32 v112, v112, v113
    v_cvt_pk_bf16_f32 v113, v114, v115
    v_cvt_pk_bf16_f32 v114, v116, v117
    v_cvt_pk_bf16_f32 v115, v118, v119
    buffer_store_dwordx4 v[112:115], v2, s[16:19], s15 offen offset:2048 sc1
    v_mul_f32 v120, v120, v15
    v_mul_f32 v121, v121, v15
    v_mul_f32 v122, v122, v15
    v_mul_f32 v123, v123, v15
    v_mul_f32 v124, v124, v15
    v_mul_f32 v125, v125, v15
    v_mul_f32 v126, v126, v15
    v_mul_f32 v127, v127, v15
    v_cvt_pk_bf16_f32 v120, v120, v121
    v_cvt_pk_bf16_f32 v121, v122, v123
    v_cvt_pk_bf16_f32 v122, v124, v125
    v_cvt_pk_bf16_f32 v123, v126, v127
    buffer_store_dwordx4 v[120:123], v2, s[16:19], s15 offen offset:3072 sc1
    v_mov_b32 v64, 0
    v_mov_b32 v65, 0
    v_mov_b32 v66, 0
    v_mov_b32 v67, 0
    v_mov_b32 v68, 0
    v_mov_b32 v69, 0
    v_mov_b32 v70, 0
    v_mov_b32 v71, 0
    v_mov_b32 v72, 0
    v_mov_b32 v73, 0
    v_mov_b32 v74, 0
    v_mov_b32 v75, 0
    v_mov_b32 v76, 0
    v_mov_b32 v77, 0
    v_mov_b32 v78, 0
    v_mov_b32 v79, 0
    v_mov_b32 v80, 0
    v_mov_b32 v81, 0
    v_mov_b32 v82, 0
    v_mov_b32 v83, 0
    v_mov_b32 v84, 0
    v_mov_b32 v85, 0
    v_mov_b32 v86, 0
    v_mov_b32 v87, 0
    v_mov_b32 v88, 0
    v_mov_b32 v89, 0
    v_mov_b32 v90, 0
    v_mov_b32 v91, 0
    v_mov_b32 v92, 0
    v_mov_b32 v93, 0
    v_mov_b32 v94, 0
    v_mov_b32 v95, 0
    v_mov_b32 v96, 0
    v_mov_b32 v97, 0
    v_mov_b32 v98, 0
    v_mov_b32 v99, 0
    v_mov_b32 v100, 0
    v_mov_b32 v101, 0
    v_mov_b32 v102, 0
    v_mov_b32 v103, 0
    v_mov_b32 v104, 0
    v_mov_b32 v105, 0
    v_mov_b32 v106, 0
    v_mov_b32 v107, 0
    v_mov_b32 v108, 0
    v_mov_b32 v109, 0
    v_mov_b32 v110, 0
    v_mov_b32 v111, 0
    v_mov_b32 v112, 0
    v_mov_b32 v113, 0
    v_mov_b32 v114, 0
    v_mov_b32 v115, 0
    v_mov_b32 v116, 0
    v_mov_b32 v117, 0
    v_mov_b32 v118, 0
    v_mov_b32 v119, 0
    v_mov_b32 v120, 0
    v_mov_b32 v121, 0
    v_mov_b32 v122, 0
    v_mov_b32 v123, 0
    v_mov_b32 v124, 0
    v_mov_b32 v125, 0
    v_mov_b32 v126, 0
    v_mov_b32 v127, 0
    v_mov_b32 v24, 0
    v_mov_b32 v25, 0
concat_skip_101:
    s_nop 7
    s_add_u32 s14, s22, 1
    s_sub_u32 s15, s14, s25
    s_cmp_lt_u32 s15, 2
    s_cbranch_scc0 concat_nomask_102
    s_lshl_b32 s15, s15, 2
    s_lshl_b32 s35, s20, 1
    s_sub_i32 s15, s15, s35
    v_mov_b32 v13, 0xff800000
    v_cmp_gt_i32 s[40:41], 0, v0
    v_cmp_gt_i32 s[42:43], 1, v0
    v_cmp_gt_i32 s[44:45], 2, v0
    v_cmp_gt_i32 s[46:47], 3, v0
    s_cmp_lt_i32 s15, 0
    s_cbranch_scc1 concat_mnext_103
    s_cmp_gt_i32 s15, 0
    s_cbranch_scc1 concat_mfull_104
    v_cndmask_b32 v128, v128, v13, s[40:41]
    v_cndmask_b32 v129, v129, v13, s[42:43]
    v_cndmask_b32 v130, v130, v13, s[44:45]
    v_cndmask_b32 v131, v131, v13, s[46:47]
    s_branch concat_mnext_103
concat_mfull_104:
    v_mov_b32 v128, v13
    v_mov_b32 v129, v13
    v_mov_b32 v130, v13
    v_mov_b32 v131, v13
concat_mnext_103:
    s_cmp_lt_i32 s15, 1
    s_cbranch_scc1 concat_mnext_105
    s_cmp_gt_i32 s15, 1
    s_cbranch_scc1 concat_mfull_106
    v_cndmask_b32 v136, v136, v13, s[40:41]
    v_cndmask_b32 v137, v137, v13, s[42:43]
    v_cndmask_b32 v138, v138, v13, s[44:45]
    v_cndmask_b32 v139, v139, v13, s[46:47]
    s_branch concat_mnext_105
concat_mfull_106:
    v_mov_b32 v136, v13
    v_mov_b32 v137, v13
    v_mov_b32 v138, v13
    v_mov_b32 v139, v13
concat_mnext_105:
    s_cmp_lt_i32 s15, -1
    s_cbranch_scc1 concat_mnext_107
    s_cmp_gt_i32 s15, -1
    s_cbranch_scc1 concat_mfull_108
    v_cndmask_b32 v132, v132, v13, s[40:41]
    v_cndmask_b32 v133, v133, v13, s[42:43]
    v_cndmask_b32 v134, v134, v13, s[44:45]
    v_cndmask_b32 v135, v135, v13, s[46:47]
    s_branch concat_mnext_107
concat_mfull_108:
    v_mov_b32 v132, v13
    v_mov_b32 v133, v13
    v_mov_b32 v134, v13
    v_mov_b32 v135, v13
concat_mnext_107:
    s_cmp_lt_i32 s15, 0
    s_cbranch_scc1 concat_mnext_109
    s_cmp_gt_i32 s15, 0
    s_cbranch_scc1 concat_mfull_110
    v_cndmask_b32 v140, v140, v13, s[40:41]
    v_cndmask_b32 v141, v141, v13, s[42:43]
    v_cndmask_b32 v142, v142, v13, s[44:45]
    v_cndmask_b32 v143, v143, v13, s[46:47]
    s_branch concat_mnext_109
concat_mfull_110:
    v_mov_b32 v140, v13
    v_mov_b32 v141, v13
    v_mov_b32 v142, v13
    v_mov_b32 v143, v13
concat_mnext_109:
    s_cmp_lt_i32 s15, -2
    s_cbranch_scc1 concat_mnext_111
    s_cmp_gt_i32 s15, -2
    s_cbranch_scc1 concat_mfull_112
    v_cndmask_b32 v144, v144, v13, s[40:41]
    v_cndmask_b32 v145, v145, v13, s[42:43]
    v_cndmask_b32 v146, v146, v13, s[44:45]
    v_cndmask_b32 v147, v147, v13, s[46:47]
    s_branch concat_mnext_111
concat_mfull_112:
    v_mov_b32 v144, v13
    v_mov_b32 v145, v13
    v_mov_b32 v146, v13
    v_mov_b32 v147, v13
concat_mnext_111:
    s_cmp_lt_i32 s15, -1
    s_cbranch_scc1 concat_mnext_113
    s_cmp_gt_i32 s15, -1
    s_cbranch_scc1 concat_mfull_114
    v_cndmask_b32 v152, v152, v13, s[40:41]
    v_cndmask_b32 v153, v153, v13, s[42:43]
    v_cndmask_b32 v154, v154, v13, s[44:45]
    v_cndmask_b32 v155, v155, v13, s[46:47]
    s_branch concat_mnext_113
concat_mfull_114:
    v_mov_b32 v152, v13
    v_mov_b32 v153, v13
    v_mov_b32 v154, v13
    v_mov_b32 v155, v13
concat_mnext_113:
    s_cmp_lt_i32 s15, -3
    s_cbranch_scc1 concat_mnext_115
    s_cmp_gt_i32 s15, -3
    s_cbranch_scc1 concat_mfull_116
    v_cndmask_b32 v148, v148, v13, s[40:41]
    v_cndmask_b32 v149, v149, v13, s[42:43]
    v_cndmask_b32 v150, v150, v13, s[44:45]
    v_cndmask_b32 v151, v151, v13, s[46:47]
    s_branch concat_mnext_115
concat_mfull_116:
    v_mov_b32 v148, v13
    v_mov_b32 v149, v13
    v_mov_b32 v150, v13
    v_mov_b32 v151, v13
concat_mnext_115:
    s_cmp_lt_i32 s15, -2
    s_cbranch_scc1 concat_mnext_117
    s_cmp_gt_i32 s15, -2
    s_cbranch_scc1 concat_mfull_118
    v_cndmask_b32 v156, v156, v13, s[40:41]
    v_cndmask_b32 v157, v157, v13, s[42:43]
    v_cndmask_b32 v158, v158, v13, s[44:45]
    v_cndmask_b32 v159, v159, v13, s[46:47]
    s_branch concat_mnext_117
concat_mfull_118:
    v_mov_b32 v156, v13
    v_mov_b32 v157, v13
    v_mov_b32 v158, v13
    v_mov_b32 v159, v13
concat_mnext_117:
concat_nomask_102:
    s_cmp_eq_u32 s14, 0
    s_cbranch_scc1 concat_doinit_120
    s_cmp_lg_u32 s14, s23
    s_cbranch_scc1 concat_noinit_119
concat_doinit_120:
    v_max3_f32 v14, v128, v129, v130
    v_max3_f32 v15, v136, v137, v138
    v_max3_f32 v14, v14, v131, v132
    v_max3_f32 v15, v15, v139, v140
    v_max3_f32 v14, v14, v133, v134
    v_max3_f32 v15, v15, v141, v142
    v_max3_f32 v14, v14, v135, v144
    v_max3_f32 v15, v15, v143, v152
    v_max3_f32 v14, v14, v145, v146
    v_max3_f32 v15, v15, v153, v154
    v_max3_f32 v14, v14, v147, v148
    v_max3_f32 v15, v15, v155, v156
    v_max3_f32 v14, v14, v149, v150
    v_max3_f32 v15, v15, v157, v158
    v_max_f32 v14, v14, v151
    v_max_f32 v15, v15, v159
    v_mov_b32 v10, v14
    v_mov_b32 v11, v15
    s_nop 0
    v_permlane16_swap_b32 v14, v10
    v_permlane16_swap_b32 v15, v11
    v_max_f32 v14, v14, v10
    v_max_f32 v15, v15, v11
    v_mov_b32 v10, v14
    v_mov_b32 v11, v15
    s_nop 0
    v_permlane32_swap_b32 v14, v10
    v_permlane32_swap_b32 v15, v11
    v_max_f32 v14, v14, v10
    v_max_f32 v15, v15, v11
    v_sub_f32 v128, v128, v14
    v_sub_f32 v129, v129, v14
    v_sub_f32 v130, v130, v14
    v_sub_f32 v131, v131, v14
    v_sub_f32 v132, v132, v14
    v_sub_f32 v133, v133, v14
    v_sub_f32 v134, v134, v14
    v_sub_f32 v135, v135, v14
    v_sub_f32 v144, v144, v14
    v_sub_f32 v145, v145, v14
    v_sub_f32 v146, v146, v14
    v_sub_f32 v147, v147, v14
    v_sub_f32 v148, v148, v14
    v_sub_f32 v149, v149, v14
    v_sub_f32 v150, v150, v14
    v_sub_f32 v151, v151, v14
    v_sub_f32 v16, 0, v14
    v_sub_f32 v17, 0, v14
    v_sub_f32 v18, 0, v14
    v_sub_f32 v19, 0, v14
    v_sub_f32 v136, v136, v15
    v_sub_f32 v137, v137, v15
    v_sub_f32 v138, v138, v15
    v_sub_f32 v139, v139, v15
    v_sub_f32 v140, v140, v15
    v_sub_f32 v141, v141, v15
    v_sub_f32 v142, v142, v15
    v_sub_f32 v143, v143, v15
    v_sub_f32 v152, v152, v15
    v_sub_f32 v153, v153, v15
    v_sub_f32 v154, v154, v15
    v_sub_f32 v155, v155, v15
    v_sub_f32 v156, v156, v15
    v_sub_f32 v157, v157, v15
    v_sub_f32 v158, v158, v15
    v_sub_f32 v159, v159, v15
    v_sub_f32 v20, 0, v15
    v_sub_f32 v21, 0, v15
    v_sub_f32 v22, 0, v15
    v_sub_f32 v23, 0, v15
concat_noinit_119:
    s_add_u32 s14, s22, 2
    s_cmp_eq_u32 s14, s23
    s_cbranch_scc0 concat_skip_121
    s_waitcnt lgkmcnt(0)
    ds_read_b128 v[32:35], v5 offset:0
    ds_read_b128 v[36:39], v5 offset:1024
    ds_read_b128 v[40:43], v5 offset:2048
    ds_read_b128 v[44:47], v5 offset:3072
    ds_read_b128 v[48:51], v5 offset:4096
    ds_read_b128 v[52:55], v5 offset:5120
    ds_read_b128 v[56:59], v5 offset:6144
    ds_read_b128 v[60:63], v5 offset:7168
    v_mov_b32 v16, 0
    v_mov_b32 v17, 0
    v_mov_b32 v18, 0
    v_mov_b32 v19, 0
    v_mov_b32 v20, 0
    v_mov_b32 v21, 0
    v_mov_b32 v22, 0
    v_mov_b32 v23, 0
    s_waitcnt lgkmcnt(0)
concat_skip_121:
    s_lshr_b32 s14, s71, s22
    s_cmp_eq_u32 s14, 3
    s_cbranch_scc0 concat_skip_122
    v_lshlrev_b32 v12, 3, v1
    s_mov_b32 s15, 8192
    buffer_load_dwordx2 v[6:7], v12, s[8:11], s15 offen offset:0 sc1
    buffer_load_dwordx2 v[8:9], v12, s[8:11], s15 offen offset:512 sc1
    buffer_load_dwordx2 v[26:27], v12, s[8:11], s15 offen offset:1024 sc1
    buffer_load_dwordx2 v[14:15], v12, s[8:11], s15 offen offset:1536 sc1
concat_skip_122:
    s_lshr_b32 s14, s71, s22
    s_cmp_eq_u32 s14, 1
    s_cbranch_scc0 concat_skip_123
    v_xor_b32 v6, s6, v6
    v_xor_b32 v7, s6, v7
    v_xor_b32 v8, s6, v8
    v_xor_b32 v9, s6, v9
    v_xor_b32 v26, s6, v26
    v_xor_b32 v27, s6, v27
    v_xor_b32 v14, s6, v14
    v_xor_b32 v15, s6, v15
    v_or_b32 v6, v6, v7
    v_or_b32 v6, v6, v9
    v_or_b32 v6, v6, v8
    v_or_b32 v6, v6, v27
    v_or_b32 v6, v6, v26
    v_or_b32 v6, v6, v15
    v_or_b32 v6, v6, v14
    v_cmp_ne_u32 vcc, 0, v6
    s_nop 0
    s_cbranch_vccz concat_yok_124
    v_lshlrev_b32 v12, 3, v1
    s_mov_b32 s15, 8192
    s_mov_b32 s35, 0x100000
concat_poll_125:
    buffer_load_dwordx2 v[6:7], v12, s[8:11], s15 offen offset:0 sc1
    buffer_load_dwordx2 v[8:9], v12, s[8:11], s15 offen offset:512 sc1
    buffer_load_dwordx2 v[26:27], v12, s[8:11], s15 offen offset:1024 sc1
    buffer_load_dwordx2 v[14:15], v12, s[8:11], s15 offen offset:1536 sc1
    s_waitcnt vmcnt(0)
    v_xor_b32 v6, s6, v6
    v_xor_b32 v7, s6, v7
    v_xor_b32 v8, s6, v8
    v_xor_b32 v9, s6, v9
    v_xor_b32 v26, s6, v26
    v_xor_b32 v27, s6, v27
    v_xor_b32 v14, s6, v14
    v_xor_b32 v15, s6, v15
    v_or_b32 v6, v6, v7
    v_or_b32 v6, v6, v9
    v_or_b32 v6, v6, v8
    v_or_b32 v6, v6, v27
    v_or_b32 v6, v6, v26
    v_or_b32 v6, v6, v15
    v_or_b32 v6, v6, v14
    v_cmp_ne_u32 vcc, 0, v6
    s_nop 0
    s_cbranch_vccz concat_pdone_126
    s_sleep 1
    s_sub_u32 s35, s35, 1
    s_cbranch_scc0 concat_poll_125
concat_pdone_126:
concat_yok_124:
concat_skip_123:
    s_branch concat_evb_58
concat_rare_59:
    s_nop 15
    v_max3_f32 v14, v128, v129, v130
    v_max3_f32 v15, v136, v137, v138
    v_max3_f32 v14, v14, v131, v132
    v_max3_f32 v15, v15, v139, v140
    v_max3_f32 v14, v14, v133, v134
    v_max3_f32 v15, v15, v141, v142
    v_max3_f32 v14, v14, v135, v144
    v_max3_f32 v15, v15, v143, v152
    v_max3_f32 v14, v14, v145, v146
    v_max3_f32 v15, v15, v153, v154
    v_max3_f32 v14, v14, v147, v148
    v_max3_f32 v15, v15, v155, v156
    v_max3_f32 v14, v14, v149, v150
    v_max3_f32 v15, v15, v157, v158
    v_max_f32 v14, v14, v151
    v_max_f32 v15, v15, v159
    v_mov_b32 v10, v14
    v_mov_b32 v11, v15
    s_nop 0
    v_permlane16_swap_b32 v14, v10
    v_permlane16_swap_b32 v15, v11
    v_max_f32 v14, v14, v10
    v_max_f32 v15, v15, v11
    v_mov_b32 v10, v14
    v_mov_b32 v11, v15
    s_nop 0
    v_permlane32_swap_b32 v14, v10
    v_permlane32_swap_b32 v15, v11
    v_max_f32 v14, v14, v10
    v_max_f32 v15, v15, v11
    v_max_f32 v6, 0, v14
    v_max_f32 v7, 0, v15
    v_exp_f32 v8, -v6
    v_exp_f32 v9, -v7
    v_mul_f32 v64, v64, v8
    v_mul_f32 v65, v65, v8
    v_mul_f32 v66, v66, v8
    v_mul_f32 v67, v67, v8
    v_mul_f32 v68, v68, v8
    v_mul_f32 v69, v69, v8
    v_mul_f32 v70, v70, v8
    v_mul_f32 v71, v71, v8
    v_mul_f32 v72, v72, v8
    v_mul_f32 v73, v73, v8
    v_mul_f32 v74, v74, v8
    v_mul_f32 v75, v75, v8
    v_mul_f32 v76, v76, v8
    v_mul_f32 v77, v77, v8
    v_mul_f32 v78, v78, v8
    v_mul_f32 v79, v79, v8
    v_mul_f32 v80, v80, v8
    v_mul_f32 v81, v81, v8
    v_mul_f32 v82, v82, v8
    v_mul_f32 v83, v83, v8
    v_mul_f32 v84, v84, v8
    v_mul_f32 v85, v85, v8
    v_mul_f32 v86, v86, v8
    v_mul_f32 v87, v87, v8
    v_mul_f32 v88, v88, v8
    v_mul_f32 v89, v89, v8
    v_mul_f32 v90, v90, v8
    v_mul_f32 v91, v91, v8
    v_mul_f32 v92, v92, v8
    v_mul_f32 v93, v93, v8
    v_mul_f32 v94, v94, v8
    v_mul_f32 v95, v95, v8
    v_mul_f32 v24, v24, v8
    v_sub_f32 v128, v128, v6
    v_sub_f32 v129, v129, v6
    v_sub_f32 v130, v130, v6
    v_sub_f32 v131, v131, v6
    v_sub_f32 v132, v132, v6
    v_sub_f32 v133, v133, v6
    v_sub_f32 v134, v134, v6
    v_sub_f32 v135, v135, v6
    v_sub_f32 v144, v144, v6
    v_sub_f32 v145, v145, v6
    v_sub_f32 v146, v146, v6
    v_sub_f32 v147, v147, v6
    v_sub_f32 v148, v148, v6
    v_sub_f32 v149, v149, v6
    v_sub_f32 v150, v150, v6
    v_sub_f32 v151, v151, v6
    v_mul_f32 v96, v96, v9
    v_mul_f32 v97, v97, v9
    v_mul_f32 v98, v98, v9
    v_mul_f32 v99, v99, v9
    v_mul_f32 v100, v100, v9
    v_mul_f32 v101, v101, v9
    v_mul_f32 v102, v102, v9
    v_mul_f32 v103, v103, v9
    v_mul_f32 v104, v104, v9
    v_mul_f32 v105, v105, v9
    v_mul_f32 v106, v106, v9
    v_mul_f32 v107, v107, v9
    v_mul_f32 v108, v108, v9
    v_mul_f32 v109, v109, v9
    v_mul_f32 v110, v110, v9
    v_mul_f32 v111, v111, v9
    v_mul_f32 v112, v112, v9
    v_mul_f32 v113, v113, v9
    v_mul_f32 v114, v114, v9
    v_mul_f32 v115, v115, v9
    v_mul_f32 v116, v116, v9
    v_mul_f32 v117, v117, v9
    v_mul_f32 v118, v118, v9
    v_mul_f32 v119, v119, v9
    v_mul_f32 v120, v120, v9
    v_mul_f32 v121, v121, v9
    v_mul_f32 v122, v122, v9
    v_mul_f32 v123, v123, v9
    v_mul_f32 v124, v124, v9
    v_mul_f32 v125, v125, v9
    v_mul_f32 v126, v126, v9
    v_mul_f32 v127, v127, v9
    v_mul_f32 v25, v25, v9
    v_sub_f32 v136, v136, v7
    v_sub_f32 v137, v137, v7
    v_sub_f32 v138, v138, v7
    v_sub_f32 v139, v139, v7
    v_sub_f32 v140, v140, v7
    v_sub_f32 v141, v141, v7
    v_sub_f32 v142, v142, v7
    v_sub_f32 v143, v143, v7
    v_sub_f32 v152, v152, v7
    v_sub_f32 v153, v153, v7
    v_sub_f32 v154, v154, v7
    v_sub_f32 v155, v155, v7
    v_sub_f32 v156, v156, v7
    v_sub_f32 v157, v157, v7
    v_sub_f32 v158, v158, v7
    v_sub_f32 v159, v159, v7
    v_exp_f32 v10, v128
    v_exp_f32 v11, v129
    v_exp_f32 v12, v130
    v_exp_f32 v13, v131
    v_cvt_pk_bf16_f32 v192, v10, v11
    v_exp_f32 v10, v132
    v_exp_f32 v11, v133
    v_cvt_pk_bf16_f32 v193, v12, v13
    v_exp_f32 v12, v134
    v_exp_f32 v13, v135
    v_cvt_pk_bf16_f32 v194, v10, v11
    v_exp_f32 v10, v136
    v_exp_f32 v11, v137
    v_cvt_pk_bf16_f32 v195, v12, v13
    v_exp_f32 v12, v138
    v_exp_f32 v13, v139
    v_cvt_pk_bf16_f32 v196, v10, v11
    v_exp_f32 v10, v140
    v_exp_f32 v11, v141
    v_cvt_pk_bf16_f32 v197, v12, v13
    v_exp_f32 v12, v142
    v_exp_f32 v13, v143
    v_cvt_pk_bf16_f32 v198, v10, v11
    v_cvt_pk_bf16_f32 v199, v12, v13
    v_exp_f32 v10, v144
    v_exp_f32 v11, v145
    v_exp_f32 v12, v146
    v_exp_f32 v13, v147
    v_cvt_pk_bf16_f32 v208, v10, v11
    v_exp_f32 v10, v148
    v_exp_f32 v11, v149
    v_cvt_pk_bf16_f32 v209, v12, v13
    v_exp_f32 v12, v150
    v_exp_f32 v13, v151
    v_cvt_pk_bf16_f32 v210, v10, v11
    v_exp_f32 v10, v152
    v_exp_f32 v11, v153
    v_cvt_pk_bf16_f32 v211, v12, v13
    v_exp_f32 v12, v154
    v_exp_f32 v13, v155
    v_cvt_pk_bf16_f32 v212, v10, v11
    v_exp_f32 v10, v156
    v_exp_f32 v11, v157
    v_cvt_pk_bf16_f32 v213, v12, v13
    v_exp_f32 v12, v158
    v_exp_f32 v13, v159
    v_cvt_pk_bf16_f32 v214, v10, v11
    v_cvt_pk_bf16_f32 v215, v12, v13
    v_mfma_f32_16x16x32_bf16 v[248:251], v[28:31], v[192:195], 0
    v_mfma_f32_16x16x32_bf16 v[252:255], v[28:31], v[196:199], 0
    v_mfma_f32_16x16x32_bf16 v[248:251], v[28:31], v[208:211], v[248:251]
    v_mfma_f32_16x16x32_bf16 v[252:255], v[28:31], v[212:215], v[252:255]
    s_bitcmp1_b32 s32, s22
    s_cbranch_scc1 concat_rback_60
    v_sub_f32 v16, v16, v6
    v_sub_f32 v17, v17, v6
    v_sub_f32 v18, v18, v6
    v_sub_f32 v19, v19, v6
    v_sub_f32 v20, v20, v7
    v_sub_f32 v21, v21, v7
    v_sub_f32 v22, v22, v7
    v_sub_f32 v23, v23, v7
    s_branch concat_rback_60
concat_ev_61:
    s_bitcmp1_b32 s33, s22
    s_cbranch_scc0 concat_skip_127
    s_nop 7
    v_rcp_f32 v14, v24
    v_rcp_f32 v15, v25
    v_mul_f32 v64, v64, v14
    v_mul_f32 v65, v65, v14
    v_mul_f32 v66, v66, v14
    v_mul_f32 v67, v67, v14
    v_mul_f32 v68, v68, v14
    v_mul_f32 v69, v69, v14
    v_mul_f32 v70, v70, v14
    v_mul_f32 v71, v71, v14
    v_cvt_pk_bf16_f32 v64, v64, v65
    v_cvt_pk_bf16_f32 v65, v66, v67
    v_cvt_pk_bf16_f32 v66, v68, v69
    v_cvt_pk_bf16_f32 v67, v70, v71
    s_add_u32 s15, s30, 0
    buffer_store_dwordx4 v[64:67], v2, s[16:19], s15 offen offset:0 sc1
    v_mul_f32 v72, v72, v14
    v_mul_f32 v73, v73, v14
    v_mul_f32 v74, v74, v14
    v_mul_f32 v75, v75, v14
    v_mul_f32 v76, v76, v14
    v_mul_f32 v77, v77, v14
    v_mul_f32 v78, v78, v14
    v_mul_f32 v79, v79, v14
    v_cvt_pk_bf16_f32 v72, v72, v73
    v_cvt_pk_bf16_f32 v73, v74, v75
    v_cvt_pk_bf16_f32 v74, v76, v77
    v_cvt_pk_bf16_f32 v75, v78, v79
    buffer_store_dwordx4 v[72:75], v2, s[16:19], s15 offen offset:1024 sc1
    v_mul_f32 v80, v80, v14
    v_mul_f32 v81, v81, v14
    v_mul_f32 v82, v82, v14
    v_mul_f32 v83, v83, v14
    v_mul_f32 v84, v84, v14
    v_mul_f32 v85, v85, v14
    v_mul_f32 v86, v86, v14
    v_mul_f32 v87, v87, v14
    v_cvt_pk_bf16_f32 v80, v80, v81
    v_cvt_pk_bf16_f32 v81, v82, v83
    v_cvt_pk_bf16_f32 v82, v84, v85
    v_cvt_pk_bf16_f32 v83, v86, v87
    buffer_store_dwordx4 v[80:83], v2, s[16:19], s15 offen offset:2048 sc1
    v_mul_f32 v88, v88, v14
    v_mul_f32 v89, v89, v14
    v_mul_f32 v90, v90, v14
    v_mul_f32 v91, v91, v14
    v_mul_f32 v92, v92, v14
    v_mul_f32 v93, v93, v14
    v_mul_f32 v94, v94, v14
    v_mul_f32 v95, v95, v14
    v_cvt_pk_bf16_f32 v88, v88, v89
    v_cvt_pk_bf16_f32 v89, v90, v91
    v_cvt_pk_bf16_f32 v90, v92, v93
    v_cvt_pk_bf16_f32 v91, v94, v95
    buffer_store_dwordx4 v[88:91], v2, s[16:19], s15 offen offset:3072 sc1
    v_mul_f32 v96, v96, v15
    v_mul_f32 v97, v97, v15
    v_mul_f32 v98, v98, v15
    v_mul_f32 v99, v99, v15
    v_mul_f32 v100, v100, v15
    v_mul_f32 v101, v101, v15
    v_mul_f32 v102, v102, v15
    v_mul_f32 v103, v103, v15
    v_cvt_pk_bf16_f32 v96, v96, v97
    v_cvt_pk_bf16_f32 v97, v98, v99
    v_cvt_pk_bf16_f32 v98, v100, v101
    v_cvt_pk_bf16_f32 v99, v102, v103
    s_add_u32 s15, s30, 4096
    buffer_store_dwordx4 v[96:99], v2, s[16:19], s15 offen offset:0 sc1
    v_mul_f32 v104, v104, v15
    v_mul_f32 v105, v105, v15
    v_mul_f32 v106, v106, v15
    v_mul_f32 v107, v107, v15
    v_mul_f32 v108, v108, v15
    v_mul_f32 v109, v109, v15
    v_mul_f32 v110, v110, v15
    v_mul_f32 v111, v111, v15
    v_cvt_pk_bf16_f32 v104, v104, v105
    v_cvt_pk_bf16_f32 v105, v106, v107
    v_cvt_pk_bf16_f32 v106, v108, v109
    v_cvt_pk_bf16_f32 v107, v110, v111
    buffer_store_dwordx4 v[104:107], v2, s[16:19], s15 offen offset:1024 sc1
    v_mul_f32 v112, v112, v15
    v_mul_f32 v113, v113, v15
    v_mul_f32 v114, v114, v15
    v_mul_f32 v115, v115, v15
    v_mul_f32 v116, v116, v15
    v_mul_f32 v117, v117, v15
    v_mul_f32 v118, v118, v15
    v_mul_f32 v119, v119, v15
    v_cvt_pk_bf16_f32 v112, v112, v113
    v_cvt_pk_bf16_f32 v113, v114, v115
    v_cvt_pk_bf16_f32 v114, v116, v117
    v_cvt_pk_bf16_f32 v115, v118, v119
    buffer_store_dwordx4 v[112:115], v2, s[16:19], s15 offen offset:2048 sc1
    v_mul_f32 v120, v120, v15
    v_mul_f32 v121, v121, v15
    v_mul_f32 v122, v122, v15
    v_mul_f32 v123, v123, v15
    v_mul_f32 v124, v124, v15
    v_mul_f32 v125, v125, v15
    v_mul_f32 v126, v126, v15
    v_mul_f32 v127, v127, v15
    v_cvt_pk_bf16_f32 v120, v120, v121
    v_cvt_pk_bf16_f32 v121, v122, v123
    v_cvt_pk_bf16_f32 v122, v124, v125
    v_cvt_pk_bf16_f32 v123, v126, v127
    buffer_store_dwordx4 v[120:123], v2, s[16:19], s15 offen offset:3072 sc1
    v_mov_b32 v64, 0
    v_mov_b32 v65, 0
    v_mov_b32 v66, 0
    v_mov_b32 v67, 0
    v_mov_b32 v68, 0
    v_mov_b32 v69, 0
    v_mov_b32 v70, 0
    v_mov_b32 v71, 0
    v_mov_b32 v72, 0
    v_mov_b32 v73, 0
    v_mov_b32 v74, 0
    v_mov_b32 v75, 0
    v_mov_b32 v76, 0
    v_mov_b32 v77, 0
    v_mov_b32 v78, 0
    v_mov_b32 v79, 0
    v_mov_b32 v80, 0
    v_mov_b32 v81, 0
    v_mov_b32 v82, 0
    v_mov_b32 v83, 0
    v_mov_b32 v84, 0
    v_mov_b32 v85, 0
    v_mov_b32 v86, 0
    v_mov_b32 v87, 0
    v_mov_b32 v88, 0
    v_mov_b32 v89, 0
    v_mov_b32 v90, 0
    v_mov_b32 v91, 0
    v_mov_b32 v92, 0
    v_mov_b32 v93, 0
    v_mov_b32 v94, 0
    v_mov_b32 v95, 0
    v_mov_b32 v96, 0
    v_mov_b32 v97, 0
    v_mov_b32 v98, 0
    v_mov_b32 v99, 0
    v_mov_b32 v100, 0
    v_mov_b32 v101, 0
    v_mov_b32 v102, 0
    v_mov_b32 v103, 0
    v_mov_b32 v104, 0
    v_mov_b32 v105, 0
    v_mov_b32 v106, 0
    v_mov_b32 v107, 0
    v_mov_b32 v108, 0
    v_mov_b32 v109, 0
    v_mov_b32 v110, 0
    v_mov_b32 v111, 0
    v_mov_b32 v112, 0
    v_mov_b32 v113, 0
    v_mov_b32 v114, 0
    v_mov_b32 v115, 0
    v_mov_b32 v116, 0
    v_mov_b32 v117, 0
    v_mov_b32 v118, 0
    v_mov_b32 v119, 0
    v_mov_b32 v120, 0
    v_mov_b32 v121, 0
    v_mov_b32 v122, 0
    v_mov_b32 v123, 0
    v_mov_b32 v124, 0
    v_mov_b32 v125, 0
    v_mov_b32 v126, 0
    v_mov_b32 v127, 0
    v_mov_b32 v24, 0
    v_mov_b32 v25, 0
concat_skip_127:
    s_branch concat_evb_62
code_last:
    s_endpgm
.section .rodata,"a"
.p2align 6
.amdhsa_kernel concat_heads__compressed_kv_cla__spectral_gfnet__prompt_kernel
  .amdhsa_next_free_vgpr 256
  .amdhsa_next_free_sgpr 102
  .amdhsa_accum_offset 256
  .amdhsa_group_segment_fixed_size 0
  .amdhsa_kernarg_size 96
  .amdhsa_user_sgpr_count 2
  .amdhsa_user_sgpr_kernarg_segment_ptr 1
  .amdhsa_system_sgpr_workgroup_id_x 1
.end_amdhsa_kernel
```
